```python
import torch

def _softmax(x, axis=-1):
    return torch.softmax(x, dim=axis)

def _gelu(x):
    return torch.nn.functional.gelu(x, approximate='tanh')

def _silu(x):
    return torch.nn.functional.silu(x)

def _sigmoid(x):
    return torch.sigmoid(x)

def _layernorm(x, axis=-1, eps=1e-05):
    m = x.mean(dim=axis, keepdim=True)
    v = x.var(dim=axis, keepdim=True, unbiased=False)
    return (x - m) / torch.sqrt(v + eps)

def _scatter_add(tgt, idx, src, axis=0):
    return tgt.clone().index_add_(axis, idx, src)

def _segment_sum(src, seg, n):
    out = torch.zeros((n,) + src.shape[1:], dtype=src.dtype)
    return out.index_add_(0, seg, src)

def _pad(x, pw):
    flat = tuple((v for pair in reversed(pw) for v in pair))
    return torch.nn.functional.pad(x, flat)
kernel_name = 'sequential_preLN__spectral_gfnet__mixer_gmlp__prompt'

def setup_inputs():

    _w = lambda a: (lambda t: t.to(torch.bfloat16) if t.is_floating_point() else t)(torch.as_tensor(a))

    def _A_setup():
        B, S, D = (1, 2048, 512)
        Df = D // 2 + 1
        return {'x': _w((lambda *s: torch.randn(*s, dtype=torch.bfloat16) * 0.05)(B, S, D)), 'w_r': _w((lambda *s: torch.randn(*s, dtype=torch.bfloat16) * 0.4)(S, Df) * 0.02), 'w_i': _w((lambda *s: torch.randn(*s, dtype=torch.bfloat16) * 0.4)(S, Df) * 0.02)}
    _A_in = _A_setup()

    def _B_setup():
        B, S, D, F = (1, 2048, 512, 1792)
        Fh = F // 2
        return {'x': _w((lambda *s: torch.randn(*s, dtype=torch.bfloat16) * 0.05)(B, S, D)), 'w_in': _w((lambda *s: torch.randn(*s, dtype=torch.bfloat16) * 0.4)(D, 2 * Fh)), 'w_sp': _w(0.01 * (lambda *s: torch.randn(*s, dtype=torch.bfloat16) * 0.4)(S, S)), 'b_sp': _w(1.0 + 0.01 * (lambda *s: torch.randn(*s, dtype=torch.bfloat16) * 0.05)(S)), 'w_out': _w((lambda *s: torch.randn(*s, dtype=torch.bfloat16) * 0.05)(Fh, D))}
    _B_in = _B_setup()
    return {'A_x': _A_in['x'], 'A_w_r': _A_in['w_r'], 'A_w_i': _A_in['w_i'], 'B_x': _B_in['x'], 'B_w_in': _B_in['w_in'], 'B_w_sp': _B_in['w_sp'], 'B_b_sp': _B_in['b_sp'], 'B_w_out': _B_in['w_out']}

def reference(A_x, A_w_r, A_w_i, B_x, B_w_in, B_w_sp, B_b_sp, B_w_out):

    def _A_ref(x, w_r, w_i):
        B, S, D = x.shape
        X = (lambda x, axes=(-2, -1): torch.fft.rfft2(x.float(), dim=axes))(x, axes=(-2, -1))
        W = w_r + 1j * w_i
        X = X * W
        y = (lambda x, s, axes=(-2, -1): torch.fft.irfft2(x, s=s, dim=axes).to(torch.bfloat16))(X, (S, D), axes=(-2, -1))
        return y

    def _B_ref(x, w_in, w_sp, b_sp, w_out):
        B, S, D = x.shape
        F = w_in.shape[-1]
        Fh = F // 2
        z = _gelu(torch.einsum('bsd,df->bsf', x, w_in))
        z1 = z[..., :Fh].clone()
        z2 = _layernorm(z[..., Fh:], axis=-1)
        g = torch.einsum('ts,bsf->btf', w_sp, z2) + b_sp[None, :, None]
        return torch.einsum('bsf,fd->bsd', z1 * g, w_out)
    x = A_x
    h = x + _A_ref(_layernorm(x, axis=-1), A_w_r, A_w_i)
    h2 = h + _B_ref(_layernorm(h, axis=-1), B_w_in, B_w_sp, B_b_sp, B_w_out)
    return h2
```

```asm
; @launch grid=(256,1,1) block=(256,1,1) lds=163840
.amdgcn_target "amdgcn-amd-amdhsa--gfx950"
.text
.globl sequential_preLN__spectral_gfnet__mixer_gmlp__prompt_kernel
.p2align 8
.type sequential_preLN__spectral_gfnet__mixer_gmlp__prompt_kernel,@function
sequential_preLN__spectral_gfnet__mixer_gmlp__prompt_kernel:
    s_cmp_ge_u32 s2, 256
    s_cbranch_scc1 L_end
    s_load_dwordx2 s[8:9], s[0:1], 0
    s_load_dwordx2 s[12:13], s[0:1], 8
    s_load_dwordx2 s[16:17], s[0:1], 16
    s_load_dwordx2 s[40:41], s[0:1], 80
    s_load_dwordx2 s[20:21], s[0:1], 32
    s_load_dwordx2 s[24:25], s[0:1], 40
    s_load_dwordx2 s[28:29], s[0:1], 48
    s_load_dwordx2 s[32:33], s[0:1], 56
    s_load_dwordx2 s[36:37], s[0:1], 64
    s_getpc_b64 s[6:7]
L_pc:
    s_bfe_u32 s48, s2, 0x30003
    s_cmp_eq_u32 s48, 7
    s_cselect_b32 s48, 0, s48
    s_lshl_b32 s48, s48, 13
    s_min_u32 s48, s48, L_padend-L_pc-8192
    s_add_u32 s6, s6, s48
    s_addc_u32 s7, s7, 0
    v_lshlrev_b32 v6, 7, v0
    v_mov_b32 v7, s7
    v_add_co_u32 v6, vcc, s6, v6
    v_lshrrev_b32 v5, 6, v0
    v_and_b32 v1, 63, v0
    v_addc_co_u32 v7, vcc, 0, v7, vcc
    v_cmp_gt_u32 vcc, 64, v0
    v_readfirstlane_b32 s44, v5
    s_and_saveexec_b64 s[6:7], vcc
    s_nop 3
    s_cbranch_execz L_ncode_1
    global_load_dword v15, v[6:7], off
L_ncode_1:
    s_mov_b64 exec, -1
    v_lshlrev_b32 v2, 4, v1
    v_and_b32 v3, 15, v1
    v_lshrrev_b32 v4, 4, v1
    s_bfe_u32 s46, s2, 0x20003
    s_lshr_b32 s47, s2, 5
    s_lshl_b32 s47, s47, 3
    s_and_b32 s48, s2, 7
    s_or_b32 s47, s47, s48
    s_mov_b32 s10, 2097152
    s_mov_b32 s11, 0x20000
    s_and_b32 s52, s47, 1
    s_lshl_b32 s52, s52, 10
    s_lshl_b32 s49, s44, 8
    s_add_u32 s52, s52, s49
    s_lshr_b32 s49, s47, 1
    s_add_u32 s52, s52, s49
    s_lshl_b32 s52, s52, 10
    s_mul_i32 m0, s44, 8320
    s_lshl_b32 s48, s46, 6
    s_lshl_b32 s49, s44, 4
    s_add_u32 s48, s48, s49
    s_add_u32 s48, s48, 1
    v_add_u32 v193, s48, v3
    v_cvt_f32_u32 v192, v193
    v_lshlrev_b32 v200, 3, v4
    v_mul_f32 v192, 0x3b000000, v192
    v_cvt_f32_u32_e64 v200, v200
    v_mul_f32 v194, 0x42000000, v192
    v_mul_f32 v200, v200, v192
    v_add_f32 v216, v200, v194
    v_cos_f32 v194, v194
    v_add_f32 v201, v200, v192
    v_add_f32 v217, v216, v192
    v_add_f32 v202, v201, v192
    v_add_f32 v218, v217, v192
    v_add_f32 v203, v202, v192
    v_add_f32 v219, v218, v192
    v_add_f32 v204, v203, v192
    v_add_f32 v220, v219, v192
    v_add_f32 v205, v204, v192
    v_add_f32 v221, v220, v192
    v_add_f32 v206, v205, v192
    v_add_f32 v222, v221, v192
    v_add_f32 v207, v206, v192
    v_add_f32 v223, v222, v192
    v_add_f32 v194, v194, v194
    v_sin_f32 v208, v200
    v_cos_f32 v200, v200
    v_sin_f32 v209, v201
    v_cos_f32 v201, v201
    s_waitcnt lgkmcnt(0)
    buffer_load_dwordx4 v2, s[8:11], s52 offen nt lds
    s_add_u32 m0, m0, 1040
    s_add_u32 s52, s52, 32768
    buffer_load_dwordx4 v2, s[8:11], s52 offen nt lds
    s_add_u32 m0, m0, 1040
    s_add_u32 s52, s52, 32768
    buffer_load_dwordx4 v2, s[8:11], s52 offen nt lds
    s_add_u32 m0, m0, 1040
    s_add_u32 s52, s52, 32768
    buffer_load_dwordx4 v2, s[8:11], s52 offen nt lds
    s_add_u32 m0, m0, 1040
    s_add_u32 s52, s52, 32768
    buffer_load_dwordx4 v2, s[8:11], s52 offen nt lds
    s_add_u32 m0, m0, 1040
    s_add_u32 s52, s52, 32768
    v_sin_f32 v210, v202
    v_cos_f32 v202, v202
    v_sin_f32 v211, v203
    v_cos_f32_e64 v203, v203
    buffer_load_dwordx4 v2, s[8:11], s52 offen nt lds
    s_add_u32 m0, m0, 1040
    s_add_u32 s52, s52, 32768
    v_sin_f32 v212, v204
    v_cos_f32 v204, v204
    v_sin_f32 v213, v205
    v_cos_f32 v205, v205
    buffer_load_dwordx4 v2, s[8:11], s52 offen nt lds
    s_add_u32 m0, m0, 1040
    s_add_u32 s52, s52, 32768
    v_sin_f32 v214, v206
    v_cos_f32 v206, v206
    v_sin_f32 v215, v207
    v_cos_f32 v207, v207
    buffer_load_dwordx4 v2, s[8:11], s52 offen nt lds
    s_load_dword s45, s[40:41], 0
    v_sin_f32 v224, v216
    v_cos_f32 v216, v216
    v_sin_f32 v225, v217
    v_cos_f32 v217, v217
    v_sin_f32 v226, v218
    v_cos_f32 v218, v218
    v_sin_f32 v227, v219
    v_cos_f32 v219, v219
    s_mov_b32 s14, 1052672
    s_mov_b32 s15, 0x20000
    s_mov_b32 s18, 1052672
    s_mov_b32 s19, 0x20000
    v_bfe_u32 v8, v1, 3, 2
    v_lshlrev_b32 v8, 6, v8
    v_lshrrev_b32 v9, 5, v1
    v_add_u32_e64 v8, v8, v9
    v_mul_u32_u24 v8, 514, v8
    v_and_b32 v5, 7, v1
    v_lshlrev_b32 v5, 4, v5
    v_add_u32 v8, v8, v5
    s_and_b32 s53, s47, 7
    s_lshl_b32 s54, s53, 3
    s_lshr_b32 s49, s47, 3
    s_lshl_b32 s53, s49, 8
    s_add_u32 s53, s53, s54
    s_add_u32 s54, s54, s49
    s_lshl_b32 s49, s44, 1
    s_add_u32 s53, s53, s49
    s_mul_i32 s53, s53, 514
    s_lshl_b32 s49, s46, 7
    s_add_u32 s53, s53, s49
    s_add_u32 s53, s53, 2
    v_sin_f32 v228, v220
    v_cos_f32 v220, v220
    v_sin_f32 v229, v221
    v_cos_f32 v221, v221
    v_sin_f32 v230, v222
    v_cos_f32 v222, v222
    v_sin_f32_e64 v231, v223
    buffer_load_dwordx4 v[24:27], v8, s[12:15], s53 offen nt
    v_cos_f32_e64 v223, v223
    v_cvt_pk_bf16_f32 v64, v200, v201
    v_cvt_pk_bf16_f32 v65, v202, v203
    v_cvt_pk_bf16_f32 v66, v204, v205
    v_cvt_pk_bf16_f32 v67, v206, v207
    v_cvt_pk_bf16_f32 v68, -v208, -v209
    v_cvt_pk_bf16_f32 v69, -v210, -v211
    v_cvt_pk_bf16_f32 v70, -v212, -v213
    buffer_load_dwordx4 v[28:31], v8, s[16:19], s53 offen nt
    v_cvt_pk_bf16_f32 v71, -v214, -v215
    v_cvt_pk_bf16_f32 v72, v216, v217
    v_cvt_pk_bf16_f32 v73, v218, v219
    v_cvt_pk_bf16_f32 v74, v220, v221
    v_cvt_pk_bf16_f32 v75, v222, v223
    v_cvt_pk_bf16_f32 v76, -v224, -v225
    v_cvt_pk_bf16_f32 v77, -v226, -v227
    s_mov_b32 s42, 24117248
    s_mov_b32 s43, 0x20000
    v_cvt_pk_bf16_f32 v78, -v228, -v229
    v_cvt_pk_bf16_f32 v79, -v230, -v231
    v_pk_fma_f32 v[200:201], v[216:217], v[194:195], v[200:201] op_sel_hi:[1,0,1] neg_lo:[0,0,1] neg_hi:[0,0,1]
    v_pk_fma_f32 v[202:203], v[218:219], v[194:195], v[202:203] op_sel_hi:[1,0,1] neg_lo:[0,0,1] neg_hi:[0,0,1]
    v_pk_fma_f32 v[204:205], v[220:221], v[194:195], v[204:205] op_sel_hi:[1,0,1] neg_lo:[0,0,1] neg_hi:[0,0,1]
    v_pk_fma_f32 v[206:207], v[222:223], v[194:195], v[206:207] op_sel_hi:[1,0,1] neg_lo:[0,0,1] neg_hi:[0,0,1]
    v_pk_fma_f32 v[208:209], v[224:225], v[194:195], v[208:209] op_sel_hi:[1,0,1] neg_lo:[0,0,1] neg_hi:[0,0,1]
    v_pk_fma_f32 v[210:211], v[226:227], v[194:195], v[210:211] op_sel_hi:[1,0,1] neg_lo:[0,0,1] neg_hi:[0,0,1]
    v_pk_fma_f32 v[212:213], v[228:229], v[194:195], v[212:213] op_sel_hi:[1,0,1] neg_lo:[0,0,1] neg_hi:[0,0,1]
    v_pk_fma_f32 v[214:215], v[230:231], v[194:195], v[214:215] op_sel_hi:[1,0,1] neg_lo:[0,0,1] neg_hi:[0,0,1]
    v_cvt_pk_bf16_f32 v80, v200, v201
    v_cvt_pk_bf16_f32 v81, v202, v203
    v_cvt_pk_bf16_f32 v82, v204, v205
    v_cvt_pk_bf16_f32 v83, v206, v207
    v_cvt_pk_bf16_f32 v84, -v208, -v209
    v_cvt_pk_bf16_f32 v85, -v210, -v211
    v_cvt_pk_bf16_f32 v86, -v212, -v213
    v_cvt_pk_bf16_f32 v87, -v214, -v215
    v_pk_fma_f32 v[216:217], v[200:201], v[194:195], v[216:217] op_sel_hi:[1,0,1] neg_lo:[0,0,1] neg_hi:[0,0,1]
    v_pk_fma_f32 v[218:219], v[202:203], v[194:195], v[218:219] op_sel_hi:[1,0,1] neg_lo:[0,0,1] neg_hi:[0,0,1]
    v_pk_fma_f32 v[220:221], v[204:205], v[194:195], v[220:221] op_sel_hi:[1,0,1] neg_lo:[0,0,1] neg_hi:[0,0,1]
    v_pk_fma_f32 v[222:223], v[206:207], v[194:195], v[222:223] op_sel_hi:[1,0,1] neg_lo:[0,0,1] neg_hi:[0,0,1]
    v_pk_fma_f32 v[224:225], v[208:209], v[194:195], v[224:225] op_sel_hi:[1,0,1] neg_lo:[0,0,1] neg_hi:[0,0,1]
    v_pk_fma_f32 v[226:227], v[210:211], v[194:195], v[226:227] op_sel_hi:[1,0,1] neg_lo:[0,0,1] neg_hi:[0,0,1]
    v_pk_fma_f32 v[228:229], v[212:213], v[194:195], v[228:229] op_sel_hi:[1,0,1] neg_lo:[0,0,1] neg_hi:[0,0,1]
    v_pk_fma_f32 v[230:231], v[214:215], v[194:195], v[230:231] op_sel_hi:[1,0,1] neg_lo:[0,0,1] neg_hi:[0,0,1]
    v_cvt_pk_bf16_f32 v88, v216, v217
    v_cvt_pk_bf16_f32 v89, v218, v219
    v_cvt_pk_bf16_f32 v90, v220, v221
    v_cvt_pk_bf16_f32 v91, v222, v223
    v_cvt_pk_bf16_f32 v92, -v224, -v225
    v_cvt_pk_bf16_f32 v93, -v226, -v227
    v_cvt_pk_bf16_f32 v94, -v228, -v229
    v_cvt_pk_bf16_f32 v95, -v230, -v231
    v_pk_fma_f32 v[200:201], v[216:217], v[194:195], v[200:201] op_sel_hi:[1,0,1] neg_lo:[0,0,1] neg_hi:[0,0,1]
    v_pk_fma_f32 v[202:203], v[218:219], v[194:195], v[202:203] op_sel_hi:[1,0,1] neg_lo:[0,0,1] neg_hi:[0,0,1]
    v_pk_fma_f32 v[204:205], v[220:221], v[194:195], v[204:205] op_sel_hi:[1,0,1] neg_lo:[0,0,1] neg_hi:[0,0,1]
    v_pk_fma_f32 v[206:207], v[222:223], v[194:195], v[206:207] op_sel_hi:[1,0,1] neg_lo:[0,0,1] neg_hi:[0,0,1]
    v_pk_fma_f32 v[208:209], v[224:225], v[194:195], v[208:209] op_sel_hi:[1,0,1] neg_lo:[0,0,1] neg_hi:[0,0,1]
    v_pk_fma_f32 v[210:211], v[226:227], v[194:195], v[210:211] op_sel_hi:[1,0,1] neg_lo:[0,0,1] neg_hi:[0,0,1]
    v_pk_fma_f32 v[212:213], v[228:229], v[194:195], v[212:213] op_sel_hi:[1,0,1] neg_lo:[0,0,1] neg_hi:[0,0,1]
    v_pk_fma_f32 v[214:215], v[230:231], v[194:195], v[214:215] op_sel_hi:[1,0,1] neg_lo:[0,0,1] neg_hi:[0,0,1]
    v_cvt_pk_bf16_f32 v96, v200, v201
    v_cvt_pk_bf16_f32 v97, v202, v203
    v_cvt_pk_bf16_f32 v98, v204, v205
    v_cvt_pk_bf16_f32 v99, v206, v207
    v_cvt_pk_bf16_f32 v100, -v208, -v209
    v_cvt_pk_bf16_f32 v101, -v210, -v211
    v_cvt_pk_bf16_f32 v102, -v212, -v213
    v_cvt_pk_bf16_f32 v103, -v214, -v215
    v_pk_fma_f32 v[216:217], v[200:201], v[194:195], v[216:217] op_sel_hi:[1,0,1] neg_lo:[0,0,1] neg_hi:[0,0,1]
    v_pk_fma_f32 v[218:219], v[202:203], v[194:195], v[218:219] op_sel_hi:[1,0,1] neg_lo:[0,0,1] neg_hi:[0,0,1]
    v_pk_fma_f32 v[220:221], v[204:205], v[194:195], v[220:221] op_sel_hi:[1,0,1] neg_lo:[0,0,1] neg_hi:[0,0,1]
    v_pk_fma_f32 v[222:223], v[206:207], v[194:195], v[222:223] op_sel_hi:[1,0,1] neg_lo:[0,0,1] neg_hi:[0,0,1]
    v_pk_fma_f32 v[224:225], v[208:209], v[194:195], v[224:225] op_sel_hi:[1,0,1] neg_lo:[0,0,1] neg_hi:[0,0,1]
    v_pk_fma_f32 v[226:227], v[210:211], v[194:195], v[226:227] op_sel_hi:[1,0,1] neg_lo:[0,0,1] neg_hi:[0,0,1]
    v_pk_fma_f32 v[228:229], v[212:213], v[194:195], v[228:229] op_sel_hi:[1,0,1] neg_lo:[0,0,1] neg_hi:[0,0,1]
    v_pk_fma_f32 v[230:231], v[214:215], v[194:195], v[230:231] op_sel_hi:[1,0,1] neg_lo:[0,0,1] neg_hi:[0,0,1]
    v_cvt_pk_bf16_f32 v104, v216, v217
    v_cvt_pk_bf16_f32 v105, v218, v219
    v_cvt_pk_bf16_f32 v106, v220, v221
    v_cvt_pk_bf16_f32 v107, v222, v223
    v_cvt_pk_bf16_f32 v108, -v224, -v225
    v_cvt_pk_bf16_f32 v109, -v226, -v227
    v_cvt_pk_bf16_f32 v110, -v228, -v229
    v_cvt_pk_bf16_f32 v111, -v230, -v231
    v_pk_fma_f32 v[200:201], v[216:217], v[194:195], v[200:201] op_sel_hi:[1,0,1] neg_lo:[0,0,1] neg_hi:[0,0,1]
    v_pk_fma_f32 v[202:203], v[218:219], v[194:195], v[202:203] op_sel_hi:[1,0,1] neg_lo:[0,0,1] neg_hi:[0,0,1]
    v_pk_fma_f32 v[204:205], v[220:221], v[194:195], v[204:205] op_sel_hi:[1,0,1] neg_lo:[0,0,1] neg_hi:[0,0,1]
    v_pk_fma_f32 v[206:207], v[222:223], v[194:195], v[206:207] op_sel_hi:[1,0,1] neg_lo:[0,0,1] neg_hi:[0,0,1]
    v_pk_fma_f32 v[208:209], v[224:225], v[194:195], v[208:209] op_sel_hi:[1,0,1] neg_lo:[0,0,1] neg_hi:[0,0,1]
    v_pk_fma_f32 v[210:211], v[226:227], v[194:195], v[210:211] op_sel_hi:[1,0,1] neg_lo:[0,0,1] neg_hi:[0,0,1]
    v_pk_fma_f32 v[212:213], v[228:229], v[194:195], v[212:213] op_sel_hi:[1,0,1] neg_lo:[0,0,1] neg_hi:[0,0,1]
    v_pk_fma_f32 v[214:215], v[230:231], v[194:195], v[214:215] op_sel_hi:[1,0,1] neg_lo:[0,0,1] neg_hi:[0,0,1]
    v_cvt_pk_bf16_f32 v112, v200, v201
    v_cvt_pk_bf16_f32 v113, v202, v203
    v_cvt_pk_bf16_f32 v114, v204, v205
    v_cvt_pk_bf16_f32 v115, v206, v207
    v_cvt_pk_bf16_f32 v116, -v208, -v209
    v_cvt_pk_bf16_f32 v117, -v210, -v211
    v_cvt_pk_bf16_f32 v118, -v212, -v213
    v_cvt_pk_bf16_f32 v119, -v214, -v215
    v_pk_fma_f32 v[216:217], v[200:201], v[194:195], v[216:217] op_sel_hi:[1,0,1] neg_lo:[0,0,1] neg_hi:[0,0,1]
    v_pk_fma_f32 v[218:219], v[202:203], v[194:195], v[218:219] op_sel_hi:[1,0,1] neg_lo:[0,0,1] neg_hi:[0,0,1]
    v_pk_fma_f32 v[220:221], v[204:205], v[194:195], v[220:221] op_sel_hi:[1,0,1] neg_lo:[0,0,1] neg_hi:[0,0,1]
    v_pk_fma_f32 v[222:223], v[206:207], v[194:195], v[222:223] op_sel_hi:[1,0,1] neg_lo:[0,0,1] neg_hi:[0,0,1]
    v_pk_fma_f32 v[224:225], v[208:209], v[194:195], v[224:225] op_sel_hi:[1,0,1] neg_lo:[0,0,1] neg_hi:[0,0,1]
    v_pk_fma_f32 v[226:227], v[210:211], v[194:195], v[226:227] op_sel_hi:[1,0,1] neg_lo:[0,0,1] neg_hi:[0,0,1]
    v_pk_fma_f32 v[228:229], v[212:213], v[194:195], v[228:229] op_sel_hi:[1,0,1] neg_lo:[0,0,1] neg_hi:[0,0,1]
    v_pk_fma_f32 v[230:231], v[214:215], v[194:195], v[230:231] op_sel_hi:[1,0,1] neg_lo:[0,0,1] neg_hi:[0,0,1]
    v_cvt_pk_bf16_f32 v120, v216, v217
    v_cvt_pk_bf16_f32 v121, v218, v219
    v_cvt_pk_bf16_f32 v122, v220, v221
    v_cvt_pk_bf16_f32 v123, v222, v223
    v_cvt_pk_bf16_f32 v124, -v224, -v225
    v_cvt_pk_bf16_f32 v125, -v226, -v227
    v_cvt_pk_bf16_f32 v126, -v228, -v229
    v_cvt_pk_bf16_f32 v127, -v230, -v231
    v_mul_u32_u24 v12, 1040, v3
    s_and_b32 s48, s44, 1
    s_lshr_b32 s49, s44, 1
    v_lshl_add_u32 v12, v4, 4, v12
    s_mul_i32 s50, s48, 16640
    s_lshl_b32 s51, s49, 9
    s_add_u32 s50, s50, s51
    v_add_u32 v200, s50, v12
    s_xor_b32 s50, s48, 1
    s_mul_i32 s50, s50, 16640
    s_add_u32 s50, s50, s51
    v_add_u32 v202, s50, v12
    s_xor_b32 s50, s51, 0x200
    s_sub_u32 s50, s50, s51
    v_add_u32 v201, s50, v200
    v_add_u32_e64 v203, s50, v202
    v_mov_b32 v204, 0x3f803f80
    v_mov_b32 v205, 0x3f803f80
    v_mov_b32 v206, 0x3f803f80
    v_mov_b32 v207, 0x3f803f80
    s_mov_b32 s22, 1835008
    s_mov_b32 s23, 0x20000
    v_lshrrev_b32_e64 v9, 2, v1
    v_mul_u32_u24 v9, 3584, v9
    v_and_b32 v10, 3, v1
    v_and_b32 v11, 2, v4
    v_xor_b32_e64 v10, v10, v11
    v_lshl_add_u32 v9, v10, 4, v9
    s_lshl_b32 s50, s54, 6
    s_mul_i32 s51, s44, 458752
    s_add_u32 s55, s50, s51
    s_cmp_lt_u32 s54, 56
    s_cselect_b32 s55, s55, 0x200000
    s_lshl_b32 s51, s44, 13
    s_add_u32 m0, s51, 33280
    s_nop 0
    buffer_load_dwordx4 v9, s[20:23], s55 offen nt lds
    s_add_u32 m0, m0, 1024
    s_add_u32 s55, s55, 57344
    buffer_load_dwordx4 v9, s[20:23], s55 offen nt lds
    s_add_u32 m0, m0, 1024
    s_add_u32 s55, s55, 57344
    s_waitcnt vmcnt(4)
    s_barrier
    ds_read_b128 v[160:163], v200 offset:0
    ds_read_b128 v[164:167], v200 offset:64
    ds_read_b128 v[168:171], v200 offset:128
    ds_read_b128 v[172:175], v200 offset:192
    ds_read_b128 v[176:179], v200 offset:256
    ds_read_b128 v[180:183], v200 offset:320
    s_mov_b32 s4, 0xaaaaaaaa
    s_mov_b32 s5, 0xaaaaaaaa
    s_mov_b32 s6, 0xcccccccc
    s_mov_b32 s7, 0xcccccccc
    v_mul_u32_u24 v216, 65, v5
    v_lshrrev_b32 v13, 3, v1
    v_lshl_add_u32 v216, v13, 2, v216
    s_lshl_b32 s50, s44, 5
    s_add_u32 s50, s50, 66048
    v_add_u32 v216, s50, v216
    s_mul_i32 s50, s44, 1040
    s_add_u32 s50, s50, 66048
    v_add_u32_e64 v217, s50, v2
    s_mov_b32 s8, 0x05040100
    s_mov_b32 s9, 0x07060302
    s_lshl_b32 s50, s48, 8
    s_lshl_b32 s51, s49, 7
    s_add_u32 s50, s50, s51
    s_add_u32 s50, s50, 86016
    v_lshl_add_u32 v219, v3, 3, s50
    v_lshrrev_b32 v13, 2, v3
    v_cmp_eq_u32 vcc, v13, v4
    v_lshlrev_b32 v13, 3, v0
    v_add_u32 v13, 86528, v13
    v_cndmask_b32 v219, v13, v219, vcc
    v_and_b32 v13, 1, v4
    v_lshlrev_b32_e64 v220, 8, v13
    v_lshl_add_u32 v220, v3, 3, v220
    v_add_u32 v220, 86016, v220
    s_mul_i32 s50, s44, 2304
    s_waitcnt lgkmcnt(4)
    v_mfma_f32_16x16x32_bf16 v[128:131], v[160:163], v[64:67], 0
    ds_read_b128 v[184:187], v200 offset:384
    buffer_load_dwordx4 v9, s[20:23], s55 offen nt lds
    v_mfma_f32_16x16x32_bf16 v[136:139], v[160:163], v[68:71], 0
    s_add_u32 m0, m0, 1024
    s_add_u32 s55, s55, 57344
    v_mfma_f32_16x16x32_bf16 v[212:215], v[160:163], v[160:163], 0
    buffer_load_dwordx4 v9, s[20:23], s55 offen nt lds
    s_add_u32 m0, m0, 1024
    v_mfma_f32_16x16x32_bf16 v[208:211], v[160:163], v[204:207], 0
    s_add_u32 s55, s55, 57344
    s_add_u32 s50, s50, 75776
    v_mfma_f32_16x16x32_bf16 v[128:131], v[164:167], v[72:75], v[128:131]
    ds_read_b128 v[188:191], v200 offset:448
    v_lshrrev_b32 v13, 3, v1
    v_mfma_f32_16x16x32_bf16 v[136:139], v[164:167], v[76:79], v[136:139]
    v_mul_u32_u24 v226, 144, v13
    v_add3_u32 v226, v226, v5, s50
    v_mfma_f32_16x16x32_bf16 v[212:215], v[164:167], v[164:167], v[212:215]
    v_mul_u32_u24 v227, 8448, v13
    v_add_u32_e64 v227, v227, v5
    v_mfma_f32_16x16x32_bf16 v[208:211], v[164:167], v[204:207], v[208:211]
    v_mul_u32_u24 v13, 144, v3
    s_waitcnt lgkmcnt(4)
    v_mfma_f32_16x16x32_bf16 v[128:131], v[168:171], v[80:83], v[128:131]
    ds_read_b128 v[160:163], v202 offset:0
    v_lshl_add_u32 v13, v4, 4, v13
    v_mfma_f32_16x16x32_bf16 v[136:139], v[168:171], v[84:87], v[136:139]
    s_lshl_b32 s51, s48, 6
    s_add_u32 s50, s50, s51
    v_mfma_f32_16x16x32_bf16 v[212:215], v[168:171], v[168:171], v[212:215]
    v_add_u32 v224, s50, v13
    s_xor_b32 s56, s51, 64
    v_mfma_f32_16x16x32_bf16 v[208:211], v[168:171], v[204:207], v[208:211]
    s_sub_u32 s56, s56, s51
    v_add_u32_e64 v225, s56, v224
    v_mfma_f32_16x16x32_bf16 v[128:131], v[172:175], v[88:91], v[128:131]
    ds_read_b128 v[164:167], v202 offset:64
    s_lshl_b32 s50, s44, 7
    v_mfma_f32_16x16x32_bf16 v[136:139], v[172:175], v[92:95], v[136:139]
    s_add_u32 s50, s50, 84992
    v_and_b32 v13, 31, v1
    v_mfma_f32_16x16x32_bf16 v[212:215], v[172:175], v[172:175], v[212:215]
    v_lshl_add_u32 v221, v13, 2, s50
    s_add_u32 s50, s50, s51
    v_mfma_f32_16x16x32_bf16 v[208:211], v[172:175], v[204:207], v[208:211]
    v_lshl_add_u32 v222, v4, 4, s50
    s_waitcnt lgkmcnt(4)
    v_mfma_f32_16x16x32_bf16 v[128:131], v[176:179], v[96:99], v[128:131]
    ds_read_b128 v[168:171], v202 offset:128
    v_xor_b32_e64 v223, 64, v222
    v_mfma_f32_16x16x32_bf16 v[136:139], v[176:179], v[100:103], v[136:139]
    s_mul_i32 s56, s46, 540672
    s_mul_i32 s50, s44, 67584
    v_mfma_f32_16x16x32_bf16 v[212:215], v[176:179], v[176:179], v[212:215]
    s_lshl_b32 s51, s47, 7
    s_add_u32 s56, s56, s50
    v_mfma_f32_16x16x32_bf16 v[208:211], v[176:179], v[204:207], v[208:211]
    s_add_u32 s56, s56, s51
    s_add_u32 s57, s56, s50
    v_mfma_f32_16x16x32_bf16 v[128:131], v[180:183], v[104:107], v[128:131]
    ds_read_b128 v[172:175], v202 offset:192
    s_add_u32 s57, s57, 1048576
    v_mfma_f32_16x16x32_bf16 v[136:139], v[180:183], v[108:111], v[136:139]
    s_add_u32 s56, s56, 3407872
    v_mfma_f32_16x16x32_bf16 v[212:215], v[180:183], v[180:183], v[212:215]
    s_lshl_b32 s50, s46, 13
    s_add_u32 s50, s50, 262144
    s_cmp_eq_u32 s44, 0
    s_cselect_b32 s52, s50, 294912
    s_cselect_b32 s59, -1, 0
    s_add_u32 s52, s52, s51
    v_mfma_f32_16x16x32_bf16 v[208:211], v[180:183], v[204:207], v[208:211]
    s_lshl_b32 s50, s46, 2
    s_add_u32 s50, s50, s44
    s_cmp_eq_u32 s50, 1
    s_cselect_b32 s59, -1, s59
    s_waitcnt lgkmcnt(4)
    v_mfma_f32_16x16x32_bf16 v[128:131], v[184:187], v[112:115], v[128:131]
    ds_read_b128 v[176:179], v202 offset:256
    v_and_b32 v196, 1, v193
    v_mfma_f32_16x16x32_bf16 v[136:139], v[184:187], v[116:119], v[136:139]
    v_lshlrev_b32_e64 v196, 31, v196
    v_mov_b32 v228, 0x3d800000
    v_mfma_f32_16x16x32_bf16 v[212:215], v[184:187], v[184:187], v[212:215]
    v_mov_b32 v13, 0x3d3504f3
    v_cmp_eq_u32 vcc, 0x100, v193
    v_mfma_f32_16x16x32_bf16 v[208:211], v[184:187], v[204:207], v[208:211]
    s_lshl_b32 s50, s49, 31
    v_and_b32 v12, s50, v196
    v_mfma_f32_16x16x32_bf16 v[128:131], v[188:191], v[120:123], v[128:131]
    ds_read_b128 v[180:183], v202 offset:320
    v_cndmask_b32_e64 v228, v228, v13, vcc
    v_mfma_f32_16x16x32_bf16 v[136:139], v[188:191], v[124:127], v[136:139]
    v_or_b32 v196, 1.0, v196
    v_xor_b32 v228, v228, v12
    v_mfma_f32_16x16x32_bf16 v[212:215], v[188:191], v[188:191], v[212:215]
    s_waitcnt vmcnt(4)
    v_perm_b32 v16, v28, v24, s8
    v_mfma_f32_16x16x32_bf16 v[208:211], v[188:191], v[204:207], v[208:211]
    v_perm_b32 v17, v28, v24, s9
    s_waitcnt lgkmcnt(4)
    v_mfma_f32_16x16x32_bf16 v[144:147], v[160:163], v[64:67], 0
    ds_read_b128 v[184:187], v202 offset:384
    v_perm_b32 v18, v29, v25, s8
    v_mfma_f32_16x16x32_bf16 v[152:155], v[160:163], v[68:71], 0
    v_perm_b32 v19, v29, v25, s9
    v_perm_b32 v20, v30, v26, s8
    v_mfma_f32_16x16x32_bf16 v[144:147], v[164:167], v[72:75], v[144:147]
    ds_read_b128 v[188:191], v202 offset:448
    v_perm_b32 v21, v30, v26, s9
    v_mfma_f32_16x16x32_bf16 v[152:155], v[164:167], v[76:79], v[152:155]
    v_perm_b32 v22, v31, v27, s8
    s_waitcnt lgkmcnt(4)
    v_mfma_f32_16x16x32_bf16 v[144:147], v[168:171], v[80:83], v[144:147]
    ds_read_b128 v[160:163], v201 offset:0
    v_perm_b32 v23, v31, v27, s9
    v_mfma_f32_16x16x32_bf16 v[152:155], v[168:171], v[84:87], v[152:155]
    ds_write_b32 v216, v16 offset:0
    ds_write_b32 v216, v17 offset:128
    v_mfma_f32_16x16x32_bf16 v[144:147], v[172:175], v[88:91], v[144:147]
    ds_read_b128 v[164:167], v203 offset:0
    ds_write_b32 v216, v18 offset:256
    v_mfma_f32_16x16x32_bf16 v[152:155], v[172:175], v[92:95], v[152:155]
    ds_write_b32 v216, v19 offset:384
    s_waitcnt lgkmcnt(8)
    v_mfma_f32_16x16x32_bf16 v[144:147], v[176:179], v[96:99], v[144:147]
    ds_read_b128 v[168:171], v201 offset:64
    ds_write_b32 v216, v20 offset:512
    v_mfma_f32_16x16x32_bf16 v[152:155], v[176:179], v[100:103], v[152:155]
    ds_write_b32 v216, v21 offset:640
    ds_write_b32 v216, v22 offset:768
    v_mfma_f32_16x16x32_bf16 v[144:147], v[180:183], v[104:107], v[144:147]
    ds_read_b128 v[172:175], v203 offset:64
    ds_write_b32 v216, v23 offset:896
    v_mfma_f32_16x16x32_bf16 v[152:155], v[180:183], v[108:111], v[152:155]
    v_cndmask_b32 v42, v208, v209, s[4:5]
    s_waitcnt lgkmcnt(12)
    v_mfma_f32_16x16x32_bf16 v[144:147], v[184:187], v[112:115], v[144:147]
    ds_read_b128 v[176:179], v201 offset:128
    v_cndmask_b32 v40, v210, v211, s[4:5]
    v_mfma_f32_16x16x32_bf16 v[152:155], v[184:187], v[116:119], v[152:155]
    v_cndmask_b32 v40, v42, v40, s[6:7]
    v_cndmask_b32 v42, v212, v213, s[4:5]
    v_mfma_f32_16x16x32_bf16 v[144:147], v[188:191], v[120:123], v[144:147]
    ds_read_b128 v[180:183], v203 offset:128
    v_cndmask_b32 v41, v214, v215, s[4:5]
    v_mfma_f32_16x16x32_bf16 v[152:155], v[188:191], v[124:127], v[152:155]
    v_cndmask_b32 v41, v42, v41, s[6:7]
    s_waitcnt lgkmcnt(10)
    v_mfma_f32_16x16x32_bf16 v[132:135], v[160:163], v[64:67], 0
    ds_read_b128 v[184:187], v201 offset:192
    v_mfma_f32_16x16x32_bf16 v[140:143], v[160:163], v[68:71], 0
    ds_write_b64 v219, v[40:41]
    v_mfma_f32_16x16x32_bf16 v[148:151], v[164:167], v[64:67], 0
    ds_read_b128 v[188:191], v203 offset:192
    v_mfma_f32_16x16x32_bf16 v[156:159], v[164:167], v[68:71], 0
    s_waitcnt lgkmcnt(1)
    s_barrier
    s_waitcnt lgkmcnt(6)
    v_mfma_f32_16x16x32_bf16 v[132:135], v[168:171], v[72:75], v[132:135]
    ds_read_b128 v[160:163], v201 offset:256
    v_mfma_f32_16x16x32_bf16 v[140:143], v[168:171], v[76:79], v[140:143]
    ds_read_b64 v[40:41], v220
    v_mfma_f32_16x16x32_bf16 v[148:151], v[172:175], v[72:75], v[148:151]
    ds_read_b128 v[164:167], v203 offset:256
    v_mfma_f32_16x16x32_bf16 v[156:159], v[172:175], v[76:79], v[156:159]
    ds_read_b64 v[42:43], v220 offset:128
    s_waitcnt lgkmcnt(7)
    v_mfma_f32_16x16x32_bf16 v[132:135], v[176:179], v[80:83], v[132:135]
    ds_read_b128 v[168:171], v201 offset:320
    v_mfma_f32_16x16x32_bf16 v[140:143], v[176:179], v[84:87], v[140:143]
    ds_read_b128 v[16:19], v217
    v_mfma_f32_16x16x32_bf16 v[148:151], v[180:183], v[80:83], v[148:151]
    ds_read_b128 v[172:175], v203 offset:320
    v_mfma_f32_16x16x32_bf16 v[156:159], v[180:183], v[84:87], v[156:159]
    ds_read_b128 v[20:23], v217 offset:4160
    s_waitcnt lgkmcnt(8)
    v_mfma_f32_16x16x32_bf16 v[132:135], v[184:187], v[88:91], v[132:135]
    ds_read_b128 v[176:179], v201 offset:384
    s_waitcnt lgkmcnt(5)
    v_mfma_f32_16x16x32_bf16 v[140:143], v[184:187], v[92:95], v[140:143]
    v_add_f32 v40, v40, v42
    v_add_f32 v42, v41, v43
    v_mfma_f32_16x16x32_bf16 v[148:151], v[188:191], v[88:91], v[148:151]
    ds_read_b128 v[180:183], v203 offset:384
    v_mul_f32 v40, 0x3b000000, v40
    v_mfma_f32_16x16x32_bf16 v[156:159], v[188:191], v[92:95], v[156:159]
    v_mul_f32 v42, 0x3b000000, v42
    s_waitcnt lgkmcnt(7)
    v_mfma_f32_16x16x32_bf16 v[132:135], v[160:163], v[96:99], v[132:135]
    ds_read_b128 v[184:187], v201 offset:448
    v_fma_f32 v42, -v40, v40, v42
    v_mfma_f32_16x16x32_bf16 v[140:143], v[160:163], v[100:103], v[140:143]
    v_max_f32 v42, 0, v42
    v_add_f32 v42, 0x3727c5ac, v42
    v_mfma_f32_16x16x32_bf16 v[148:151], v[164:167], v[96:99], v[148:151]
    ds_read_b128 v[188:191], v203 offset:448
    v_mfma_f32_16x16x32_bf16 v[156:159], v[164:167], v[100:103], v[156:159]
    v_rsq_f32 v41, v42
    s_waitcnt lgkmcnt(5)
    v_mfma_f32_16x16x32_bf16 v[132:135], v[168:171], v[104:107], v[132:135]
    v_sqrt_f32_e64 v43, v42
    v_mfma_f32_16x16x32_bf16 v[140:143], v[168:171], v[108:111], v[140:143]
    ds_write_b32 v221, v41
    s_add_u32 s50, s56, 270336
    v_mfma_f32_16x16x32_bf16 v[148:151], v[172:175], v[104:107], v[148:151]
    s_waitcnt lgkmcnt(5)
    v_mfma_f32_16x16x32_bf16 v[156:159], v[172:175], v[108:111], v[156:159]
    buffer_store_dwordx4 v[16:19], v227, s[40:43], s56 offen sc1
    s_waitcnt lgkmcnt(3)
    v_mfma_f32_16x16x32_bf16 v[132:135], v[176:179], v[112:115], v[132:135]
    buffer_store_dwordx4 v[20:23], v227, s[40:43], s50 offen sc1
    v_mfma_f32_16x16x32_bf16 v[140:143], v[176:179], v[116:119], v[140:143]
    s_waitcnt lgkmcnt(0)
    ds_read_b128 v[32:35], v222
    v_mfma_f32_16x16x32_bf16 v[148:151], v[180:183], v[112:115], v[148:151]
    ds_read_b128 v[36:39], v223
    v_mfma_f32_16x16x32_bf16 v[156:159], v[180:183], v[116:119], v[156:159]
    s_cmp_eq_u32 s44, 0
    s_cselect_b64 vcc, -1, 0
    s_waitcnt lgkmcnt(3)
    v_mfma_f32_16x16x32_bf16 v[132:135], v[184:187], v[120:123], v[132:135]
    v_lshlrev_b32 v44, 2, v1
    v_cndmask_b32 v40, v40, v43, vcc
    v_mfma_f32_16x16x32_bf16 v[140:143], v[184:187], v[124:127], v[140:143]
    s_mov_b32 exec_lo, s59
    s_mov_b32 exec_hi, 0
    buffer_store_dword v40, v44, s[40:43], s52 offen sc1
    s_mov_b64 exec, -1
    v_mfma_f32_16x16x32_bf16 v[148:151], v[188:191], v[120:123], v[148:151]
    s_add_u32 s49, s57, 67584
    s_waitcnt lgkmcnt(0)
    v_mfma_f32_16x16x32_bf16 v[156:159], v[188:191], v[124:127], v[156:159]
    v_mul_f32 v32, v32, v228
    v_mul_f32 v33, v33, v228
    v_mul_f32 v34, v34, v228
    v_mul_f32 v35, v35, v228
    v_mul_f32 v36, v36, v228
    v_mul_f32 v37, v37, v228
    v_mul_f32 v38, v38, v228
    v_mul_f32 v39, v39, v228
    v_pk_fma_f32 v[128:129], v[132:133], v[196:197], v[128:129] op_sel_hi:[1,0,1]
    v_pk_fma_f32 v[130:131], v[134:135], v[196:197], v[130:131] op_sel_hi:[1,0,1]
    v_pk_fma_f32 v[136:137], v[140:141], v[196:197], v[136:137] op_sel_hi:[1,0,1]
    v_pk_fma_f32 v[138:139], v[142:143], v[196:197], v[138:139] op_sel_hi:[1,0,1]
    v_pk_mul_f32 v[128:129], v[128:129], v[32:33]
    v_pk_mul_f32 v[130:131], v[130:131], v[34:35]
    v_pk_mul_f32 v[136:137], v[136:137], v[32:33]
    v_pk_mul_f32 v[138:139], v[138:139], v[34:35]
    v_cvt_pk_bf16_f32 v160, v128, v136
    v_cvt_pk_bf16_f32 v161, v129, v137
    v_cvt_pk_bf16_f32 v162, v130, v138
    v_cvt_pk_bf16_f32 v163, v131, v139
    ds_write_b128 v224, v[160:163]
    v_pk_fma_f32 v[144:145], v[148:149], v[196:197], v[144:145] op_sel_hi:[1,0,1]
    v_pk_fma_f32 v[146:147], v[150:151], v[196:197], v[146:147] op_sel_hi:[1,0,1]
    v_pk_fma_f32 v[152:153], v[156:157], v[196:197], v[152:153] op_sel_hi:[1,0,1]
    v_pk_fma_f32 v[154:155], v[158:159], v[196:197], v[154:155] op_sel_hi:[1,0,1]
    v_pk_mul_f32 v[144:145], v[144:145], v[36:37]
    v_pk_mul_f32 v[146:147], v[146:147], v[38:39]
    v_pk_mul_f32 v[152:153], v[152:153], v[36:37]
    v_pk_mul_f32 v[154:155], v[154:155], v[38:39]
    v_cvt_pk_bf16_f32 v164, v144, v152
    v_cvt_pk_bf16_f32 v165, v145, v153
    v_cvt_pk_bf16_f32 v166, v146, v154
    v_cvt_pk_bf16_f32 v167, v147, v155
    ds_write_b128 v225, v[164:167]
    s_waitcnt lgkmcnt(0)
    ds_read_b128 v[168:171], v226
    ds_read_b128 v[172:175], v226 offset:1152
    s_waitcnt lgkmcnt(1)
    buffer_store_dwordx4 v[168:171], v227, s[40:43], s57 offen sc1
    s_waitcnt lgkmcnt(0)
    buffer_store_dwordx4 v[172:175], v227, s[40:43], s49 offen sc1
    s_mov_b32 s26, 8388608
    s_mov_b32 s27, 0x20000
    s_and_b32 s65, s2, 1
    s_lshl_b32 s65, s65, 2
    s_or_b32 s65, s65, s46
    s_bfe_u32 s64, s2, 0x20001
    s_lshl_b32 s64, s64, 3
    s_lshr_b32 s50, s2, 5
    s_or_b32 s64, s64, s50
    s_lshl_b32 s61, s64, 18
    s_lshl_b32 s50, s44, 10
    s_add_u32 s61, s61, s50
    v_lshrrev_b32_e64 v13, 5, v1
    v_mul_u32_u24 v13, 32896, v13
    v_and_b32 v187, 31, v1
    v_lshlrev_b32 v187, 4, v187
    v_xor_b32 v187, v187, v13
    s_lshl_b32 s51, s44, 13
    s_add_u32 m0, s51, 37376
    s_nop 0
    buffer_load_dwordx4 v9, s[20:23], s55 offen nt lds
    s_add_u32 m0, m0, 1024
    s_add_u32 s55, s55, 57344
    buffer_load_dwordx4 v9, s[20:23], s55 offen nt lds
    s_add_u32 m0, m0, 1024
    s_add_u32 s55, s55, 57344
    buffer_load_dwordx4 v9, s[20:23], s55 offen nt lds
    s_add_u32 m0, m0, 1024
    s_add_u32 s55, s55, 57344
    buffer_load_dwordx4 v9, s[20:23], s55 offen nt lds
    s_mul_i32 s45, s45, 0x9e3779b1
    s_add_u32 s45, s45, 0x7f4a7c15
    s_mov_b32 s30, 4096
    s_mov_b32 s31, 0x20000
    s_mov_b32 s34, 917504
    s_mov_b32 s35, 0x20000
    s_mov_b32 s38, 2097152
    s_mov_b32 s39, 0x20000
    v_bfe_u32 v8, v1, 2, 2
    v_lshl_add_u32 v8, v4, 3, v8
    v_lshlrev_b32 v8, 6, v8
    v_and_b32_e64 v9, 1, v4
    v_lshl_add_u32 v8, v9, 5, v8
    v_and_b32_e64 v9, 3, v1
    v_lshl_add_u32 v8, v9, 3, v8
    v_add_u32 v184, 33280, v8
    v_xor_b32_e64 v185, 32, v8
    v_add_u32 v185, 33280, v185
    v_and_b32_e64 v254, 7, v3
    v_mul_u32_u24 v254, 1040, v254
    v_lshrrev_b32_e64 v9, 3, v3
    v_mul_u32_u24 v9, 640, v9
    v_lshl_add_u32 v9, v4, 4, v9
    s_mul_i32 s62, s44, 16640
    s_add_u32 s62, s62, 97280
    v_xor_b32 v255, 128, v9
    v_add3_u32 v255, v255, v254, s62
    v_add3_u32 v254, v9, v254, s62
    s_lshl_b32 s49, s46, 2
    s_add_u32 s49, s49, s44
    s_cmp_eq_u32 s49, 15
    s_cselect_b32 s50, 3, 4
    v_mov_b32_e64 v186, 1.0
    v_mov_b32 v9, 0x3f3504f3
    v_cmp_eq_u32 vcc, s50, v4
    s_lshl_b32 s56, s54, 15
    s_lshl_b32 s49, s49, 10
    s_add_u32 s56, s56, s49
    v_cndmask_b32_e64 v186, v186, v9, vcc
    s_add_u32 s56, s56, 8126464
    s_cmp_lt_u32 s54, 56
    s_cselect_b32 s56, s56, 24117248
    s_add_u32 s57, s56, 16384
    s_lshr_b32 s49, s2, 6
    s_lshl_b32 s50, s49, 3
    v_and_b32 v244, 7, v1
    v_lshrrev_b32_e64 v236, 3, v1
    v_lshl_add_u32 v244, v236, 5, v244
    v_add_u32 v244, s50, v244
    v_lshlrev_b32 v244, 7, v244
    v_add_u32 v244, 65536, v244
    s_lshl_b32 s18, s44, 4
    v_add_u32 v228, s18, v3
    v_cvt_f32_u32 v228, v228
    v_lshlrev_b32 v229, 2, v4
    v_cvt_f32_u32_e64 v229, v229
    v_mul_f32 v230, 0x3a000000, v228
    v_mul_f32_e64 v231, v230, v229
    v_fmamk_f32 v188, v230, 0x00000000, v231
    v_fmamk_f32 v189, v230, 0x3f800000, v231
    v_fmamk_f32 v190, v230, 0x40000000, v231
    v_fmamk_f32 v191, v230, 0x40400000, v231
    v_fmamk_f32 v192, v230, 0x41800000, v231
    v_fmamk_f32 v193, v230, 0x41880000, v231
    v_fmamk_f32 v194, v230, 0x41900000, v231
    v_fmamk_f32 v195, v230, 0x41980000, v231
    v_sin_f32 v196, v188
    v_cos_f32 v188, v188
    v_sin_f32 v197, v189
    v_cos_f32 v189, v189
    v_sin_f32 v198, v190
    v_cos_f32 v190, v190
    v_sin_f32 v199, v191
    v_cos_f32 v191, v191
    v_sin_f32 v200, v192
    v_cos_f32 v192, v192
    v_sin_f32 v201, v193
    v_cos_f32 v193, v193
    v_sin_f32 v202, v194
    v_cos_f32 v194, v194
    v_sin_f32 v203, v195
    v_cos_f32 v195, v195
    v_or_b32 v236, 0, v4
    v_xor_b32 v236, v236, v3
    v_lshlrev_b32_e64 v236, 4, v236
    v_lshl_add_u32 v250, v3, 8, v236
    v_or_b32 v236, 4, v4
    v_xor_b32 v236, v236, v3
    v_lshlrev_b32_e64 v236, 4, v236
    v_lshl_add_u32 v251, v3, 8, v236
    v_or_b32 v236, 8, v4
    v_xor_b32 v236, v236, v3
    v_lshlrev_b32_e64 v236, 4, v236
    v_lshl_add_u32 v252, v3, 8, v236
    v_or_b32 v236, 12, v4
    v_xor_b32 v236, v236, v3
    v_lshlrev_b32_e64 v236, 4, v236
    v_lshl_add_u32 v253, v3, 8, v236
    v_lshl_add_u32 v236, s44, 3, v4
    v_add_u32 v236, 0, v236
    v_xor_b32 v237, v236, v3
    v_and_b32 v237, 15, v237
    v_lshlrev_b32 v237, 4, v237
    v_lshl_add_u32 v248, v236, 8, v237
    v_lshl_add_u32 v236, s44, 3, v4
    v_add_u32 v236, 4, v236
    v_xor_b32 v237, v236, v3
    v_and_b32 v237, 15, v237
    v_lshlrev_b32 v237, 4, v237
    v_lshl_add_u32 v249, v236, 8, v237
    v_mul_f32 v230, 0x3c800000, v228
    v_mul_f32 v231, v230, v229
    v_and_b32 v234, 1, v3
    v_mul_u32_u24 v234, 0x8000, v234
    v_lshl_or_b32 v234, v234, 16, v234
    v_fmamk_f32 v236, v230, 0x00000000, v231
    v_fmamk_f32 v237, v230, 0x3f800000, v231
    v_fmamk_f32 v238, v230, 0x40000000, v231
    v_fmamk_f32 v239, v230, 0x40400000, v231
    v_sin_f32 v240, v236
    v_cos_f32 v236, v236
    v_sin_f32 v241, v237
    v_cos_f32 v237, v237
    v_sin_f32 v242, v238
    v_cos_f32 v238, v238
    v_sin_f32 v243, v239
    v_cos_f32 v239, v239
    v_cvt_pk_bf16_f32 v8, v236, v240
    v_cvt_pk_bf16_f32 v24, -v240, v236
    v_cvt_pk_bf16_f32 v9, v237, v241
    v_cvt_pk_bf16_f32 v25, -v241, v237
    v_cvt_pk_bf16_f32 v10, v238, v242
    v_cvt_pk_bf16_f32 v26, -v242, v238
    v_cvt_pk_bf16_f32 v11, v239, v243
    v_cvt_pk_bf16_f32 v27, -v243, v239
    v_fmamk_f32 v236, v230, 0x41800000, v231
    v_fmamk_f32 v237, v230, 0x41880000, v231
    v_fmamk_f32 v238, v230, 0x41900000, v231
    v_fmamk_f32 v239, v230, 0x41980000, v231
    v_sin_f32 v240, v236
    v_cos_f32 v236, v236
    v_sin_f32 v241, v237
    v_cos_f32 v237, v237
    v_sin_f32 v242, v238
    v_cos_f32 v238, v238
    v_sin_f32 v243, v239
    v_cos_f32 v239, v239
    v_cvt_pk_bf16_f32 v12, v236, v240
    v_cvt_pk_bf16_f32 v28, -v240, v236
    v_cvt_pk_bf16_f32 v13, v237, v241
    v_cvt_pk_bf16_f32 v29, -v241, v237
    v_cvt_pk_bf16_f32 v14, v238, v242
    v_cvt_pk_bf16_f32 v30, -v242, v238
    v_cvt_pk_bf16_f32 v15, v239, v243
    v_cvt_pk_bf16_f32 v31, -v243, v239
    v_xor_b32 v16, v8, v234
    v_xor_b32 v17, v9, v234
    v_xor_b32 v18, v10, v234
    v_xor_b32 v19, v11, v234
    v_xor_b32 v20, v12, v234
    v_xor_b32 v21, v13, v234
    v_xor_b32 v22, v14, v234
    v_xor_b32 v23, v15, v234
    s_waitcnt vmcnt(4)
    s_waitcnt lgkmcnt(0)
    s_barrier
    s_cmp_eq_u32 s44, 0
    s_cbranch_scc0 L_nf_2
    s_lshl_b32 s48, s2, 7
    s_add_u32 s48, s48, 65536
    v_mov_b32 v6, s45
    v_mov_b32 v7, 0
    s_mov_b64 exec, 1
    buffer_store_dword v6, v7, s[40:43], s48 offen sc1
    s_mov_b64 exec, -1
L_nf_2:
    ds_read_b64_tr_b16 v[160:161], v184 offset:0
    ds_read_b64_tr_b16 v[162:163], v184 offset:256
    ds_read_b64_tr_b16 v[164:165], v185 offset:0
    ds_read_b64_tr_b16 v[166:167], v185 offset:256
    ds_read_b64_tr_b16 v[168:169], v184 offset:2048
    ds_read_b64_tr_b16 v[170:171], v184 offset:2304
    ds_read_b64_tr_b16 v[172:173], v185 offset:2048
    ds_read_b64_tr_b16 v[174:175], v185 offset:2304
    s_waitcnt lgkmcnt(4)
    v_mfma_f32_16x16x32_bf16 v[128:131], v[64:67], v[160:163], 0
    ds_read_b64_tr_b16 v[176:177], v184 offset:8192
    s_mul_i32 s69, s44, 16640
    v_mfma_f32_16x16x32_bf16 v[144:147], v[68:71], v[160:163], 0
    ds_read_b64_tr_b16 v[178:179], v184 offset:8448
    s_add_u32 s69, s69, 97280
    v_mfma_f32_16x16x32_bf16 v[136:139], v[64:67], v[164:167], 0
    ds_read_b64_tr_b16 v[180:181], v185 offset:8192
    s_mov_b32 m0, s69
    v_mfma_f32_16x16x32_bf16 v[152:155], v[68:71], v[164:167], 0
    ds_read_b64_tr_b16 v[182:183], v185 offset:8448
    s_waitcnt lgkmcnt(4)
    v_mfma_f32_16x16x32_bf16 v[128:131], v[72:75], v[168:171], v[128:131]
    ds_read_b64_tr_b16 v[160:161], v184 offset:10240
    s_add_u32 s69, s44, 0
    v_mfma_f32_16x16x32_bf16 v[144:147], v[76:79], v[168:171], v[144:147]
    ds_read_b64_tr_b16 v[162:163], v184 offset:10496
    s_and_b32 s69, s69, 3
    v_mfma_f32_16x16x32_bf16 v[136:139], v[72:75], v[172:175], v[136:139]
    ds_read_b64_tr_b16 v[164:165], v185 offset:10240
    s_lshl_b32 s69, s69, 16
    v_mfma_f32_16x16x32_bf16 v[152:155], v[76:79], v[172:175], v[152:155]
    ds_read_b64_tr_b16 v[166:167], v185 offset:10496
    s_waitcnt lgkmcnt(4)
    v_mfma_f32_16x16x32_bf16 v[128:131], v[96:99], v[176:179], v[128:131]
    ds_read_b64_tr_b16 v[168:169], v184 offset:16384
    s_add_u32 s69, s69, s61
    v_mfma_f32_16x16x32_bf16 v[144:147], v[100:103], v[176:179], v[144:147]
    ds_read_b64_tr_b16 v[170:171], v184 offset:16640
    buffer_load_dwordx4 v187, s[24:27], s69 offen lds
    v_mfma_f32_16x16x32_bf16 v[136:139], v[96:99], v[180:183], v[136:139]
    ds_read_b64_tr_b16 v[172:173], v185 offset:16384
    s_add_u32 m0, m0, 1040
    v_mfma_f32_16x16x32_bf16 v[152:155], v[100:103], v[180:183], v[152:155]
    ds_read_b64_tr_b16 v[174:175], v185 offset:16640
    s_waitcnt lgkmcnt(4)
    v_mfma_f32_16x16x32_bf16 v[128:131], v[104:107], v[160:163], v[128:131]
    ds_read_b64_tr_b16 v[176:177], v184 offset:18432
    s_add_u32 s69, s69, 4096
    v_mfma_f32_16x16x32_bf16 v[144:147], v[108:111], v[160:163], v[144:147]
    ds_read_b64_tr_b16 v[178:179], v184 offset:18688
    v_xor_b32 v32, v24, v234
    v_mfma_f32_16x16x32_bf16 v[136:139], v[104:107], v[164:167], v[136:139]
    ds_read_b64_tr_b16 v[180:181], v185 offset:18432
    buffer_load_dwordx4 v187, s[24:27], s69 offen lds
    v_mfma_f32_16x16x32_bf16 v[152:155], v[108:111], v[164:167], v[152:155]
    ds_read_b64_tr_b16 v[182:183], v185 offset:18688
    s_waitcnt lgkmcnt(4)
    v_mfma_f32_16x16x32_bf16 v[132:135], v[64:67], v[168:171], 0
    ds_read_b64_tr_b16 v[160:161], v184 offset:24576
    s_add_u32 m0, m0, 1040
    v_mfma_f32_16x16x32_bf16 v[148:151], v[68:71], v[168:171], 0
    ds_read_b64_tr_b16 v[162:163], v184 offset:24832
    s_add_u32 s69, s69, 4096
    v_mfma_f32_16x16x32_bf16 v[140:143], v[64:67], v[172:175], 0
    ds_read_b64_tr_b16 v[164:165], v185 offset:24576
    v_xor_b32 v33, v25, v234
    v_mfma_f32_16x16x32_bf16 v[156:159], v[68:71], v[172:175], 0
    ds_read_b64_tr_b16 v[166:167], v185 offset:24832
    s_waitcnt lgkmcnt(4)
    v_mfma_f32_16x16x32_bf16 v[132:135], v[72:75], v[176:179], v[132:135]
    ds_read_b64_tr_b16 v[168:169], v184 offset:26624
    buffer_load_dwordx4 v187, s[24:27], s69 offen lds
    v_mfma_f32_16x16x32_bf16 v[148:151], v[76:79], v[176:179], v[148:151]
    ds_read_b64_tr_b16 v[170:171], v184 offset:26880
    s_add_u32 m0, m0, 1040
    v_mfma_f32_16x16x32_bf16 v[140:143], v[72:75], v[180:183], v[140:143]
    ds_read_b64_tr_b16 v[172:173], v185 offset:26624
    s_add_u32 s69, s69, 4096
    v_mfma_f32_16x16x32_bf16 v[156:159], v[76:79], v[180:183], v[156:159]
    ds_read_b64_tr_b16 v[174:175], v185 offset:26880
    s_waitcnt vmcnt(3)
    s_barrier
    s_waitcnt lgkmcnt(4)
    v_mfma_f32_16x16x32_bf16 v[132:135], v[96:99], v[160:163], v[132:135]
    ds_read_b64_tr_b16 v[176:177], v184 offset:4096
    v_xor_b32_e64 v34, v26, v234
    v_mfma_f32_16x16x32_bf16 v[148:151], v[100:103], v[160:163], v[148:151]
    ds_read_b64_tr_b16 v[178:179], v184 offset:4352
    buffer_load_dwordx4 v187, s[24:27], s69 offen lds
    v_mfma_f32_16x16x32_bf16 v[140:143], v[96:99], v[164:167], v[140:143]
    ds_read_b64_tr_b16 v[180:181], v185 offset:4096
    s_add_u32 m0, m0, 1040
    v_mfma_f32_16x16x32_bf16 v[156:159], v[100:103], v[164:167], v[156:159]
    ds_read_b64_tr_b16 v[182:183], v185 offset:4352
    s_waitcnt lgkmcnt(4)
    v_mfma_f32_16x16x32_bf16 v[132:135], v[104:107], v[168:171], v[132:135]
    ds_read_b64_tr_b16 v[160:161], v184 offset:6144
    s_add_u32 s69, s69, 4096
    v_mfma_f32_16x16x32_bf16 v[148:151], v[108:111], v[168:171], v[148:151]
    ds_read_b64_tr_b16 v[162:163], v184 offset:6400
    v_xor_b32 v35, v27, v234
    v_mfma_f32_16x16x32_bf16 v[140:143], v[104:107], v[172:175], v[140:143]
    ds_read_b64_tr_b16 v[164:165], v185 offset:6144
    buffer_load_dwordx4 v187, s[24:27], s69 offen lds
    v_mfma_f32_16x16x32_bf16 v[156:159], v[108:111], v[172:175], v[156:159]
    ds_read_b64_tr_b16 v[166:167], v185 offset:6400
    s_waitcnt lgkmcnt(4)
    v_mfma_f32_16x16x32_bf16 v[128:131], v[80:83], v[176:179], v[128:131]
    ds_read_b64_tr_b16 v[168:169], v184 offset:12288
    s_add_u32 m0, m0, 1040
    v_mfma_f32_16x16x32_bf16 v[144:147], v[84:87], v[176:179], v[144:147]
    ds_read_b64_tr_b16 v[170:171], v184 offset:12544
    s_add_u32 s69, s69, 4096
    v_mfma_f32_16x16x32_bf16 v[136:139], v[80:83], v[180:183], v[136:139]
    ds_read_b64_tr_b16 v[172:173], v185 offset:12288
    v_xor_b32 v36, v28, v234
    v_mfma_f32_16x16x32_bf16 v[152:155], v[84:87], v[180:183], v[152:155]
    ds_read_b64_tr_b16 v[174:175], v185 offset:12544
    s_waitcnt lgkmcnt(4)
    v_mfma_f32_16x16x32_bf16 v[128:131], v[88:91], v[160:163], v[128:131]
    ds_read_b64_tr_b16 v[176:177], v184 offset:14336
    buffer_load_dwordx4 v187, s[24:27], s69 offen lds
    v_mfma_f32_16x16x32_bf16 v[144:147], v[92:95], v[160:163], v[144:147]
    ds_read_b64_tr_b16 v[178:179], v184 offset:14592
    s_add_u32 m0, m0, 1040
    v_mfma_f32_16x16x32_bf16 v[136:139], v[88:91], v[164:167], v[136:139]
    ds_read_b64_tr_b16 v[180:181], v185 offset:14336
    s_add_u32 s69, s69, 4096
    v_mfma_f32_16x16x32_bf16 v[152:155], v[92:95], v[164:167], v[152:155]
    ds_read_b64_tr_b16 v[182:183], v185 offset:14592
    s_waitcnt lgkmcnt(4)
    v_mfma_f32_16x16x32_bf16 v[128:131], v[112:115], v[168:171], v[128:131]
    ds_read_b64_tr_b16 v[160:161], v184 offset:20480
    v_xor_b32_e64 v37, v29, v234
    v_mfma_f32_16x16x32_bf16 v[144:147], v[116:119], v[168:171], v[144:147]
    ds_read_b64_tr_b16 v[162:163], v184 offset:20736
    buffer_load_dwordx4 v187, s[24:27], s69 offen lds
    v_mfma_f32_16x16x32_bf16 v[136:139], v[112:115], v[172:175], v[136:139]
    ds_read_b64_tr_b16 v[164:165], v185 offset:20480
    s_add_u32 m0, m0, 1040
    v_mfma_f32_16x16x32_bf16 v[152:155], v[116:119], v[172:175], v[152:155]
    ds_read_b64_tr_b16 v[166:167], v185 offset:20736
    s_waitcnt lgkmcnt(4)
    v_mfma_f32_16x16x32_bf16 v[128:131], v[120:123], v[176:179], v[128:131]
    ds_read_b64_tr_b16 v[168:169], v184 offset:22528
    s_add_u32 s69, s69, 4096
    v_mfma_f32_16x16x32_bf16 v[144:147], v[124:127], v[176:179], v[144:147]
    ds_read_b64_tr_b16 v[170:171], v184 offset:22784
    v_xor_b32 v38, v30, v234
    v_mfma_f32_16x16x32_bf16 v[136:139], v[120:123], v[180:183], v[136:139]
    ds_read_b64_tr_b16 v[172:173], v185 offset:22528
    buffer_load_dwordx4 v187, s[24:27], s69 offen lds
    v_mfma_f32_16x16x32_bf16 v[152:155], v[124:127], v[180:183], v[152:155]
    ds_read_b64_tr_b16 v[174:175], v185 offset:22784
    s_waitcnt lgkmcnt(4)
    v_mfma_f32_16x16x32_bf16 v[132:135], v[80:83], v[160:163], v[132:135]
    ds_read_b64_tr_b16 v[176:177], v184 offset:28672
    v_xor_b32 v39, v31, v234
    v_mfma_f32_16x16x32_bf16 v[148:151], v[84:87], v[160:163], v[148:151]
    ds_read_b64_tr_b16 v[178:179], v184 offset:28928
    s_lshr_b32 s49, s2, 6
    v_mfma_f32_16x16x32_bf16 v[140:143], v[80:83], v[164:167], v[140:143]
    ds_read_b64_tr_b16 v[180:181], v185 offset:28672
    s_lshl_b32 s50, s44, 2
    v_mfma_f32_16x16x32_bf16 v[156:159], v[84:87], v[164:167], v[156:159]
    ds_read_b64_tr_b16 v[182:183], v185 offset:28928
    s_waitcnt lgkmcnt(4)
    v_mfma_f32_16x16x32_bf16 v[132:135], v[88:91], v[168:171], v[132:135]
    ds_read_b64_tr_b16 v[160:161], v184 offset:30720
    v_or_b32 v236, s50, v4
    v_mfma_f32_16x16x32_bf16 v[148:151], v[92:95], v[168:171], v[148:151]
    ds_read_b64_tr_b16 v[162:163], v184 offset:30976
    v_xor_b32_e64 v236, v236, v3
    v_mfma_f32_16x16x32_bf16 v[140:143], v[88:91], v[172:175], v[140:143]
    ds_read_b64_tr_b16 v[164:165], v185 offset:30720
    v_lshlrev_b32_e64 v236, 4, v236
    v_mfma_f32_16x16x32_bf16 v[156:159], v[92:95], v[172:175], v[156:159]
    ds_read_b64_tr_b16 v[166:167], v185 offset:30976
    s_waitcnt lgkmcnt(4)
    v_mfma_f32_16x16x32_bf16 v[132:135], v[112:115], v[176:179], v[132:135]
    v_lshl_add_u32 v245, v3, 8, v236
    s_mul_i32 s15, s2, 8448
    v_mfma_f32_16x16x32_bf16 v[148:151], v[116:119], v[176:179], v[148:151]
    s_lshl_b32 s50, s44, 11
    s_add_u32 s12, s15, s50
    v_mfma_f32_16x16x32_bf16 v[140:143], v[112:115], v[180:183], v[140:143]
    s_add_u32 s12, s12, 1048576
    s_lshl_b32 s50, s44, 8
    v_mfma_f32_16x16x32_bf16 v[156:159], v[116:119], v[180:183], v[156:159]
    s_add_u32 s13, s15, s50
    s_waitcnt lgkmcnt(0)
    v_mfma_f32_16x16x32_bf16 v[132:135], v[120:123], v[160:163], v[132:135]
    s_add_u32 s13, s13, 3407872
    s_add_u32 s19, s13, 4096
    v_mfma_f32_16x16x32_bf16 v[148:151], v[124:127], v[160:163], v[148:151]
    s_lshl_b32 s14, s49, 13
    s_lshl_b32 s49, s44, 6
    v_mfma_f32_16x16x32_bf16 v[140:143], v[120:123], v[164:167], v[140:143]
    s_add_u32 s14, s14, s49
    s_add_u32 s14, s14, 262144
    v_mfma_f32_16x16x32_bf16 v[156:159], v[124:127], v[164:167], v[156:159]
    s_add_u32 s17, s14, 4096
    s_lshl_b32 s15, s2, 9
    s_lshl_b32 s49, s44, 19
    s_add_u32 s15, s15, s49
    s_add_u32 s15, s15, 5767168
    s_lshl_b32 s49, s44, 10
    v_lshlrev_b32 v5, 17, v4
    v_lshl_add_u32 v5, v3, 4, v5
    s_cmp_eq_u32 s2, 255
    s_cselect_b32 s16, 0, -1
    v_lshlrev_b32 v246, 10, v4
    v_lshl_add_u32 v246, v3, 2, v246
    v_pk_add_f32 v[128:129], v[128:129], v[132:133] neg_lo:[0,1]
    v_pk_add_f32 v[130:131], v[130:131], v[134:135] neg_lo:[0,1]
    v_pk_add_f32 v[144:145], v[144:145], v[148:149] neg_lo:[0,1]
    v_pk_add_f32 v[146:147], v[146:147], v[150:151] neg_lo:[0,1]
    v_mul_f32_e64 v131, v131, v186
    v_cvt_pk_bf16_f32 v160, v128, v129
    v_cvt_pk_bf16_f32 v161, v130, v131
    v_cvt_pk_bf16_f32 v162, v144, v145
    v_cvt_pk_bf16_f32 v163, v146, v147
    buffer_store_dwordx4 v[160:163], v2, s[40:43], s56 offen sc1
    v_pk_add_f32 v[136:137], v[136:137], v[140:141] neg_lo:[0,1]
    v_pk_add_f32 v[138:139], v[138:139], v[142:143] neg_lo:[0,1]
    v_pk_add_f32 v[152:153], v[152:153], v[156:157] neg_lo:[0,1]
    v_pk_add_f32 v[154:155], v[154:155], v[158:159] neg_lo:[0,1]
    v_mul_f32_e64 v139, v139, v186
    v_cvt_pk_bf16_f32 v164, v136, v137
    v_cvt_pk_bf16_f32 v165, v138, v139
    v_cvt_pk_bf16_f32 v166, v152, v153
    v_cvt_pk_bf16_f32 v167, v154, v155
    buffer_store_dwordx4 v[164:167], v2, s[40:43], s57 offen sc1
    buffer_load_dword v94, v244, s[40:43], 0 offen sc1
    s_and_b32 s66, s2, 3
    s_lshl_b32 s66, s66, 2
    s_or_b32 s66, s66, s46
    s_bfe_u32 s67, s2, 0x10002
    s_lshl_b32 s67, s67, 3
    s_lshr_b32 s48, s2, 5
    s_or_b32 s67, s67, s48
    s_and_b32 s3, s2, 31
    s_lshr_b32 s60, s2, 5
    s_lshr_b32 s68, s67, 1
    s_mul_i32 s68, s68, 7
    s_and_b32 s23, s67, 1
    s_lshl_b32 s23, s23, 2
    s_add_u32 s48, s23, 56
    s_mul_i32 s49, s23, 14
    s_sub_u32 s49, 56, s49
    s_sub_u32 s50, s23, 4
    v_lshrrev_b32 v88, 2, v1
    v_min_u32 v88, 6, v88
    v_mov_b32 v95, s50
    v_mov_b32 v89, s49
    v_cmp_eq_u32 vcc, 3, v88
    s_nop 1
    v_cndmask_b32 v95, v95, v89, vcc
    v_mov_b32 v89, s48
    v_cmp_gt_u32 vcc, 3, v88
    s_nop 1
    v_cndmask_b32_e64 v95, v95, v89, vcc
    v_add3_u32 v88, v88, v95, s68
    v_lshrrev_b32 v88, 1, v88
    v_and_b32 v95, 7, v88
    v_lshrrev_b32_e64 v88, 3, v88
    v_lshl_add_u32 v95, v95, 5, v88
    v_and_b32_e64 v88, 3, v1
    v_lshl_add_u32 v95, v88, 3, v95
    v_lshlrev_b32_e64 v95, 7, v95
    v_add_u32 v95, 98304, v95
    s_add_u32 s8, s68, s48
    s_add_u32 s8, s8, 0
    s_lshl_b32 s8, s8, 14
    s_add_u32 s8, s8, 8126464
    s_add_u32 s9, s68, s48
    s_add_u32 s9, s9, 1
    s_lshl_b32 s9, s9, 14
    s_add_u32 s9, s9, 8126464
    s_add_u32 s10, s68, s48
    s_add_u32 s10, s10, 2
    s_lshl_b32 s10, s10, 14
    s_add_u32 s10, s10, 8126464
    s_add_u32 s11, s68, s49
    s_add_u32 s11, s11, 3
    s_lshl_b32 s11, s11, 14
    s_add_u32 s11, s11, 8126464
    s_add_u32 s20, s68, s50
    s_add_u32 s20, s20, 4
    s_lshl_b32 s20, s20, 14
    s_add_u32 s20, s20, 8126464
    s_add_u32 s21, s68, s50
    s_add_u32 s21, s21, 5
    s_lshl_b32 s21, s21, 14
    s_add_u32 s21, s21, 8126464
    s_add_u32 s22, s68, s50
    s_add_u32 s22, s22, 6
    s_lshl_b32 s22, s22, 14
    s_add_u32 s22, s22, 8126464
    v_lshlrev_b32 v233, 2, v4
    v_sub_u32_e64 v233, v3, v233
    v_mov_b32 v235, 0x3f80
    v_cvt_f32_u32 v232, v3
    v_cmp_eq_u32 vcc, 0, v233
    v_mul_f32 v230, 0x3d000000, v232
    v_mul_f32 v231, v230, v229
    v_cndmask_b32 v220, 0, v235, vcc
    v_fmamk_f32 v236, v230, 0x00000000, v231
    v_lshlrev_b32 v224, 16, v220
    v_cmp_eq_u32 vcc, 1, v233
    v_mul_f32 v230, 0x3d000000, v232
    v_mul_f32 v231, v230, v229
    v_cndmask_b32 v221, 0, v235, vcc
    v_fmamk_f32 v237, v230, 0x3f800000, v231
    v_lshlrev_b32 v225, 16, v221
    v_cmp_eq_u32 vcc, 2, v233
    v_mul_f32 v230, 0x3d000000, v232
    v_mul_f32 v231, v230, v229
    v_cndmask_b32 v222, 0, v235, vcc
    v_fmamk_f32 v238, v230, 0x40000000, v231
    v_lshlrev_b32 v226, 16, v222
    v_cmp_eq_u32 vcc, 3, v233
    v_mul_f32 v230, 0x3d000000, v232
    v_mul_f32 v231, v230, v229
    v_cndmask_b32 v223, 0, v235, vcc
    v_fmamk_f32 v239, v230, 0x40400000, v231
    v_lshlrev_b32 v227, 16, v223
    v_sin_f32 v240, v236
    v_cos_f32 v236, v236
    s_waitcnt vmcnt(0)
    v_cmp_ne_u32 vcc, s45, v94
    s_nop 0
    s_cbranch_vccnz L_slow_3
L_back_4:
    buffer_load_dwordx4 v[64:67], v2, s[40:43], s12 offen sc1
    buffer_load_dwordx4 v[68:71], v2, s[40:43], s12 offen offset:1024 sc1
    v_lshlrev_b32 v90, 10, v4
    v_lshl_add_u32 v90, v3, 4, v90
    buffer_load_dwordx4 v[72:75], v90, s[40:43], s13 offen sc1
    buffer_load_dwordx4 v[76:79], v90, s[40:43], s19 offen sc1
    buffer_load_dword v80, v246, s[40:43], s14 offen offset:0 sc1
    buffer_load_dword v81, v246, s[40:43], s14 offen offset:256 sc1
    buffer_load_dword v82, v246, s[40:43], s14 offen offset:512 sc1
    buffer_load_dword v83, v246, s[40:43], s14 offen offset:768 sc1
    buffer_load_dword v84, v246, s[40:43], s17 offen offset:0 sc1
    buffer_load_dword v85, v246, s[40:43], s17 offen offset:256 sc1
    buffer_load_dword v86, v246, s[40:43], s17 offen offset:512 sc1
    buffer_load_dword v87, v246, s[40:43], s17 offen offset:768 sc1
    ds_read_b128 a[0:3], v254 offset:0
    ds_read_b128 a[4:7], v254 offset:64
    ds_read_b128 a[8:11], v255 offset:0
    ds_read_b128 a[12:15], v255 offset:64
    ds_read_b128 a[16:19], v254 offset:256
    ds_read_b128 a[20:23], v254 offset:320
    ds_read_b128 a[24:27], v255 offset:256
    ds_read_b128 a[28:31], v255 offset:320
    s_lshl_b32 s49, s44, 10
    v_add_u32 v247, s49, v2
    v_lshrrev_b32_e64 v91, 1, v4
    v_bfe_u32 v92, v3, 1, 2
    v_xor_b32 v91, v91, v92
    v_lshlrev_b32 v91, 4, v91
    v_lshl_add_u32 v91, v3, 6, v91
    v_and_b32_e64 v92, 1, v4
    v_lshl_add_u32 v91, v92, 3, v91
    v_add_u32 v93, s49, v91
    v_xor_b32 v92, 32, v93
    s_mul_i32 s69, s44, 16640
    s_add_u32 s69, s69, 105600
    s_mov_b32 m0, s69
    s_add_u32 s69, s44, 0
    s_and_b32 s69, s69, 3
    s_lshl_b32 s69, s69, 16
    s_add_u32 s69, s69, s61
    s_xor_b32 s69, s69, 512
    buffer_load_dwordx4 v187, s[24:27], s69 offen lds
    s_add_u32 m0, m0, 1040
    s_add_u32 s69, s69, 4096
    v_bfe_u32 v91, v1, 3, 2
    v_lshlrev_b32 v91, 4, v91
    v_xor_b32 v91, v91, v247
    v_sin_f32 v241, v237
    v_cos_f32 v237, v237
    v_sin_f32 v242, v238
    v_cos_f32 v238, v238
    v_sin_f32 v243, v239
    v_cos_f32_e64 v239, v239
    v_cvt_pk_bf16_f32 v40, v236, v237
    v_cvt_pk_bf16_f32 v48, v240, v241
    buffer_load_dwordx4 v187, s[24:27], s69 offen lds
    s_add_u32 m0, m0, 1040
    s_add_u32 s69, s69, 4096
    v_cvt_pk_bf16_f32 v56, -v240, -v241
    v_cvt_pk_bf16_f32 v41, v238, v239
    v_cvt_pk_bf16_f32 v49, v242, v243
    v_cvt_pk_bf16_f32 v57, -v242, -v243
    v_xor_b32 v42, v40, v234
    v_xor_b32 v43, v41, v234
    v_xor_b32 v50, v48, v234
    v_xor_b32 v51, v49, v234
    v_xor_b32 v58, v56, v234
    v_xor_b32 v59, v57, v234
    buffer_load_dwordx4 v187, s[24:27], s69 offen lds
    s_add_u32 m0, m0, 1040
    s_add_u32 s69, s69, 4096
    v_xor_b32 v44, 0x80000000, v40
    v_xor_b32 v45, 0x80000000, v41
    v_xor_b32 v46, 0x80000000, v42
    v_xor_b32 v47, 0x80000000, v43
    v_xor_b32 v52, 0x80000000, v48
    v_xor_b32 v53, 0x80000000, v49
    v_xor_b32 v54, 0x80000000, v50
    v_xor_b32 v55, 0x80000000, v51
    v_xor_b32 v60, 0x80000000, v56
    v_xor_b32 v61, 0x80000000, v57
    v_xor_b32 v62, 0x80000000, v58
    buffer_load_dwordx4 v187, s[24:27], s69 offen lds
    s_add_u32 m0, m0, 1040
    s_add_u32 s69, s69, 4096
    v_xor_b32 v63, 0x80000000, v59
    v_cvt_f32_u32 v233, s18
    v_add_f32 v233, v233, v229
    v_add_f32_e64 v230, 0x00000000, v232
    v_mul_f32 v230, 0x3a000000, v230
    v_mul_f32_e64 v231, v230, v233
    v_fmamk_f32 v204, v230, 0x00000000, v231
    v_fmamk_f32 v205, v230, 0x3f800000, v231
    v_fmamk_f32 v206, v230, 0x40000000, v231
    v_fmamk_f32 v207, v230, 0x40400000, v231
    v_add_f32 v230, 0x41800000, v232
    buffer_load_dwordx4 v187, s[24:27], s69 offen lds
    s_add_u32 m0, m0, 1040
    s_add_u32 s69, s69, 4096
    v_mul_f32 v230, 0x3a000000, v230
    v_mul_f32_e64 v231, v230, v233
    v_fmamk_f32 v208, v230, 0x00000000, v231
    v_fmamk_f32 v209, v230, 0x3f800000, v231
    v_fmamk_f32 v210, v230, 0x40000000, v231
    v_fmamk_f32 v211, v230, 0x40400000, v231
    v_sin_f32 v212, v204
    v_cos_f32 v204, v204
    v_sin_f32 v213, v205
    v_cos_f32 v205, v205
    buffer_load_dwordx4 v187, s[24:27], s69 offen lds
    s_add_u32 m0, m0, 1040
    s_add_u32 s69, s69, 4096
    v_sin_f32 v214, v206
    v_cos_f32 v206, v206
    v_sin_f32 v215, v207
    v_cos_f32 v207, v207
    v_sin_f32 v216, v208
    v_cos_f32 v208, v208
    v_sin_f32 v217, v209
    v_cos_f32 v209, v209
    v_sin_f32 v218, v210
    v_cos_f32 v210, v210
    v_sin_f32_e64 v219, v211
    buffer_load_dwordx4 v187, s[24:27], s69 offen lds
    s_add_u32 m0, m0, 1040
    s_add_u32 s69, s69, 4096
    v_cos_f32_e64 v211, v211
    v_mov_b32 v230, 0x3a000000
    v_pk_mul_f32 v[204:205], v[204:205], v[230:231] op_sel_hi:[1,0]
    v_pk_mul_f32 v[206:207], v[206:207], v[230:231] op_sel_hi:[1,0]
    v_pk_mul_f32 v[208:209], v[208:209], v[230:231] op_sel_hi:[1,0]
    v_pk_mul_f32 v[210:211], v[210:211], v[230:231] op_sel_hi:[1,0]
    v_pk_mul_f32 v[212:213], v[212:213], v[230:231] op_sel_hi:[1,0]
    v_pk_mul_f32 v[214:215], v[214:215], v[230:231] op_sel_hi:[1,0]
    v_pk_mul_f32 v[216:217], v[216:217], v[230:231] op_sel_hi:[1,0]
    v_pk_mul_f32 v[218:219], v[218:219], v[230:231] op_sel_hi:[1,0]
    buffer_load_dwordx4 v187, s[24:27], s69 offen lds
    s_waitcnt vmcnt(18)
    ds_write_b128 v248, v[64:67] offset:0
    ds_write_b128 v249, v[68:71] offset:0
    s_waitcnt lgkmcnt(0)
    s_barrier
    ds_read_b128 v[96:99], v250 offset:0
    ds_read_b128 v[112:115], v250 offset:4096
    ds_read_b128 v[100:103], v251 offset:0
    ds_read_b128 v[116:119], v251 offset:4096
    ds_read_b128 v[104:107], v252 offset:0
    ds_read_b128 v[120:123], v252 offset:4096
    ds_read_b128 v[108:111], v253 offset:0
    ds_read_b128 v[124:127], v253 offset:4096
    ds_read_b128 v[128:131], v245 offset:0
    ds_read_b128 v[132:135], v245 offset:4096
    s_lshl_b32 s48, s2, 7
    s_add_u32 s48, s48, 98304
    s_cmp_eq_u32 s44, 0
    s_cselect_b32 exec_lo, 1, 0
    s_mov_b32 exec_hi, 0
    v_mov_b32 v6, s45
    v_mov_b32_e64 v7, 0
    buffer_store_dword v6, v7, s[40:43], s48 offen sc1
    s_mov_b64 exec, -1
    s_mul_i32 s69, s44, 16640
    s_add_u32 s69, s69, 97280
    s_mov_b32 m0, s69
    s_add_u32 s69, s44, 1
    s_and_b32 s69, s69, 3
    s_lshl_b32 s69, s69, 16
    s_add_u32 s69, s69, s61
    buffer_load_dwordx4 v187, s[24:27], s69 offen lds
    s_add_u32 m0, m0, 1040
    s_add_u32 s69, s69, 4096
    buffer_load_dwordx4 v187, s[24:27], s69 offen lds
    s_add_u32 m0, m0, 1040
    s_add_u32 s69, s69, 4096
    s_waitcnt lgkmcnt(9)
    v_mfma_f32_16x16x32_bf16 v[136:139], v[96:99], v[8:11], 0
    v_mfma_f32_16x16x32_bf16 v[140:143], v[96:99], v[24:27], 0
    s_waitcnt lgkmcnt(8)
    v_mfma_f32_16x16x32_bf16 v[144:147], v[112:115], v[8:11], 0
    v_mfma_f32_16x16x32_bf16 v[148:151], v[112:115], v[24:27], 0
    buffer_load_dwordx4 v187, s[24:27], s69 offen lds
    s_add_u32 m0, m0, 1040
    s_add_u32 s69, s69, 4096
    s_waitcnt lgkmcnt(7)
    v_mfma_f32_16x16x32_bf16 v[136:139], v[100:103], v[12:15], v[136:139]
    v_mfma_f32_16x16x32_bf16 v[140:143], v[100:103], v[28:31], v[140:143]
    s_waitcnt lgkmcnt(6)
    v_mfma_f32_16x16x32_bf16 v[144:147], v[116:119], v[12:15], v[144:147]
    v_mfma_f32_16x16x32_bf16 v[148:151], v[116:119], v[28:31], v[148:151]
    buffer_load_dwordx4 v187, s[24:27], s69 offen lds
    s_add_u32 m0, m0, 1040
    s_add_u32 s69, s69, 4096
    s_waitcnt lgkmcnt(5)
    v_mfma_f32_16x16x32_bf16 v[136:139], v[104:107], v[16:19], v[136:139]
    v_mfma_f32_16x16x32_bf16 v[140:143], v[104:107], v[32:35], v[140:143]
    s_waitcnt lgkmcnt(4)
    v_mfma_f32_16x16x32_bf16 v[144:147], v[120:123], v[16:19], v[144:147]
    v_mfma_f32_16x16x32_bf16 v[148:151], v[120:123], v[32:35], v[148:151]
    buffer_load_dwordx4 v187, s[24:27], s69 offen lds
    s_add_u32 m0, m0, 1040
    s_add_u32 s69, s69, 4096
    s_waitcnt lgkmcnt(3)
    v_mfma_f32_16x16x32_bf16 v[136:139], v[108:111], v[20:23], v[136:139]
    v_mfma_f32_16x16x32_bf16 v[140:143], v[108:111], v[36:39], v[140:143]
    s_waitcnt lgkmcnt(2)
    v_mfma_f32_16x16x32_bf16 v[144:147], v[124:127], v[20:23], v[144:147]
    v_mfma_f32_16x16x32_bf16 v[148:151], v[124:127], v[36:39], v[148:151]
    buffer_load_dwordx4 v187, s[24:27], s69 offen lds
    s_add_u32 m0, m0, 1040
    s_add_u32 s69, s69, 4096
    s_waitcnt lgkmcnt(0)
    v_mfma_f32_16x16x32_bf16 v[168:171], v[128:131], v[220:223], 0
    v_mfma_f32_16x16x32_bf16 v[172:175], v[128:131], v[224:227], 0
    v_mfma_f32_16x16x32_bf16 v[176:179], v[132:135], v[220:223], 0
    v_mfma_f32_16x16x32_bf16 v[180:183], v[132:135], v[224:227], 0
    buffer_load_dwordx4 v187, s[24:27], s69 offen lds
    s_add_u32 m0, m0, 1040
    s_add_u32 s69, s69, 4096
    v_pk_mul_f32 v[152:153], v[136:137], v[188:189]
    v_pk_mul_f32 v[156:157], v[140:141], v[188:189]
    v_pk_fma_f32 v[152:153], v[140:141], v[196:197], v[152:153]
    v_pk_fma_f32 v[156:157], v[136:137], v[196:197], v[156:157] neg_lo:[1,0,0] neg_hi:[1,0,0]
    v_pk_mul_f32 v[154:155], v[138:139], v[190:191]
    v_pk_mul_f32 v[158:159], v[142:143], v[190:191]
    v_pk_fma_f32 v[154:155], v[142:143], v[198:199], v[154:155]
    v_pk_fma_f32 v[158:159], v[138:139], v[198:199], v[158:159] neg_lo:[1,0,0] neg_hi:[1,0,0]
    v_pk_mul_f32 v[160:161], v[144:145], v[192:193]
    v_pk_mul_f32 v[164:165], v[148:149], v[192:193]
    v_pk_fma_f32 v[160:161], v[148:149], v[200:201], v[160:161]
    v_pk_fma_f32 v[164:165], v[144:145], v[200:201], v[164:165] neg_lo:[1,0,0] neg_hi:[1,0,0]
    v_pk_mul_f32 v[162:163], v[146:147], v[194:195]
    v_pk_mul_f32 v[166:167], v[150:151], v[194:195]
    v_pk_fma_f32 v[162:163], v[150:151], v[202:203], v[162:163]
    v_pk_fma_f32 v[166:167], v[146:147], v[202:203], v[166:167] neg_lo:[1,0,0] neg_hi:[1,0,0]
    v_cvt_pk_bf16_f32 v96, v152, v153
    v_cvt_pk_bf16_f32 v100, v156, v157
    v_cvt_pk_bf16_f32 v97, v154, v155
    v_cvt_pk_bf16_f32 v101, v158, v159
    v_cvt_pk_bf16_f32 v98, v160, v161
    v_cvt_pk_bf16_f32 v102, v164, v165
    v_cvt_pk_bf16_f32 v99, v162, v163
    v_cvt_pk_bf16_f32 v103, v166, v167
    buffer_load_dwordx4 v187, s[24:27], s69 offen lds
    v_mfma_f32_16x16x32_bf16 v[136:139], v[40:43], v[96:99], 0
    v_mfma_f32_16x16x32_bf16 v[140:143], v[40:43], v[100:103], 0
    v_mfma_f32_16x16x32_bf16 v[144:147], v[44:47], v[96:99], 0
    v_mfma_f32_16x16x32_bf16 v[148:151], v[44:47], v[100:103], 0
    s_waitcnt vmcnt(24)
    v_mfma_f32_16x16x32_bf16 v[136:139], v[48:51], v[100:103], v[136:139]
    v_lshlrev_b32_e64 v64, 16, v72
    v_and_b32 v72, 0xffff0000, v72
    v_mfma_f32_16x16x32_bf16 v[140:143], v[56:59], v[96:99], v[140:143]
    v_lshlrev_b32_e64 v65, 16, v73
    v_and_b32 v73, 0xffff0000, v73
    v_mfma_f32_16x16x32_bf16 v[144:147], v[52:55], v[100:103], v[144:147]
    v_lshlrev_b32_e64 v66, 16, v74
    v_and_b32 v74, 0xffff0000, v74
    v_mfma_f32_16x16x32_bf16 v[148:151], v[60:63], v[96:99], v[148:151]
    v_lshlrev_b32_e64 v67, 16, v75
    v_and_b32 v75, 0xffff0000, v75
    v_lshlrev_b32_e64 v68, 16, v76
    v_and_b32 v76, 0xffff0000, v76
    v_lshlrev_b32_e64 v69, 16, v77
    v_and_b32 v77, 0xffff0000, v77
    v_lshlrev_b32_e64 v70, 16, v78
    v_and_b32 v78, 0xffff0000, v78
    v_lshlrev_b32_e64 v71, 16, v79
    v_and_b32 v79, 0xffff0000, v79
    v_pk_mul_f32 v[152:153], v[136:137], v[64:65]
    v_pk_mul_f32 v[156:157], v[140:141], v[64:65]
    v_pk_fma_f32 v[152:153], v[140:141], v[72:73], v[152:153] neg_lo:[1,0,0] neg_hi:[1,0,0]
    v_pk_fma_f32 v[156:157], v[136:137], v[72:73], v[156:157]
    v_pk_mul_f32 v[154:155], v[138:139], v[66:67]
    v_pk_mul_f32 v[158:159], v[142:143], v[66:67]
    v_pk_fma_f32 v[154:155], v[142:143], v[74:75], v[154:155] neg_lo:[1,0,0] neg_hi:[1,0,0]
    v_pk_fma_f32 v[158:159], v[138:139], v[74:75], v[158:159]
    v_pk_mul_f32 v[160:161], v[144:145], v[68:69]
    v_pk_mul_f32 v[164:165], v[148:149], v[68:69]
    v_pk_fma_f32 v[160:161], v[148:149], v[76:77], v[160:161] neg_lo:[1,0,0] neg_hi:[1,0,0]
    v_pk_fma_f32 v[164:165], v[144:145], v[76:77], v[164:165]
    v_pk_mul_f32 v[162:163], v[146:147], v[70:71]
    v_pk_mul_f32 v[166:167], v[150:151], v[70:71]
    v_pk_fma_f32 v[162:163], v[150:151], v[78:79], v[162:163] neg_lo:[1,0,0] neg_hi:[1,0,0]
    v_pk_fma_f32 v[166:167], v[146:147], v[78:79], v[166:167]
    v_cvt_pk_bf16_f32 v96, v152, v153
    v_cvt_pk_bf16_f32 v100, v156, v157
    v_cvt_pk_bf16_f32 v97, v154, v155
    v_cvt_pk_bf16_f32 v101, v158, v159
    v_cvt_pk_bf16_f32 v98, v160, v161
    v_cvt_pk_bf16_f32 v102, v164, v165
    v_cvt_pk_bf16_f32 v99, v162, v163
    v_cvt_pk_bf16_f32 v103, v166, v167
    s_nop 0
    v_mfma_f32_16x16x32_bf16 v[136:139], v[96:99], v[40:43], 0
    v_mfma_f32_16x16x32_bf16 v[140:143], v[100:103], v[40:43], 0
    v_mfma_f32_16x16x32_bf16 v[144:147], v[96:99], v[44:47], 0
    v_mfma_f32_16x16x32_bf16 v[148:151], v[100:103], v[44:47], 0
    v_mfma_f32_16x16x32_bf16 v[136:139], v[100:103], v[56:59], v[136:139]
    v_mfma_f32_16x16x32_bf16 v[140:143], v[96:99], v[48:51], v[140:143]
    v_mfma_f32_16x16x32_bf16 v[144:147], v[100:103], v[60:63], v[144:147]
    v_mfma_f32_16x16x32_bf16 v[148:151], v[96:99], v[52:55], v[148:151]
    s_waitcnt vmcnt(16)
    v_pk_mul_f32 v[168:169], v[168:169], v[80:81]
    v_pk_mul_f32 v[172:173], v[172:173], v[80:81] neg_lo:[1,0] neg_hi:[1,0]
    v_pk_mul_f32 v[170:171], v[170:171], v[82:83]
    v_pk_mul_f32 v[174:175], v[174:175], v[82:83] neg_lo:[1,0] neg_hi:[1,0]
    v_pk_mul_f32 v[176:177], v[176:177], v[84:85]
    v_pk_mul_f32 v[180:181], v[180:181], v[84:85] neg_lo:[1,0] neg_hi:[1,0]
    v_pk_mul_f32 v[178:179], v[178:179], v[86:87]
    v_pk_mul_f32 v[182:183], v[182:183], v[86:87] neg_lo:[1,0] neg_hi:[1,0]
    v_pk_mul_f32 v[152:153], v[136:137], v[204:205]
    v_pk_mul_f32 v[156:157], v[140:141], v[204:205]
    v_pk_fma_f32 v[152:153], v[140:141], v[212:213], v[152:153] neg_lo:[1,0,0] neg_hi:[1,0,0]
    v_pk_fma_f32 v[156:157], v[136:137], v[212:213], v[156:157]
    v_pk_mul_f32 v[154:155], v[138:139], v[206:207]
    v_pk_mul_f32 v[158:159], v[142:143], v[206:207]
    v_pk_fma_f32 v[154:155], v[142:143], v[214:215], v[154:155] neg_lo:[1,0,0] neg_hi:[1,0,0]
    v_pk_fma_f32 v[158:159], v[138:139], v[214:215], v[158:159]
    v_pk_mul_f32 v[160:161], v[144:145], v[208:209]
    v_pk_mul_f32 v[164:165], v[148:149], v[208:209]
    v_pk_fma_f32 v[160:161], v[148:149], v[216:217], v[160:161] neg_lo:[1,0,0] neg_hi:[1,0,0]
    v_pk_fma_f32 v[164:165], v[144:145], v[216:217], v[164:165]
    v_pk_mul_f32 v[162:163], v[146:147], v[210:211]
    v_pk_mul_f32 v[166:167], v[150:151], v[210:211]
    v_pk_fma_f32 v[162:163], v[150:151], v[218:219], v[162:163] neg_lo:[1,0,0] neg_hi:[1,0,0]
    v_pk_fma_f32 v[166:167], v[146:147], v[218:219], v[166:167]
    v_cvt_pk_bf16_f32 v128, v152, -v156
    v_cvt_pk_bf16_f32 v129, v153, -v157
    v_cvt_pk_bf16_f32 v130, v154, -v158
    v_cvt_pk_bf16_f32 v131, v155, -v159
    ds_write_b128 v247, v[128:131] offset:8192
    v_cvt_pk_bf16_f32 v132, v160, -v164
    v_cvt_pk_bf16_f32 v133, v161, -v165
    v_cvt_pk_bf16_f32 v134, v162, -v166
    v_cvt_pk_bf16_f32 v135, v163, -v167
    ds_write_b128 v247, v[132:135] offset:12288
    s_waitcnt lgkmcnt(0)
    s_barrier
    ds_read_b128 v[96:99], v2 offset:8192
    ds_read_b128 v[112:115], v2 offset:12288
    ds_read_b128 v[100:103], v2 offset:9216
    ds_read_b128 v[116:119], v2 offset:13312
    ds_read_b128 v[104:107], v2 offset:10240
    ds_read_b128 v[120:123], v2 offset:14336
    ds_read_b128 v[108:111], v2 offset:11264
    ds_read_b128 v[124:127], v2 offset:15360
    buffer_load_dword v94, v95, s[40:43], 0 offen sc1
    s_waitcnt lgkmcnt(7)
    v_mfma_f32_16x16x32_bf16 v[168:171], v[96:99], v[8:11], v[168:171]
    v_mfma_f32_16x16x32_bf16 v[172:175], v[96:99], v[24:27], v[172:175]
    s_waitcnt lgkmcnt(6)
    v_mfma_f32_16x16x32_bf16 v[176:179], v[112:115], v[8:11], v[176:179]
    v_mfma_f32_16x16x32_bf16 v[180:183], v[112:115], v[24:27], v[180:183]
    s_waitcnt lgkmcnt(5)
    v_mfma_f32_16x16x32_bf16 v[168:171], v[100:103], v[12:15], v[168:171]
    v_mfma_f32_16x16x32_bf16 v[172:175], v[100:103], v[28:31], v[172:175]
    s_waitcnt lgkmcnt(4)
    v_mfma_f32_16x16x32_bf16 v[176:179], v[116:119], v[12:15], v[176:179]
    v_mfma_f32_16x16x32_bf16 v[180:183], v[116:119], v[28:31], v[180:183]
    s_waitcnt lgkmcnt(3)
    v_mfma_f32_16x16x32_bf16 v[168:171], v[104:107], v[16:19], v[168:171]
    v_mfma_f32_16x16x32_bf16 v[172:175], v[104:107], v[32:35], v[172:175]
    s_waitcnt lgkmcnt(2)
    v_mfma_f32_16x16x32_bf16 v[176:179], v[120:123], v[16:19], v[176:179]
    v_mfma_f32_16x16x32_bf16 v[180:183], v[120:123], v[32:35], v[180:183]
    s_waitcnt lgkmcnt(1)
    v_mfma_f32_16x16x32_bf16 v[168:171], v[108:111], v[20:23], v[168:171]
    v_mfma_f32_16x16x32_bf16 v[172:175], v[108:111], v[36:39], v[172:175]
    s_waitcnt lgkmcnt(0)
    v_mfma_f32_16x16x32_bf16 v[176:179], v[124:127], v[20:23], v[176:179]
    v_mfma_f32_16x16x32_bf16 v[180:183], v[124:127], v[36:39], v[180:183]
    s_nop 3
    v_cvt_pk_bf16_f32 v136, v168, v169
    v_cvt_pk_bf16_f32 v137, v170, v171
    ds_write_b64 v93, v[136:137] offset:16384
    v_cvt_pk_bf16_f32 v138, -v172, -v173
    v_cvt_pk_bf16_f32 v139, -v174, -v175
    v_and_b32 v138, s16, v138
    v_and_b32_e64 v139, s16, v139
    ds_write_b64 v93, v[138:139] offset:20480
    v_cvt_pk_bf16_f32 v140, v176, v177
    v_cvt_pk_bf16_f32 v141, v178, v179
    ds_write_b64 v92, v[140:141] offset:16384
    v_cvt_pk_bf16_f32 v142, -v180, -v181
    v_cvt_pk_bf16_f32 v143, -v182, -v183
    v_and_b32 v142, s16, v142
    v_and_b32 v143, s16, v143
    ds_write_b64 v92, v[142:143] offset:20480
    s_waitcnt lgkmcnt(0)
    ds_read_b128 v[144:147], v91 offset:16384
    ds_read_b128 v[148:151], v91 offset:20480
    s_waitcnt lgkmcnt(1)
    buffer_store_dwordx4 v[144:147], v5, s[40:43], s15 offen sc1
    s_waitcnt lgkmcnt(0)
    buffer_store_dwordx4 v[148:151], v5, s[40:43], s15 offen offset:256 sc1
    s_waitcnt vmcnt(2)
    v_cmp_ne_u32 vcc, s45, v94
    s_nop 0
    s_cbranch_vccnz L_slow_5
L_back_6:
    s_lshl_b32 s51, s44, 12
    s_add_u32 m0, s51, 32768
    s_add_u32 s51, s51, s10
    buffer_load_dwordx4 v2, s[40:43], s51 offen sc1 lds
    buffer_load_dwordx4 v2, s[40:43], s51 offen offset:1024 sc1 lds
    buffer_load_dwordx4 v2, s[40:43], s51 offen offset:2048 sc1 lds
    buffer_load_dwordx4 v2, s[40:43], s51 offen offset:3072 sc1 lds
    s_lshl_b32 s51, s44, 12
    s_add_u32 m0, s51, 49152
    s_add_u32 s51, s51, s11
    buffer_load_dwordx4 v2, s[40:43], s51 offen sc1 lds
    ds_read_b128 a[32:35], v254 offset:8320
    buffer_load_dwordx4 v2, s[40:43], s51 offen offset:1024 sc1 lds
    ds_read_b128 a[36:39], v254 offset:8384
    buffer_load_dwordx4 v2, s[40:43], s51 offen offset:2048 sc1 lds
    ds_read_b128 a[40:43], v255 offset:8320
    buffer_load_dwordx4 v2, s[40:43], s51 offen offset:3072 sc1 lds
    ds_read_b128 a[44:47], v255 offset:8384
    ds_read_b128 a[48:51], v254 offset:8576
    ds_read_b128 a[52:55], v254 offset:8640
    ds_read_b128 a[56:59], v255 offset:8576
    ds_read_b128 a[60:63], v255 offset:8640
    ds_read_b128 a[64:67], v254 offset:0
    ds_read_b128 a[68:71], v254 offset:64
    ds_read_b128 a[72:75], v255 offset:0
    ds_read_b128 a[76:79], v255 offset:64
    ds_read_b128 a[80:83], v254 offset:256
    ds_read_b128 a[84:87], v254 offset:320
    ds_read_b128 a[88:91], v255 offset:256
    ds_read_b128 a[92:95], v255 offset:320
    s_waitcnt vmcnt(8)
    s_waitcnt lgkmcnt(0)
    s_barrier
    s_cmp_eq_u32 s44, 0
    s_cbranch_scc0 L_nf_7
    s_lshl_b32 s48, s2, 7
    s_add_u32 s48, s48, 131072
    v_mov_b32 v6, s45
    v_mov_b32 v7, 0
    s_mov_b64 exec, 1
    buffer_store_dword v6, v7, s[40:43], s48 offen sc1
    s_mov_b64 exec, -1
L_nf_7:
    s_lshl_b32 s19, s66, 17
    s_lshl_b32 s49, s44, 12
    s_add_u32 s19, s19, s49
    s_add_u32 s19, s19, 5767168
    s_lshl_b32 s51, s44, 12
    s_add_u32 m0, s51, 0
    s_add_u32 s51, s51, s8
    buffer_load_dwordx4 v2, s[40:43], s51 offen sc1 lds
    s_mov_b32 s18, s49
    v_and_b32 v16, 2, v4
    v_lshlrev_b32 v16, 5, v16
    v_xor_b32_e64 v20, v16, v2
    buffer_load_dwordx4 v2, s[40:43], s51 offen offset:1024 sc1 lds
    v_xor_b32 v21, 128, v20
    v_xor_b32_e64 v22, 32, v20
    v_xor_b32 v23, 160, v20
    v_mul_u32_u24 v13, 80, v4
    buffer_load_dwordx4 v2, s[40:43], s51 offen offset:2048 sc1 lds
    v_lshrrev_b32 v9, 2, v3
    v_lshlrev_b32 v9, 4, v9
    v_add_lshl_u32 v9, v9, v3, 2
    buffer_load_dwordx4 v2, s[40:43], s51 offen offset:3072 sc1 lds
    v_bfe_u32 v16, v1, 2, 2
    v_and_b32_e64 v17, 1, v4
    v_lshl_add_u32 v17, v16, 1, v17
    s_lshl_b32 s48, s44, 1
    s_lshl_b32 s51, s44, 12
    s_add_u32 m0, s51, 16384
    s_add_u32 s51, s51, s9
    buffer_load_dwordx4 v2, s[40:43], s51 offen sc1 lds
    v_xor_b32 v17, s48, v17
    v_lshl_add_u32 v16, v4, 2, v16
    v_lshlrev_b32_e64 v16, 9, v16
    v_lshl_add_u32 v16, v17, 5, v16
    buffer_load_dwordx4 v2, s[40:43], s51 offen offset:1024 sc1 lds
    v_and_b32_e64 v17, 3, v1
    v_lshl_add_u32 v16, v17, 3, v16
    v_add_u32 v10, 98304, v16
    v_xor_b32_e64 v11, 32, v10
    buffer_load_dwordx4 v2, s[40:43], s51 offen offset:2048 sc1 lds
    v_add_u32 v12, 65536, v2
    v_add_u32_e64 v8, s18, v12
    v_mov_b32 v14, 0xc0135761
    buffer_load_dwordx4 v2, s[40:43], s51 offen offset:3072 sc1 lds
    s_mul_i32 s62, s2, 3584
    v_lshlrev_b32 v18, 7, v1
    s_cmp_eq_u32 s44, 3
    s_cselect_b32 exec_lo, 0xfffffff, 0
    s_mov_b32 exec_hi, 0
    buffer_load_dword v18, v18, s[32:35], s62 offen
    s_mov_b64 exec, -1
    v_mov_b32 v30, 0xbdd2d3e8
    v_lshrrev_b32 v16, 3, v1
    v_lshlrev_b32 v16, 5, v16
    v_and_b32 v17, 7, v1
    s_lshl_b32 s48, s44, 3
    v_add3_u32 v16, v16, v17, s48
    v_lshlrev_b32_e64 v16, 7, v16
    v_add_u32 v15, 131072, v16
    v_lshrrev_b32 v16, 3, v3
    v_lshlrev_b32 v16, 4, v16
    v_lshl_add_u32 v16, v4, 2, v16
    v_bfe_u32 v17, v3, 2, 1
    v_lshl_add_u32 v16, v17, 1, v16
    v_and_b32_e64 v17, 1, v3
    v_add_lshl_u32 v25, v16, v17, 4
    v_and_b32 v16, 31, v1
    v_lshlrev_b32 v16, 4, v16
    v_lshrrev_b32_e64 v17, 5, v1
    v_lshl_add_u32 v24, v17, 11, v16
    s_lshl_b32 s12, s66, 15
    s_lshl_b32 s49, s44, 9
    s_add_u32 s12, s12, s49
    s_add_u32 s12, s12, 524288
    s_lshl_b32 s49, s67, 11
    s_add_u32 s13, s49, s12
    v_and_b32 v27, 7, v3
    v_mul_u32_u24 v27, 1040, v27
    v_lshrrev_b32_e64 v19, 3, v3
    v_mul_u32_u24 v19, 640, v19
    v_lshl_add_u32 v19, v4, 4, v19
    s_mul_i32 s62, s44, 0
    s_add_u32 s62, s62, 0
    v_xor_b32 v31, 128, v19
    v_add3_u32 v31, v31, v27, s62
    v_add3_u32 v27, v19, v27, s62
    v_mov_b32 v5, v187
    s_lshl_b32 s49, s67, 5
    v_lshrrev_b32 v32, 2, v3
    v_lshlrev_b32 v32, 3, v32
    v_and_b32_e64 v33, 3, v3
    v_add3_u32 v32, v32, v33, s49
    s_lshl_b32 s49, s44, 6
    s_add_u32 s49, s49, 1
    v_lshl_add_u32 v34, v4, 2, s49
    v_cvt_f32_u32_e64 v34, v34
    s_mul_i32 s69, s44, 16640
    s_add_u32 s69, s69, 105600
    s_mov_b32 m0, s69
    s_add_u32 s69, s44, 1
    s_and_b32 s69, s69, 3
    s_lshl_b32 s69, s69, 16
    s_add_u32 s69, s69, s61
    s_xor_b32 s69, s69, 512
    buffer_load_dwordx4 v187, s[24:27], s69 offen lds
    s_add_u32 m0, m0, 1040
    s_add_u32 s69, s69, 4096
    v_mov_b32 v36, 1.0
    v_mov_b32 v37, 0x3f3504f3
    v_cmp_eq_u32 vcc, 0xf0, v0
    v_lshrrev_b32 v38, 4, v0
    v_cmp_eq_u32 vcc, 15, v38
    s_nop 1
    v_cndmask_b32 v36, v36, v37, vcc
    v_add_u32 v33, 0, v32
    v_cvt_f32_u32 v33, v33
    buffer_load_dwordx4 v187, s[24:27], s69 offen lds
    s_add_u32 m0, m0, 1040
    s_add_u32 s69, s69, 4096
    v_mul_f32 v33, 0x3b000000, v33
    v_mul_f32 v35, v34, v33
    v_fract_f32 v35, v35
    v_fmamk_f32 v40, v33, 0x00000000, v35
    v_fmamk_f32 v41, v33, 0x3f800000, v35
    v_fmamk_f32 v42, v33, 0x40000000, v35
    v_fmamk_f32 v43, v33, 0x40400000, v35
    v_sin_f32_e64 v44, v40
    buffer_load_dwordx4 v187, s[24:27], s69 offen lds
    s_add_u32 m0, m0, 1040
    s_add_u32 s69, s69, 4096
    v_cos_f32 v40, v40
    v_sin_f32 v45, v41
    v_cos_f32 v41, v41
    v_sin_f32 v46, v42
    v_cos_f32 v42, v42
    v_sin_f32 v47, v43
    v_cos_f32_e64 v43, v43
    v_cvt_pk_bf16_f32 v96, v40, v41
    buffer_load_dwordx4 v187, s[24:27], s69 offen lds
    s_add_u32 m0, m0, 1040
    s_add_u32 s69, s69, 4096
    v_cvt_pk_bf16_f32 v97, v42, v43
    v_cvt_pk_bf16_f32 v98, -v44, -v45
    v_cvt_pk_bf16_f32 v99, -v46, -v47
    v_fmamk_f32 v40, v33, 0x41800000, v35
    v_fmamk_f32 v41, v33, 0x41880000, v35
    v_fmamk_f32 v42, v33, 0x41900000, v35
    v_fmamk_f32 v43, v33, 0x41980000, v35
    v_sin_f32_e64 v44, v40
    buffer_load_dwordx4 v187, s[24:27], s69 offen lds
    s_add_u32 m0, m0, 1040
    s_add_u32 s69, s69, 4096
    v_cos_f32 v40, v40
    v_sin_f32 v45, v41
    v_cos_f32 v41, v41
    v_sin_f32 v46, v42
    v_cos_f32 v42, v42
    v_sin_f32 v47, v43
    v_cos_f32_e64 v43, v43
    v_cvt_pk_bf16_f32 v104, v40, v41
    buffer_load_dwordx4 v187, s[24:27], s69 offen lds
    s_add_u32 m0, m0, 1040
    s_add_u32 s69, s69, 4096
    v_cvt_pk_bf16_f32 v105, v42, v43
    v_cvt_pk_bf16_f32 v106, -v44, -v45
    v_cvt_pk_bf16_f32 v107, -v46, -v47
    v_fmamk_f32 v40, v33, 0x42000000, v35
    v_fmamk_f32 v41, v33, 0x42040000, v35
    v_fmamk_f32 v42, v33, 0x42080000, v35
    v_fmamk_f32 v43, v33, 0x420c0000, v35
    v_sin_f32_e64 v44, v40
    buffer_load_dwordx4 v187, s[24:27], s69 offen lds
    s_add_u32 m0, m0, 1040
    s_add_u32 s69, s69, 4096
    v_cos_f32 v40, v40
    v_sin_f32 v45, v41
    v_cos_f32 v41, v41
    v_sin_f32 v46, v42
    v_cos_f32 v42, v42
    v_sin_f32 v47, v43
    v_cos_f32_e64 v43, v43
    v_cvt_pk_bf16_f32 v112, v40, v41
    buffer_load_dwordx4 v187, s[24:27], s69 offen lds
    v_cvt_pk_bf16_f32 v113, v42, v43
    v_cvt_pk_bf16_f32 v114, -v44, -v45
    v_cvt_pk_bf16_f32 v115, -v46, -v47
    v_fmamk_f32 v40, v33, 0x42400000, v35
    v_fmamk_f32 v41, v33, 0x42440000, v35
    v_fmamk_f32 v42, v33, 0x42480000, v35
    v_fmamk_f32 v43, v33, 0x424c0000, v35
    v_sin_f32 v44, v40
    v_cos_f32 v40, v40
    s_mul_i32 s69, s44, 16640
    s_add_u32 s69, s69, 97280
    s_mov_b32 m0, s69
    s_add_u32 s69, s44, 2
    s_and_b32 s69, s69, 3
    s_lshl_b32 s69, s69, 16
    s_add_u32 s69, s69, s61
    buffer_load_dwordx4 v187, s[24:27], s69 offen lds
    s_add_u32 m0, m0, 1040
    s_add_u32 s69, s69, 4096
    v_sin_f32 v45, v41
    v_cos_f32 v41, v41
    v_sin_f32 v46, v42
    v_cos_f32 v42, v42
    v_sin_f32 v47, v43
    v_cos_f32 v43, v43
    s_nop 0
    v_mul_f32_e64 v43, v43, v36
    v_cvt_pk_bf16_f32 v120, v40, v41
    buffer_load_dwordx4 v187, s[24:27], s69 offen lds
    s_add_u32 m0, m0, 1040
    s_add_u32 s69, s69, 4096
    v_cvt_pk_bf16_f32 v121, v42, v43
    v_cvt_pk_bf16_f32 v122, -v44, -v45
    v_cvt_pk_bf16_f32 v123, -v46, -v47
    v_add_u32 v33, 4, v32
    v_cvt_f32_u32 v33, v33
    v_mul_f32 v33, 0x3b000000, v33
    v_mul_f32 v35, v34, v33
    v_fract_f32 v35, v35
    buffer_load_dwordx4 v187, s[24:27], s69 offen lds
    s_add_u32 m0, m0, 1040
    s_add_u32 s69, s69, 4096
    v_fmamk_f32 v40, v33, 0x00000000, v35
    v_fmamk_f32 v41, v33, 0x3f800000, v35
    v_fmamk_f32 v42, v33, 0x40000000, v35
    v_fmamk_f32 v43, v33, 0x40400000, v35
    v_sin_f32 v44, v40
    v_cos_f32 v40, v40
    v_sin_f32 v45, v41
    v_cos_f32 v41, v41
    buffer_load_dwordx4 v187, s[24:27], s69 offen lds
    s_add_u32 m0, m0, 1040
    s_add_u32 s69, s69, 4096
    v_sin_f32 v46, v42
    v_cos_f32 v42, v42
    v_sin_f32 v47, v43
    v_cos_f32 v43, v43
    v_cvt_pk_bf16_f32 v100, v40, v41
    v_cvt_pk_bf16_f32 v101, v42, v43
    v_cvt_pk_bf16_f32 v102, -v44, -v45
    v_cvt_pk_bf16_f32 v103, -v46, -v47
    buffer_load_dwordx4 v187, s[24:27], s69 offen lds
    s_add_u32 m0, m0, 1040
    s_add_u32 s69, s69, 4096
    v_fmamk_f32 v40, v33, 0x41800000, v35
    v_fmamk_f32 v41, v33, 0x41880000, v35
    v_fmamk_f32 v42, v33, 0x41900000, v35
    v_fmamk_f32 v43, v33, 0x41980000, v35
    v_sin_f32 v44, v40
    v_cos_f32 v40, v40
    v_sin_f32 v45, v41
    v_cos_f32 v41, v41
    buffer_load_dwordx4 v187, s[24:27], s69 offen lds
    s_add_u32 m0, m0, 1040
    s_add_u32 s69, s69, 4096
    v_sin_f32 v46, v42
    v_cos_f32 v42, v42
    v_sin_f32 v47, v43
    v_cos_f32 v43, v43
    v_cvt_pk_bf16_f32 v108, v40, v41
    v_cvt_pk_bf16_f32 v109, v42, v43
    v_cvt_pk_bf16_f32 v110, -v44, -v45
    v_cvt_pk_bf16_f32 v111, -v46, -v47
    buffer_load_dwordx4 v187, s[24:27], s69 offen lds
    s_add_u32 m0, m0, 1040
    s_add_u32 s69, s69, 4096
    v_fmamk_f32 v40, v33, 0x42000000, v35
    v_fmamk_f32 v41, v33, 0x42040000, v35
    v_fmamk_f32 v42, v33, 0x42080000, v35
    v_fmamk_f32 v43, v33, 0x420c0000, v35
    v_sin_f32 v44, v40
    v_cos_f32 v40, v40
    v_sin_f32 v45, v41
    v_cos_f32 v41, v41
    buffer_load_dwordx4 v187, s[24:27], s69 offen lds
    v_sin_f32 v46, v42
    v_cos_f32 v42, v42
    v_sin_f32 v47, v43
    v_cos_f32 v43, v43
    v_cvt_pk_bf16_f32 v116, v40, v41
    v_cvt_pk_bf16_f32 v117, v42, v43
    v_cvt_pk_bf16_f32 v118, -v44, -v45
    v_cvt_pk_bf16_f32 v119, -v46, -v47
    v_fmamk_f32 v40, v33, 0x42400000, v35
    v_fmamk_f32 v41, v33, 0x42440000, v35
    v_fmamk_f32 v42, v33, 0x42480000, v35
    v_fmamk_f32 v43, v33, 0x424c0000, v35
    v_sin_f32 v44, v40
    v_cos_f32 v40, v40
    v_sin_f32 v45, v41
    v_cos_f32 v41, v41
    v_sin_f32 v46, v42
    v_cos_f32 v42, v42
    v_sin_f32 v47, v43
    v_cos_f32 v43, v43
    s_nop 0
    v_mul_f32 v43, v43, v36
    v_cvt_pk_bf16_f32 v124, v40, v41
    v_cvt_pk_bf16_f32 v125, v42, v43
    v_cvt_pk_bf16_f32 v126, -v44, -v45
    v_cvt_pk_bf16_f32 v127, -v46, -v47
    ds_write_b128 v8, v[96:99] offset:0
    ds_write_b128 v8, v[100:103] offset:16384
    ds_write_b128 v8, v[104:107] offset:1024
    ds_write_b128 v8, v[108:111] offset:17408
    ds_write_b128 v8, v[112:115] offset:2048
    ds_write_b128 v8, v[116:119] offset:18432
    ds_write_b128 v8, v[120:123] offset:3072
    s_waitcnt vmcnt(8)
    ds_read_b128 a[96:99], v254 offset:8320
    ds_read_b128 a[100:103], v254 offset:8384
    ds_read_b128 a[104:107], v255 offset:8320
    ds_read_b128 a[108:111], v255 offset:8384
    ds_read_b128 a[112:115], v254 offset:8576
    ds_read_b128 a[116:119], v254 offset:8640
    ds_read_b128 a[120:123], v255 offset:8576
    ds_read_b128 a[124:127], v255 offset:8640
    s_waitcnt vmcnt(0)
    ds_read_b128 a[128:131], v254 offset:0
    ds_read_b128 a[132:135], v254 offset:64
    ds_read_b128 a[136:139], v255 offset:0
    ds_read_b128 a[140:143], v255 offset:64
    ds_read_b128 a[144:147], v254 offset:256
    ds_read_b128 a[148:151], v254 offset:320
    ds_read_b128 a[152:155], v255 offset:256
    ds_read_b128 a[156:159], v255 offset:320
    s_waitcnt lgkmcnt(0)
    s_barrier
    ds_write_b128 v8, v[124:127] offset:19456
    s_mov_b32 s48, 0
L_poll_8:
    buffer_load_dword v6, v15, s[40:43], 0 offen sc1
    s_add_u32 s48, s48, 1
    s_cmp_ge_u32 s48, 65536
    s_cbranch_scc1 L_pdone_9
    s_waitcnt vmcnt(0)
    v_cmp_ne_u32 vcc, s45, v6
    s_nop 0
    s_and_b64 exec, exec, vcc
    s_nop 2
    s_cbranch_scc1 L_poll_8
L_pdone_9:
    s_mov_b64 exec, -1
    s_waitcnt vmcnt(0)
    s_add_u32 m0, s18, 98304
    s_add_u32 s48, s19, 0
    buffer_load_dwordx4 v20, s[40:43], s48 offen offset:0 sc1 lds
    buffer_load_dwordx4 v21, s[40:43], s48 offen offset:1024 sc1 lds
    buffer_load_dwordx4 v22, s[40:43], s48 offen offset:2048 sc1 lds
    buffer_load_dwordx4 v23, s[40:43], s48 offen offset:3072 sc1 lds
    s_add_u32 m0, s18, 114688
    s_add_u32 s48, s19, 16384
    buffer_load_dwordx4 v20, s[40:43], s48 offen offset:0 sc1 lds
    buffer_load_dwordx4 v21, s[40:43], s48 offen offset:1024 sc1 lds
    buffer_load_dwordx4 v22, s[40:43], s48 offen offset:2048 sc1 lds
    buffer_load_dwordx4 v23, s[40:43], s48 offen offset:3072 sc1 lds
    s_add_u32 m0, s18, 131072
    s_add_u32 s48, s19, 32768
    buffer_load_dwordx4 v20, s[40:43], s48 offen offset:0 sc1 lds
    buffer_load_dwordx4 v21, s[40:43], s48 offen offset:1024 sc1 lds
    buffer_load_dwordx4 v22, s[40:43], s48 offen offset:2048 sc1 lds
    buffer_load_dwordx4 v23, s[40:43], s48 offen offset:3072 sc1 lds
    s_cmp_lg_u32 s23, 0
    s_cbranch_scc1 L_par1_10
    s_waitcnt vmcnt(8)
    s_waitcnt lgkmcnt(0)
    s_barrier
    ds_read_b64_tr_b16 v[128:129], v10 offset:0
    ds_read_b64_tr_b16 v[130:131], v10 offset:256
    ds_read_b64_tr_b16 v[132:133], v11 offset:0
    ds_read_b64_tr_b16 v[134:135], v11 offset:256
    ds_read_b64_tr_b16 v[136:137], v10 offset:8192
    ds_read_b64_tr_b16 v[138:139], v10 offset:8448
    ds_read_b64_tr_b16 v[140:141], v11 offset:8192
    ds_read_b64_tr_b16 v[142:143], v11 offset:8448
    ds_read_b128 v[32:35], v2 offset:0
    ds_read_b128 v[36:39], v2 offset:16384
    ds_read_b128 v[40:43], v2 offset:32768
    ds_read_b128 v[44:47], v2 offset:49152
    ds_read_b128 v[48:51], v12 offset:0
    ds_read_b128 v[52:55], v12 offset:16384
    ds_read_b128 v[112:115], v2 offset:1024
    ds_read_b128 v[116:119], v2 offset:17408
    s_add_u32 m0, s18, 147456
    s_add_u32 s48, s19, 49152
    buffer_load_dwordx4 v20, s[40:43], s48 offen offset:0 sc1 lds
    buffer_load_dwordx4 v21, s[40:43], s48 offen offset:1024 sc1 lds
    buffer_load_dwordx4 v22, s[40:43], s48 offen offset:2048 sc1 lds
    buffer_load_dwordx4 v23, s[40:43], s48 offen offset:3072 sc1 lds
    s_lshl_b32 s49, s66, 2
    s_add_u32 s49, s49, s44
    s_lshl_b32 s49, s49, 2
    s_add_u32 s49, s49, 294912
    s_add_u32 s50, s49, 4096
    v_lshlrev_b32_e64 v16, 8, v3
    buffer_load_dword v18, v16, s[40:43], s49 offen sc1
    buffer_load_dword v19, v16, s[40:43], s50 offen sc1
    v_add_u32 v8, 131072, v2
    s_waitcnt lgkmcnt(8)
    v_mfma_f32_16x16x32_bf16 v[56:59], v[128:131], v[128:131], 0
    v_mfma_f32_16x16x32_bf16 v[60:63], v[132:135], v[132:135], 0
    v_mfma_f32_16x16x32_bf16 v[56:59], v[136:139], v[136:139], v[56:59]
    v_mfma_f32_16x16x32_bf16 v[60:63], v[140:143], v[140:143], v[60:63]
    s_waitcnt vmcnt(10)
    s_barrier
    s_waitcnt lgkmcnt(7)
    v_mfma_f32_16x16x32_bf16 v[64:67], v[128:131], v[32:35], 0
    s_add_u32 m0, s18, 98304
    s_add_u32 s48, s19, 65536
    v_mfma_f32_16x16x32_bf16 v[68:71], v[132:135], v[32:35], 0
    ds_read_b128 v[120:123], v2 offset:33792
    s_waitcnt lgkmcnt(7)
    v_mfma_f32_16x16x32_bf16 v[72:75], v[128:131], v[36:39], 0
    buffer_load_dwordx4 v20, s[40:43], s48 offen offset:0 sc1 lds
    buffer_load_dwordx4 v21, s[40:43], s48 offen offset:1024 sc1 lds
    v_mfma_f32_16x16x32_bf16 v[76:79], v[132:135], v[36:39], 0
    ds_read_b128 v[32:35], v2 offset:50176
    s_waitcnt lgkmcnt(7)
    v_mfma_f32_16x16x32_bf16 v[80:83], v[128:131], v[40:43], 0
    ds_read_b64_tr_b16 v[144:145], v10 offset:16384
    v_mfma_f32_16x16x32_bf16 v[84:87], v[132:135], v[40:43], 0
    ds_read_b128 v[36:39], v12 offset:1024
    s_waitcnt lgkmcnt(8)
    v_mfma_f32_16x16x32_bf16 v[88:91], v[128:131], v[44:47], 0
    ds_read_b64_tr_b16 v[146:147], v10 offset:16640
    v_mfma_f32_16x16x32_bf16 v[92:95], v[132:135], v[44:47], 0
    ds_read_b128 v[40:43], v12 offset:17408
    s_waitcnt lgkmcnt(9)
    v_mfma_f32_16x16x32_bf16 v[96:99], v[48:51], v[128:131], 0
    ds_read_b64_tr_b16 v[148:149], v11 offset:16384
    v_mfma_f32_16x16x32_bf16 v[104:107], v[48:51], v[132:135], 0
    ds_read_b128 v[44:47], v2 offset:2048
    s_waitcnt lgkmcnt(10)
    v_mfma_f32_16x16x32_bf16 v[100:103], v[52:55], v[128:131], 0
    ds_read_b64_tr_b16 v[150:151], v11 offset:16640
    v_mfma_f32_16x16x32_bf16 v[108:111], v[52:55], v[132:135], 0
    ds_read_b128 v[48:51], v2 offset:18432
    s_waitcnt lgkmcnt(11)
    v_mfma_f32_16x16x32_bf16 v[64:67], v[136:139], v[112:115], v[64:67]
    ds_read_b64_tr_b16 v[152:153], v10 offset:24576
    v_mfma_f32_16x16x32_bf16 v[68:71], v[140:143], v[112:115], v[68:71]
    ds_read_b128 v[52:55], v2 offset:34816
    s_waitcnt lgkmcnt(12)
    v_mfma_f32_16x16x32_bf16 v[72:75], v[136:139], v[116:119], v[72:75]
    ds_read_b64_tr_b16 v[154:155], v10 offset:24832
    v_mfma_f32_16x16x32_bf16 v[76:79], v[140:143], v[116:119], v[76:79]
    ds_read_b128 v[112:115], v2 offset:51200
    s_waitcnt lgkmcnt(13)
    v_mfma_f32_16x16x32_bf16 v[80:83], v[136:139], v[120:123], v[80:83]
    ds_read_b64_tr_b16 v[156:157], v11 offset:24576
    v_mfma_f32_16x16x32_bf16 v[84:87], v[140:143], v[120:123], v[84:87]
    ds_read_b128 v[116:119], v12 offset:2048
    s_waitcnt lgkmcnt(14)
    v_mfma_f32_16x16x32_bf16 v[88:91], v[136:139], v[32:35], v[88:91]
    ds_read_b64_tr_b16 v[158:159], v11 offset:24832
    buffer_load_dwordx4 v22, s[40:43], s48 offen offset:2048 sc1 lds
    v_mfma_f32_16x16x32_bf16 v[92:95], v[140:143], v[32:35], v[92:95]
    ds_read_b128 v[120:123], v12 offset:18432
    s_waitcnt lgkmcnt(14)
    v_mfma_f32_16x16x32_bf16 v[96:99], v[36:39], v[136:139], v[96:99]
    buffer_load_dwordx4 v23, s[40:43], s48 offen offset:3072 sc1 lds
    v_mfma_f32_16x16x32_bf16 v[104:107], v[36:39], v[140:143], v[104:107]
    ds_read_b128 v[32:35], v2 offset:3072
    s_waitcnt lgkmcnt(13)
    v_mfma_f32_16x16x32_bf16 v[100:103], v[40:43], v[136:139], v[100:103]
    v_mfma_f32_16x16x32_bf16 v[108:111], v[40:43], v[140:143], v[108:111]
    ds_read_b128 v[36:39], v2 offset:19456
    s_waitcnt lgkmcnt(3)
    v_mfma_f32_16x16x32_bf16 v[56:59], v[144:147], v[144:147], v[56:59]
    v_mfma_f32_16x16x32_bf16 v[60:63], v[148:151], v[148:151], v[60:63]
    v_mfma_f32_16x16x32_bf16 v[56:59], v[152:155], v[152:155], v[56:59]
    v_mfma_f32_16x16x32_bf16 v[60:63], v[156:159], v[156:159], v[60:63]
    s_waitcnt vmcnt(10)
    s_barrier
    s_waitcnt lgkmcnt(12)
    v_mfma_f32_16x16x32_bf16 v[64:67], v[144:147], v[44:47], v[64:67]
    s_add_u32 m0, s18, 114688
    s_add_u32 s48, s19, 81920
    v_mfma_f32_16x16x32_bf16 v[68:71], v[148:151], v[44:47], v[68:71]
    ds_read_b128 v[40:43], v2 offset:35840
    s_waitcnt lgkmcnt(11)
    v_mfma_f32_16x16x32_bf16 v[72:75], v[144:147], v[48:51], v[72:75]
    buffer_load_dwordx4 v20, s[40:43], s48 offen offset:0 sc1 lds
    buffer_load_dwordx4 v21, s[40:43], s48 offen offset:1024 sc1 lds
    v_mfma_f32_16x16x32_bf16 v[76:79], v[148:151], v[48:51], v[76:79]
    ds_read_b128 v[44:47], v2 offset:52224
    s_waitcnt lgkmcnt(10)
    v_mfma_f32_16x16x32_bf16 v[80:83], v[144:147], v[52:55], v[80:83]
    ds_read_b64_tr_b16 v[160:161], v10 offset:32768
    v_mfma_f32_16x16x32_bf16 v[84:87], v[148:151], v[52:55], v[84:87]
    ds_read_b128 v[48:51], v12 offset:3072
    s_waitcnt lgkmcnt(10)
    v_mfma_f32_16x16x32_bf16 v[88:91], v[144:147], v[112:115], v[88:91]
    ds_read_b64_tr_b16 v[162:163], v10 offset:33024
    v_mfma_f32_16x16x32_bf16 v[92:95], v[148:151], v[112:115], v[92:95]
    ds_read_b128 v[52:55], v12 offset:19456
    s_waitcnt lgkmcnt(10)
    v_mfma_f32_16x16x32_bf16 v[96:99], v[116:119], v[144:147], v[96:99]
    ds_read_b64_tr_b16 v[164:165], v11 offset:32768
    v_mfma_f32_16x16x32_bf16 v[104:107], v[116:119], v[148:151], v[104:107]
    ds_read_b128 v[112:115], v2 offset:4096
    s_waitcnt lgkmcnt(10)
    v_mfma_f32_16x16x32_bf16 v[100:103], v[120:123], v[144:147], v[100:103]
    ds_read_b64_tr_b16 v[166:167], v11 offset:33024
    v_mfma_f32_16x16x32_bf16 v[108:111], v[120:123], v[148:151], v[108:111]
    ds_read_b128 v[116:119], v2 offset:20480
    s_waitcnt lgkmcnt(11)
    v_mfma_f32_16x16x32_bf16 v[64:67], v[152:155], v[32:35], v[64:67]
    ds_read_b64_tr_b16 v[168:169], v10 offset:40960
    v_mfma_f32_16x16x32_bf16 v[68:71], v[156:159], v[32:35], v[68:71]
    ds_read_b128 v[120:123], v2 offset:36864
    s_waitcnt lgkmcnt(12)
    v_mfma_f32_16x16x32_bf16 v[72:75], v[152:155], v[36:39], v[72:75]
    ds_read_b64_tr_b16 v[170:171], v10 offset:41216
    v_mfma_f32_16x16x32_bf16 v[76:79], v[156:159], v[36:39], v[76:79]
    ds_read_b128 v[32:35], v2 offset:53248
    s_waitcnt lgkmcnt(13)
    v_mfma_f32_16x16x32_bf16 v[80:83], v[152:155], v[40:43], v[80:83]
    ds_read_b64_tr_b16 v[172:173], v11 offset:40960
    v_mfma_f32_16x16x32_bf16 v[84:87], v[156:159], v[40:43], v[84:87]
    ds_read_b128 v[36:39], v12 offset:4096
    s_waitcnt lgkmcnt(14)
    v_mfma_f32_16x16x32_bf16 v[88:91], v[152:155], v[44:47], v[88:91]
    ds_read_b64_tr_b16 v[174:175], v11 offset:41216
    buffer_load_dwordx4 v22, s[40:43], s48 offen offset:2048 sc1 lds
    v_mfma_f32_16x16x32_bf16 v[92:95], v[156:159], v[44:47], v[92:95]
    ds_read_b128 v[40:43], v12 offset:20480
    s_waitcnt lgkmcnt(14)
    v_mfma_f32_16x16x32_bf16 v[96:99], v[48:51], v[152:155], v[96:99]
    buffer_load_dwordx4 v23, s[40:43], s48 offen offset:3072 sc1 lds
    v_mfma_f32_16x16x32_bf16 v[104:107], v[48:51], v[156:159], v[104:107]
    ds_read_b128 v[44:47], v2 offset:5120
    s_waitcnt lgkmcnt(13)
    v_mfma_f32_16x16x32_bf16 v[100:103], v[52:55], v[152:155], v[100:103]
    v_mfma_f32_16x16x32_bf16 v[108:111], v[52:55], v[156:159], v[108:111]
    ds_read_b128 v[48:51], v2 offset:21504
    s_waitcnt lgkmcnt(3)
    v_mfma_f32_16x16x32_bf16 v[56:59], v[160:163], v[160:163], v[56:59]
    v_mfma_f32_16x16x32_bf16 v[60:63], v[164:167], v[164:167], v[60:63]
    v_mfma_f32_16x16x32_bf16 v[56:59], v[168:171], v[168:171], v[56:59]
    v_mfma_f32_16x16x32_bf16 v[60:63], v[172:175], v[172:175], v[60:63]
    s_waitcnt vmcnt(10)
    s_barrier
    s_waitcnt lgkmcnt(12)
    v_mfma_f32_16x16x32_bf16 v[64:67], v[160:163], v[112:115], v[64:67]
    s_add_u32 m0, s18, 131072
    s_add_u32 s48, s19, 98304
    v_mfma_f32_16x16x32_bf16 v[68:71], v[164:167], v[112:115], v[68:71]
    ds_read_b128 v[52:55], v2 offset:37888
    s_waitcnt lgkmcnt(11)
    v_mfma_f32_16x16x32_bf16 v[72:75], v[160:163], v[116:119], v[72:75]
    buffer_load_dwordx4 v20, s[40:43], s48 offen offset:0 sc1 lds
    buffer_load_dwordx4 v21, s[40:43], s48 offen offset:1024 sc1 lds
    v_mfma_f32_16x16x32_bf16 v[76:79], v[164:167], v[116:119], v[76:79]
    ds_read_b128 v[112:115], v2 offset:54272
    s_waitcnt lgkmcnt(10)
    v_mfma_f32_16x16x32_bf16 v[80:83], v[160:163], v[120:123], v[80:83]
    ds_read_b64_tr_b16 v[176:177], v10 offset:49152
    v_mfma_f32_16x16x32_bf16 v[84:87], v[164:167], v[120:123], v[84:87]
    ds_read_b128 v[116:119], v12 offset:5120
    s_waitcnt lgkmcnt(10)
    v_mfma_f32_16x16x32_bf16 v[88:91], v[160:163], v[32:35], v[88:91]
    ds_read_b64_tr_b16 v[178:179], v10 offset:49408
    v_mfma_f32_16x16x32_bf16 v[92:95], v[164:167], v[32:35], v[92:95]
    ds_read_b128 v[120:123], v12 offset:21504
    s_waitcnt lgkmcnt(10)
    v_mfma_f32_16x16x32_bf16 v[96:99], v[36:39], v[160:163], v[96:99]
    ds_read_b64_tr_b16 v[180:181], v11 offset:49152
    v_mfma_f32_16x16x32_bf16 v[104:107], v[36:39], v[164:167], v[104:107]
    ds_read_b128 v[32:35], v2 offset:6144
    s_waitcnt lgkmcnt(10)
    v_mfma_f32_16x16x32_bf16 v[100:103], v[40:43], v[160:163], v[100:103]
    ds_read_b64_tr_b16 v[182:183], v11 offset:49408
    v_mfma_f32_16x16x32_bf16 v[108:111], v[40:43], v[164:167], v[108:111]
    ds_read_b128 v[36:39], v2 offset:22528
    s_waitcnt lgkmcnt(11)
    v_mfma_f32_16x16x32_bf16 v[64:67], v[168:171], v[44:47], v[64:67]
    ds_read_b64_tr_b16 v[184:185], v10 offset:57344
    v_mfma_f32_16x16x32_bf16 v[68:71], v[172:175], v[44:47], v[68:71]
    ds_read_b128 v[40:43], v2 offset:38912
    s_waitcnt lgkmcnt(12)
    v_mfma_f32_16x16x32_bf16 v[72:75], v[168:171], v[48:51], v[72:75]
    ds_read_b64_tr_b16 v[186:187], v10 offset:57600
    v_mfma_f32_16x16x32_bf16 v[76:79], v[172:175], v[48:51], v[76:79]
    ds_read_b128 v[44:47], v2 offset:55296
    s_waitcnt lgkmcnt(13)
    v_mfma_f32_16x16x32_bf16 v[80:83], v[168:171], v[52:55], v[80:83]
    ds_read_b64_tr_b16 v[188:189], v11 offset:57344
    v_mfma_f32_16x16x32_bf16 v[84:87], v[172:175], v[52:55], v[84:87]
    ds_read_b128 v[48:51], v12 offset:6144
    s_waitcnt lgkmcnt(14)
    v_mfma_f32_16x16x32_bf16 v[88:91], v[168:171], v[112:115], v[88:91]
    ds_read_b64_tr_b16 v[190:191], v11 offset:57600
    buffer_load_dwordx4 v22, s[40:43], s48 offen offset:2048 sc1 lds
    v_mfma_f32_16x16x32_bf16 v[92:95], v[172:175], v[112:115], v[92:95]
    ds_read_b128 v[52:55], v12 offset:22528
    s_waitcnt lgkmcnt(14)
    v_mfma_f32_16x16x32_bf16 v[96:99], v[116:119], v[168:171], v[96:99]
    buffer_load_dwordx4 v23, s[40:43], s48 offen offset:3072 sc1 lds
    v_mfma_f32_16x16x32_bf16 v[104:107], v[116:119], v[172:175], v[104:107]
    ds_read_b128 v[112:115], v2 offset:7168
    s_waitcnt lgkmcnt(13)
    v_mfma_f32_16x16x32_bf16 v[100:103], v[120:123], v[168:171], v[100:103]
    v_mfma_f32_16x16x32_bf16 v[108:111], v[120:123], v[172:175], v[108:111]
    ds_read_b128 v[116:119], v2 offset:23552
    s_waitcnt lgkmcnt(3)
    v_mfma_f32_16x16x32_bf16 v[56:59], v[176:179], v[176:179], v[56:59]
    v_mfma_f32_16x16x32_bf16 v[60:63], v[180:183], v[180:183], v[60:63]
    v_mfma_f32_16x16x32_bf16 v[56:59], v[184:187], v[184:187], v[56:59]
    v_mfma_f32_16x16x32_bf16 v[60:63], v[188:191], v[188:191], v[60:63]
    s_waitcnt vmcnt(8)
    s_barrier
    s_waitcnt lgkmcnt(12)
    v_mfma_f32_16x16x32_bf16 v[64:67], v[176:179], v[32:35], v[64:67]
    s_add_u32 m0, s18, 147456
    s_add_u32 s48, s19, 114688
    v_mfma_f32_16x16x32_bf16 v[68:71], v[180:183], v[32:35], v[68:71]
    ds_read_b128 v[120:123], v2 offset:39936
    s_waitcnt lgkmcnt(11)
    v_mfma_f32_16x16x32_bf16 v[72:75], v[176:179], v[36:39], v[72:75]
    buffer_load_dwordx4 v20, s[40:43], s48 offen offset:0 sc1 lds
    buffer_load_dwordx4 v21, s[40:43], s48 offen offset:1024 sc1 lds
    v_mfma_f32_16x16x32_bf16 v[76:79], v[180:183], v[36:39], v[76:79]
    ds_read_b128 v[32:35], v2 offset:56320
    s_waitcnt lgkmcnt(10)
    v_mfma_f32_16x16x32_bf16 v[80:83], v[176:179], v[40:43], v[80:83]
    ds_read_b64_tr_b16 v[192:193], v10 offset:0
    v_mfma_f32_16x16x32_bf16 v[84:87], v[180:183], v[40:43], v[84:87]
    ds_read_b128 v[36:39], v12 offset:7168
    s_waitcnt lgkmcnt(10)
    v_mfma_f32_16x16x32_bf16 v[88:91], v[176:179], v[44:47], v[88:91]
    ds_read_b64_tr_b16 v[194:195], v10 offset:256
    v_mfma_f32_16x16x32_bf16 v[92:95], v[180:183], v[44:47], v[92:95]
    ds_read_b128 v[40:43], v12 offset:23552
    s_waitcnt lgkmcnt(10)
    v_mfma_f32_16x16x32_bf16 v[96:99], v[48:51], v[176:179], v[96:99]
    ds_read_b64_tr_b16 v[196:197], v11 offset:0
    v_mfma_f32_16x16x32_bf16 v[104:107], v[48:51], v[180:183], v[104:107]
    ds_read_b128 v[44:47], v2 offset:8192
    s_waitcnt lgkmcnt(10)
    v_mfma_f32_16x16x32_bf16 v[100:103], v[52:55], v[176:179], v[100:103]
    ds_read_b64_tr_b16 v[198:199], v11 offset:256
    v_mfma_f32_16x16x32_bf16 v[108:111], v[52:55], v[180:183], v[108:111]
    ds_read_b128 v[48:51], v2 offset:24576
    s_waitcnt lgkmcnt(11)
    v_mfma_f32_16x16x32_bf16 v[64:67], v[184:187], v[112:115], v[64:67]
    ds_read_b64_tr_b16 v[200:201], v10 offset:8192
    v_mfma_f32_16x16x32_bf16 v[68:71], v[188:191], v[112:115], v[68:71]
    ds_read_b128 v[52:55], v2 offset:40960
    s_waitcnt lgkmcnt(12)
    v_mfma_f32_16x16x32_bf16 v[72:75], v[184:187], v[116:119], v[72:75]
    ds_read_b64_tr_b16 v[202:203], v10 offset:8448
    v_mfma_f32_16x16x32_bf16 v[76:79], v[188:191], v[116:119], v[76:79]
    ds_read_b128 v[112:115], v2 offset:57344
    s_waitcnt lgkmcnt(13)
    v_mfma_f32_16x16x32_bf16 v[80:83], v[184:187], v[120:123], v[80:83]
    ds_read_b64_tr_b16 v[204:205], v11 offset:8192
    v_mfma_f32_16x16x32_bf16 v[84:87], v[188:191], v[120:123], v[84:87]
    ds_read_b128 v[116:119], v12 offset:8192
    s_waitcnt lgkmcnt(14)
    v_mfma_f32_16x16x32_bf16 v[88:91], v[184:187], v[32:35], v[88:91]
    ds_read_b64_tr_b16 v[206:207], v11 offset:8448
    buffer_load_dwordx4 v22, s[40:43], s48 offen offset:2048 sc1 lds
    v_mfma_f32_16x16x32_bf16 v[92:95], v[188:191], v[32:35], v[92:95]
    ds_read_b128 v[120:123], v12 offset:24576
    s_waitcnt lgkmcnt(14)
    v_mfma_f32_16x16x32_bf16 v[96:99], v[36:39], v[184:187], v[96:99]
    buffer_load_dwordx4 v23, s[40:43], s48 offen offset:3072 sc1 lds
    v_mfma_f32_16x16x32_bf16 v[104:107], v[36:39], v[188:191], v[104:107]
    ds_read_b128 v[32:35], v2 offset:9216
    s_waitcnt lgkmcnt(13)
    v_mfma_f32_16x16x32_bf16 v[100:103], v[40:43], v[184:187], v[100:103]
    v_mfma_f32_16x16x32_bf16 v[108:111], v[40:43], v[188:191], v[108:111]
    ds_read_b128 v[36:39], v2 offset:25600
    s_waitcnt lgkmcnt(3)
    v_mfma_f32_16x16x32_bf16 v[56:59], v[192:195], v[192:195], v[56:59]
    v_mfma_f32_16x16x32_bf16 v[60:63], v[196:199], v[196:199], v[60:63]
    v_mfma_f32_16x16x32_bf16 v[56:59], v[200:203], v[200:203], v[56:59]
    v_mfma_f32_16x16x32_bf16 v[60:63], v[204:207], v[204:207], v[60:63]
    s_waitcnt vmcnt(8)
    s_barrier
    s_waitcnt lgkmcnt(12)
    v_mfma_f32_16x16x32_bf16 v[64:67], v[192:195], v[44:47], v[64:67]
    s_lshl_b32 s51, s44, 12
    s_add_u32 m0, s51, 98304
    v_mfma_f32_16x16x32_bf16 v[68:71], v[196:199], v[44:47], v[68:71]
    ds_read_b128 v[40:43], v2 offset:41984
    s_waitcnt lgkmcnt(11)
    v_mfma_f32_16x16x32_bf16 v[72:75], v[192:195], v[48:51], v[72:75]
    s_add_u32 s51, s51, s20
    buffer_load_dwordx4 v2, s[40:43], s51 offen sc1 lds
    v_mfma_f32_16x16x32_bf16 v[76:79], v[196:199], v[48:51], v[76:79]
    ds_read_b128 v[44:47], v2 offset:58368
    s_waitcnt lgkmcnt(10)
    v_mfma_f32_16x16x32_bf16 v[80:83], v[192:195], v[52:55], v[80:83]
    buffer_load_dwordx4 v2, s[40:43], s51 offen offset:1024 sc1 lds
    ds_read_b64_tr_b16 v[208:209], v10 offset:16384
    v_mfma_f32_16x16x32_bf16 v[84:87], v[196:199], v[52:55], v[84:87]
    ds_read_b128 v[48:51], v12 offset:9216
    s_waitcnt lgkmcnt(10)
    v_mfma_f32_16x16x32_bf16 v[88:91], v[192:195], v[112:115], v[88:91]
    ds_read_b64_tr_b16 v[210:211], v10 offset:16640
    v_mfma_f32_16x16x32_bf16 v[92:95], v[196:199], v[112:115], v[92:95]
    ds_read_b128 v[52:55], v12 offset:25600
    s_waitcnt lgkmcnt(10)
    v_mfma_f32_16x16x32_bf16 v[96:99], v[116:119], v[192:195], v[96:99]
    ds_read_b64_tr_b16 v[212:213], v11 offset:16384
    v_mfma_f32_16x16x32_bf16 v[104:107], v[116:119], v[196:199], v[104:107]
    ds_read_b128 v[112:115], v2 offset:10240
    s_waitcnt lgkmcnt(10)
    v_mfma_f32_16x16x32_bf16 v[100:103], v[120:123], v[192:195], v[100:103]
    ds_read_b64_tr_b16 v[214:215], v11 offset:16640
    v_mfma_f32_16x16x32_bf16 v[108:111], v[120:123], v[196:199], v[108:111]
    ds_read_b128 v[116:119], v2 offset:26624
    s_waitcnt lgkmcnt(11)
    v_mfma_f32_16x16x32_bf16 v[64:67], v[200:203], v[32:35], v[64:67]
    ds_read_b64_tr_b16 v[216:217], v10 offset:24576
    v_mfma_f32_16x16x32_bf16 v[68:71], v[204:207], v[32:35], v[68:71]
    ds_read_b128 v[120:123], v2 offset:43008
    s_waitcnt lgkmcnt(12)
    v_mfma_f32_16x16x32_bf16 v[72:75], v[200:203], v[36:39], v[72:75]
    ds_read_b64_tr_b16 v[218:219], v10 offset:24832
    v_mfma_f32_16x16x32_bf16 v[76:79], v[204:207], v[36:39], v[76:79]
    ds_read_b128 v[32:35], v2 offset:59392
    s_waitcnt lgkmcnt(13)
    v_mfma_f32_16x16x32_bf16 v[80:83], v[200:203], v[40:43], v[80:83]
    ds_read_b64_tr_b16 v[220:221], v11 offset:24576
    v_mfma_f32_16x16x32_bf16 v[84:87], v[204:207], v[40:43], v[84:87]
    ds_read_b128 v[36:39], v12 offset:10240
    s_waitcnt lgkmcnt(14)
    v_mfma_f32_16x16x32_bf16 v[88:91], v[200:203], v[44:47], v[88:91]
    ds_read_b64_tr_b16 v[222:223], v11 offset:24832
    buffer_load_dwordx4 v2, s[40:43], s51 offen offset:2048 sc1 lds
    v_mfma_f32_16x16x32_bf16 v[92:95], v[204:207], v[44:47], v[92:95]
    ds_read_b128 v[40:43], v12 offset:26624
    s_waitcnt lgkmcnt(14)
    v_mfma_f32_16x16x32_bf16 v[96:99], v[48:51], v[200:203], v[96:99]
    buffer_load_dwordx4 v2, s[40:43], s51 offen offset:3072 sc1 lds
    v_mfma_f32_16x16x32_bf16 v[104:107], v[48:51], v[204:207], v[104:107]
    ds_read_b128 v[44:47], v2 offset:11264
    s_waitcnt lgkmcnt(13)
    v_mfma_f32_16x16x32_bf16 v[100:103], v[52:55], v[200:203], v[100:103]
    v_mfma_f32_16x16x32_bf16 v[108:111], v[52:55], v[204:207], v[108:111]
    ds_read_b128 v[48:51], v2 offset:27648
    s_waitcnt lgkmcnt(3)
    v_mfma_f32_16x16x32_bf16 v[56:59], v[208:211], v[208:211], v[56:59]
    v_mfma_f32_16x16x32_bf16 v[60:63], v[212:215], v[212:215], v[60:63]
    v_mfma_f32_16x16x32_bf16 v[56:59], v[216:219], v[216:219], v[56:59]
    v_mfma_f32_16x16x32_bf16 v[60:63], v[220:223], v[220:223], v[60:63]
    s_waitcnt vmcnt(8)
    s_barrier
    s_waitcnt lgkmcnt(12)
    v_mfma_f32_16x16x32_bf16 v[64:67], v[208:211], v[112:115], v[64:67]
    s_lshl_b32 s51, s44, 12
    s_add_u32 m0, s51, 114688
    v_mfma_f32_16x16x32_bf16 v[68:71], v[212:215], v[112:115], v[68:71]
    ds_read_b128 v[52:55], v2 offset:44032
    s_waitcnt lgkmcnt(11)
    v_mfma_f32_16x16x32_bf16 v[72:75], v[208:211], v[116:119], v[72:75]
    s_add_u32 s51, s51, s21
    buffer_load_dwordx4 v2, s[40:43], s51 offen sc1 lds
    v_mfma_f32_16x16x32_bf16 v[76:79], v[212:215], v[116:119], v[76:79]
    ds_read_b128 v[112:115], v2 offset:60416
    s_waitcnt lgkmcnt(10)
    v_mfma_f32_16x16x32_bf16 v[80:83], v[208:211], v[120:123], v[80:83]
    buffer_load_dwordx4 v2, s[40:43], s51 offen offset:1024 sc1 lds
    ds_read_b64_tr_b16 v[224:225], v10 offset:32768
    v_mfma_f32_16x16x32_bf16 v[84:87], v[212:215], v[120:123], v[84:87]
    ds_read_b128 v[116:119], v12 offset:11264
    s_waitcnt lgkmcnt(10)
    v_mfma_f32_16x16x32_bf16 v[88:91], v[208:211], v[32:35], v[88:91]
    ds_read_b64_tr_b16 v[226:227], v10 offset:33024
    v_mfma_f32_16x16x32_bf16 v[92:95], v[212:215], v[32:35], v[92:95]
    ds_read_b128 v[120:123], v12 offset:27648
    s_waitcnt lgkmcnt(10)
    v_mfma_f32_16x16x32_bf16 v[96:99], v[36:39], v[208:211], v[96:99]
    ds_read_b64_tr_b16 v[228:229], v11 offset:32768
    v_mfma_f32_16x16x32_bf16 v[104:107], v[36:39], v[212:215], v[104:107]
    ds_read_b128 v[32:35], v2 offset:12288
    s_waitcnt lgkmcnt(10)
    v_mfma_f32_16x16x32_bf16 v[100:103], v[40:43], v[208:211], v[100:103]
    ds_read_b64_tr_b16 v[230:231], v11 offset:33024
    v_mfma_f32_16x16x32_bf16 v[108:111], v[40:43], v[212:215], v[108:111]
    ds_read_b128 v[36:39], v2 offset:28672
    s_waitcnt lgkmcnt(11)
    v_mfma_f32_16x16x32_bf16 v[64:67], v[216:219], v[44:47], v[64:67]
    ds_read_b64_tr_b16 v[232:233], v10 offset:40960
    v_mfma_f32_16x16x32_bf16 v[68:71], v[220:223], v[44:47], v[68:71]
    ds_read_b128 v[40:43], v2 offset:45056
    s_waitcnt lgkmcnt(12)
    v_mfma_f32_16x16x32_bf16 v[72:75], v[216:219], v[48:51], v[72:75]
    ds_read_b64_tr_b16 v[234:235], v10 offset:41216
    v_mfma_f32_16x16x32_bf16 v[76:79], v[220:223], v[48:51], v[76:79]
    ds_read_b128 v[44:47], v2 offset:61440
    s_waitcnt lgkmcnt(13)
    v_mfma_f32_16x16x32_bf16 v[80:83], v[216:219], v[52:55], v[80:83]
    ds_read_b64_tr_b16 v[236:237], v11 offset:40960
    v_mfma_f32_16x16x32_bf16 v[84:87], v[220:223], v[52:55], v[84:87]
    ds_read_b128 v[48:51], v12 offset:12288
    s_waitcnt lgkmcnt(14)
    v_mfma_f32_16x16x32_bf16 v[88:91], v[216:219], v[112:115], v[88:91]
    ds_read_b64_tr_b16 v[238:239], v11 offset:41216
    buffer_load_dwordx4 v2, s[40:43], s51 offen offset:2048 sc1 lds
    v_mfma_f32_16x16x32_bf16 v[92:95], v[220:223], v[112:115], v[92:95]
    ds_read_b128 v[52:55], v12 offset:28672
    s_waitcnt lgkmcnt(14)
    v_mfma_f32_16x16x32_bf16 v[96:99], v[116:119], v[216:219], v[96:99]
    buffer_load_dwordx4 v2, s[40:43], s51 offen offset:3072 sc1 lds
    v_mfma_f32_16x16x32_bf16 v[104:107], v[116:119], v[220:223], v[104:107]
    ds_read_b128 v[112:115], v2 offset:13312
    s_waitcnt lgkmcnt(13)
    v_mfma_f32_16x16x32_bf16 v[100:103], v[120:123], v[216:219], v[100:103]
    v_mfma_f32_16x16x32_bf16 v[108:111], v[120:123], v[220:223], v[108:111]
    ds_read_b128 v[116:119], v2 offset:29696
    s_waitcnt lgkmcnt(3)
    v_mfma_f32_16x16x32_bf16 v[56:59], v[224:227], v[224:227], v[56:59]
    v_mfma_f32_16x16x32_bf16 v[60:63], v[228:231], v[228:231], v[60:63]
    v_mfma_f32_16x16x32_bf16 v[56:59], v[232:235], v[232:235], v[56:59]
    v_mfma_f32_16x16x32_bf16 v[60:63], v[236:239], v[236:239], v[60:63]
    s_waitcnt vmcnt(8)
    s_barrier
    s_waitcnt lgkmcnt(12)
    v_mfma_f32_16x16x32_bf16 v[64:67], v[224:227], v[32:35], v[64:67]
    s_lshl_b32 s51, s44, 12
    s_add_u32 m0, s51, 131072
    v_mfma_f32_16x16x32_bf16 v[68:71], v[228:231], v[32:35], v[68:71]
    ds_read_b128 v[120:123], v2 offset:46080
    s_waitcnt lgkmcnt(11)
    v_mfma_f32_16x16x32_bf16 v[72:75], v[224:227], v[36:39], v[72:75]
    s_add_u32 s51, s51, s22
    buffer_load_dwordx4 v2, s[40:43], s51 offen sc1 lds
    v_mfma_f32_16x16x32_bf16 v[76:79], v[228:231], v[36:39], v[76:79]
    ds_read_b128 v[32:35], v2 offset:62464
    s_waitcnt lgkmcnt(10)
    v_mfma_f32_16x16x32_bf16 v[80:83], v[224:227], v[40:43], v[80:83]
    buffer_load_dwordx4 v2, s[40:43], s51 offen offset:1024 sc1 lds
    ds_read_b64_tr_b16 v[240:241], v10 offset:49152
    v_mfma_f32_16x16x32_bf16 v[84:87], v[228:231], v[40:43], v[84:87]
    ds_read_b128 v[36:39], v12 offset:13312
    s_waitcnt lgkmcnt(10)
    v_mfma_f32_16x16x32_bf16 v[88:91], v[224:227], v[44:47], v[88:91]
    ds_read_b64_tr_b16 v[242:243], v10 offset:49408
    v_mfma_f32_16x16x32_bf16 v[92:95], v[228:231], v[44:47], v[92:95]
    ds_read_b128 v[40:43], v12 offset:29696
    s_waitcnt lgkmcnt(10)
    v_mfma_f32_16x16x32_bf16 v[96:99], v[48:51], v[224:227], v[96:99]
    ds_read_b64_tr_b16 v[244:245], v11 offset:49152
    v_mfma_f32_16x16x32_bf16 v[104:107], v[48:51], v[228:231], v[104:107]
    ds_read_b128 v[44:47], v2 offset:14336
    s_waitcnt lgkmcnt(10)
    v_mfma_f32_16x16x32_bf16 v[100:103], v[52:55], v[224:227], v[100:103]
    ds_read_b64_tr_b16 v[246:247], v11 offset:49408
    v_mfma_f32_16x16x32_bf16 v[108:111], v[52:55], v[228:231], v[108:111]
    ds_read_b128 v[48:51], v2 offset:30720
    s_waitcnt lgkmcnt(11)
    v_mfma_f32_16x16x32_bf16 v[64:67], v[232:235], v[112:115], v[64:67]
    ds_read_b64_tr_b16 v[248:249], v10 offset:57344
    v_mfma_f32_16x16x32_bf16 v[68:71], v[236:239], v[112:115], v[68:71]
    ds_read_b128 v[52:55], v2 offset:47104
    s_waitcnt lgkmcnt(12)
    v_mfma_f32_16x16x32_bf16 v[72:75], v[232:235], v[116:119], v[72:75]
    ds_read_b64_tr_b16 v[250:251], v10 offset:57600
    v_mfma_f32_16x16x32_bf16 v[76:79], v[236:239], v[116:119], v[76:79]
    ds_read_b128 v[112:115], v2 offset:63488
    s_waitcnt lgkmcnt(13)
    v_mfma_f32_16x16x32_bf16 v[80:83], v[232:235], v[120:123], v[80:83]
    ds_read_b64_tr_b16 v[252:253], v11 offset:57344
    v_mfma_f32_16x16x32_bf16 v[84:87], v[236:239], v[120:123], v[84:87]
    ds_read_b128 v[116:119], v12 offset:14336
    s_waitcnt lgkmcnt(14)
    v_mfma_f32_16x16x32_bf16 v[88:91], v[232:235], v[32:35], v[88:91]
    ds_read_b64_tr_b16 v[254:255], v11 offset:57600
    buffer_load_dwordx4 v2, s[40:43], s51 offen offset:2048 sc1 lds
    v_mfma_f32_16x16x32_bf16 v[92:95], v[236:239], v[32:35], v[92:95]
    ds_read_b128 v[120:123], v12 offset:30720
    s_waitcnt lgkmcnt(14)
    v_mfma_f32_16x16x32_bf16 v[96:99], v[36:39], v[232:235], v[96:99]
    buffer_load_dwordx4 v2, s[40:43], s51 offen offset:3072 sc1 lds
    v_mfma_f32_16x16x32_bf16 v[104:107], v[36:39], v[236:239], v[104:107]
    ds_read_b128 v[32:35], v2 offset:15360
    s_waitcnt lgkmcnt(13)
    v_mfma_f32_16x16x32_bf16 v[100:103], v[40:43], v[232:235], v[100:103]
    v_mfma_f32_16x16x32_bf16 v[108:111], v[40:43], v[236:239], v[108:111]
    ds_read_b128 v[36:39], v2 offset:31744
    s_waitcnt lgkmcnt(3)
    v_mfma_f32_16x16x32_bf16 v[56:59], v[240:243], v[240:243], v[56:59]
    v_mfma_f32_16x16x32_bf16 v[60:63], v[244:247], v[244:247], v[60:63]
    v_mfma_f32_16x16x32_bf16 v[56:59], v[248:251], v[248:251], v[56:59]
    v_mfma_f32_16x16x32_bf16 v[60:63], v[252:255], v[252:255], v[60:63]
    s_waitcnt lgkmcnt(12)
    v_mfma_f32_16x16x32_bf16 v[64:67], v[240:243], v[44:47], v[64:67]
    v_mfma_f32_16x16x32_bf16 v[68:71], v[244:247], v[44:47], v[68:71]
    ds_read_b128 v[40:43], v2 offset:48128
    s_waitcnt lgkmcnt(11)
    v_mfma_f32_16x16x32_bf16 v[72:75], v[240:243], v[48:51], v[72:75]
    v_mov_b32 v10, v18
    v_mov_b32 v11, v19
    v_mfma_f32_16x16x32_bf16 v[76:79], v[244:247], v[48:51], v[76:79]
    ds_read_b128 v[44:47], v2 offset:64512
    s_waitcnt lgkmcnt(10)
    v_mfma_f32_16x16x32_bf16 v[80:83], v[240:243], v[52:55], v[80:83]
    v_cndmask_b32 v18, v56, v57, s[4:5]
    v_cndmask_b32 v16, v58, v59, s[4:5]
    v_mfma_f32_16x16x32_bf16 v[84:87], v[244:247], v[52:55], v[84:87]
    ds_read_b128 v[48:51], v12 offset:15360
    s_waitcnt lgkmcnt(9)
    v_mfma_f32_16x16x32_bf16 v[88:91], v[240:243], v[112:115], v[88:91]
    v_cndmask_b32 v16, v18, v16, s[6:7]
    v_cndmask_b32 v18, v60, v61, s[4:5]
    v_mfma_f32_16x16x32_bf16 v[92:95], v[244:247], v[112:115], v[92:95]
    ds_read_b128 v[52:55], v12 offset:31744
    s_waitcnt lgkmcnt(8)
    v_mfma_f32_16x16x32_bf16 v[96:99], v[116:119], v[240:243], v[96:99]
    v_cndmask_b32 v17, v62, v63, s[4:5]
    v_cndmask_b32 v17, v18, v17, s[6:7]
    v_mfma_f32_16x16x32_bf16 v[104:107], v[116:119], v[244:247], v[104:107]
    ds_bpermute_b32 v56, v13, v16 offset:0
    s_waitcnt lgkmcnt(7)
    v_mfma_f32_16x16x32_bf16 v[100:103], v[120:123], v[240:243], v[100:103]
    ds_bpermute_b32 v57, v13, v16 offset:4
    ds_bpermute_b32 v58, v13, v16 offset:8
    v_mfma_f32_16x16x32_bf16 v[108:111], v[120:123], v[244:247], v[108:111]
    ds_bpermute_b32 v59, v13, v16 offset:12
    s_waitcnt lgkmcnt(9)
    v_mfma_f32_16x16x32_bf16 v[64:67], v[248:251], v[32:35], v[64:67]
    ds_bpermute_b32 v60, v13, v17 offset:0
    ds_bpermute_b32 v61, v13, v17 offset:4
    v_mfma_f32_16x16x32_bf16 v[68:71], v[252:255], v[32:35], v[68:71]
    ds_bpermute_b32 v62, v13, v17 offset:8
    s_waitcnt lgkmcnt(11)
    v_mfma_f32_16x16x32_bf16 v[72:75], v[248:251], v[36:39], v[72:75]
    ds_bpermute_b32 v63, v13, v17 offset:12
    ds_bpermute_b32 v26, v9, v16
    v_mfma_f32_16x16x32_bf16 v[76:79], v[252:255], v[36:39], v[76:79]
    ds_bpermute_b32 v28, v9, v17
    s_waitcnt lgkmcnt(13)
    v_mfma_f32_16x16x32_bf16 v[80:83], v[248:251], v[40:43], v[80:83]
    v_mov_b32 v18, 0x3f000000
    v_mov_b32 v20, 0x3b27c5ac
    v_mfma_f32_16x16x32_bf16 v[84:87], v[252:255], v[40:43], v[84:87]
    s_waitcnt lgkmcnt(12)
    v_mfma_f32_16x16x32_bf16 v[88:91], v[248:251], v[44:47], v[88:91]
    v_mfma_f32_16x16x32_bf16 v[92:95], v[252:255], v[44:47], v[92:95]
    s_waitcnt lgkmcnt(11)
    v_mfma_f32_16x16x32_bf16 v[96:99], v[48:51], v[248:251], v[96:99]
    v_mfma_f32_16x16x32_bf16 v[104:107], v[48:51], v[252:255], v[104:107]
    s_waitcnt lgkmcnt(10)
    v_mfma_f32_16x16x32_bf16 v[100:103], v[52:55], v[248:251], v[100:103]
    v_mfma_f32_16x16x32_bf16 v[108:111], v[52:55], v[252:255], v[108:111]
    s_waitcnt lgkmcnt(0)
    s_barrier
    s_lshl_b32 s49, s66, 2
    s_add_u32 s49, s49, s44
    s_add_u32 s16, s68, 0
    s_lshl_b32 s16, s16, 6
    s_add_u32 s16, s16, s49
    s_lshl_b32 s16, s16, 10
    s_add_u32 s16, s16, 13631488
    v_mov_b32 v116, -1
    v_mov_b32 v117, -1
    v_mov_b32 v118, -1
    v_mov_b32 v119, -1
    v_lshlrev_b32 v115, 3, v1
    s_lshl_b32 s53, s64, 3
    s_add_u32 s53, s53, s65
    s_lshl_b32 s53, s53, 2
    s_add_u32 s53, s53, s44
    s_mul_i32 s53, s53, 3584
    s_add_u32 s53, s53, 19922944
    buffer_store_dwordx4 v[116:119], v2, s[40:43], s53 offen offset:0 sc1
    buffer_store_dwordx4 v[116:119], v2, s[40:43], s53 offen offset:1024 sc1
    buffer_store_dwordx4 v[116:119], v2, s[40:43], s53 offen offset:2048 sc1
    buffer_store_dwordx2 v[116:117], v115, s[40:43], s53 offen offset:3072 sc1
    s_mul_i32 s69, s44, 8320
    s_add_u32 s69, s69, 0
    s_cmp_eq_u32 s44, 3
    s_cselect_b32 s69, 24960, s69
    s_mov_b32 m0, s69
    s_add_u32 s69, s44, 2
    s_and_b32 s69, s69, 3
    s_lshl_b32 s69, s69, 16
    s_add_u32 s69, s69, s61
    s_xor_b32 s69, s69, 512
    buffer_load_dwordx4 v5, s[24:27], s69 offen lds
    s_add_u32 m0, m0, 1040
    s_add_u32 s69, s69, 4096
    buffer_load_dwordx4 v5, s[24:27], s69 offen lds
    s_add_u32 m0, m0, 1040
    s_add_u32 s69, s69, 4096
    buffer_load_dwordx4 v5, s[24:27], s69 offen lds
    s_add_u32 m0, m0, 1040
    s_add_u32 s69, s69, 4096
    v_pk_fma_f32 v[56:57], v[56:57], v[18:19], v[20:21] op_sel_hi:[1,0,0]
    v_pk_fma_f32 v[58:59], v[58:59], v[18:19], v[20:21] op_sel_hi:[1,0,0]
    v_pk_fma_f32 v[60:61], v[60:61], v[18:19], v[20:21] op_sel_hi:[1,0,0]
    v_pk_fma_f32 v[62:63], v[62:63], v[18:19], v[20:21] op_sel_hi:[1,0,0]
    v_fma_f32 v26, v26, v18, v20
    v_fma_f32 v28, v28, v18, v20
    v_rsq_f32 v56, v56
    v_rsq_f32 v57, v57
    v_rsq_f32 v58, v58
    v_rsq_f32 v59, v59
    v_rsq_f32 v60, v60
    v_rsq_f32 v61, v61
    v_rsq_f32 v62, v62
    v_rsq_f32 v63, v63
    v_rsq_f32 v26, v26
    v_rsq_f32_e64 v28, v28
    v_pk_mul_f32 v[64:65], v[64:65], v[56:57]
    v_pk_mul_f32 v[68:69], v[68:69], v[60:61]
    v_pk_mul_f32 v[66:67], v[66:67], v[58:59]
    v_pk_mul_f32 v[70:71], v[70:71], v[62:63]
    v_pk_mul_f32 v[16:17], v[64:65], v[64:65]
    v_pk_mul_f32 v[20:21], v[68:69], v[68:69]
    v_pk_mul_f32 v[18:19], v[66:67], v[66:67]
    v_pk_mul_f32 v[22:23], v[70:71], v[70:71]
    v_pk_fma_f32 v[16:17], v[16:17], v[30:31], v[14:15] op_sel_hi:[1,0,0]
    v_pk_fma_f32 v[20:21], v[20:21], v[30:31], v[14:15] op_sel_hi:[1,0,0]
    v_pk_fma_f32 v[18:19], v[18:19], v[30:31], v[14:15] op_sel_hi:[1,0,0]
    v_pk_fma_f32 v[22:23], v[22:23], v[30:31], v[14:15] op_sel_hi:[1,0,0]
    v_pk_mul_f32 v[16:17], v[16:17], v[64:65]
    v_pk_mul_f32 v[20:21], v[20:21], v[68:69]
    v_pk_mul_f32 v[18:19], v[18:19], v[66:67]
    v_pk_mul_f32 v[22:23], v[22:23], v[70:71]
    v_exp_f32 v16, v16
    v_exp_f32 v20, v20
    v_exp_f32 v17, v17
    v_exp_f32 v21, v21
    v_exp_f32 v18, v18
    v_exp_f32 v22, v22
    v_exp_f32 v19, v19
    v_exp_f32 v23, v23
    v_pk_add_f32 v[16:17], v[16:17], 1.0 op_sel_hi:[1,0]
    v_pk_add_f32 v[20:21], v[20:21], 1.0 op_sel_hi:[1,0]
    v_pk_add_f32 v[18:19], v[18:19], 1.0 op_sel_hi:[1,0]
    v_pk_add_f32 v[22:23], v[22:23], 1.0 op_sel_hi:[1,0]
    v_rcp_f32 v16, v16
    v_rcp_f32 v20, v20
    v_rcp_f32 v17, v17
    v_rcp_f32 v21, v21
    v_rcp_f32 v18, v18
    v_rcp_f32 v22, v22
    v_rcp_f32 v19, v19
    v_rcp_f32 v23, v23
    v_pk_mul_f32 v[64:65], v[64:65], v[16:17]
    v_pk_mul_f32 v[68:69], v[68:69], v[20:21]
    v_pk_mul_f32 v[66:67], v[66:67], v[18:19]
    v_pk_mul_f32 v[70:71], v[70:71], v[22:23]
    buffer_load_dwordx4 v5, s[24:27], s69 offen lds
    s_add_u32 m0, m0, 1040
    s_add_u32 s69, s69, 4096
    v_pk_mul_f32 v[40:41], v[64:65], v[64:65]
    v_pk_mul_f32 v[42:43], v[66:67], v[66:67]
    v_pk_mul_f32 v[44:45], v[68:69], v[68:69]
    v_pk_mul_f32 v[46:47], v[70:71], v[70:71]
    v_pk_mul_f32 v[72:73], v[72:73], v[56:57]
    v_pk_mul_f32 v[76:77], v[76:77], v[60:61]
    v_pk_mul_f32 v[74:75], v[74:75], v[58:59]
    v_pk_mul_f32 v[78:79], v[78:79], v[62:63]
    v_pk_mul_f32 v[16:17], v[72:73], v[72:73]
    v_pk_mul_f32 v[20:21], v[76:77], v[76:77]
    v_pk_mul_f32 v[18:19], v[74:75], v[74:75]
    v_pk_mul_f32 v[22:23], v[78:79], v[78:79]
    v_pk_fma_f32 v[16:17], v[16:17], v[30:31], v[14:15] op_sel_hi:[1,0,0]
    v_pk_fma_f32 v[20:21], v[20:21], v[30:31], v[14:15] op_sel_hi:[1,0,0]
    v_pk_fma_f32 v[18:19], v[18:19], v[30:31], v[14:15] op_sel_hi:[1,0,0]
    v_pk_fma_f32 v[22:23], v[22:23], v[30:31], v[14:15] op_sel_hi:[1,0,0]
    v_pk_mul_f32 v[16:17], v[16:17], v[72:73]
    v_pk_mul_f32 v[20:21], v[20:21], v[76:77]
    v_pk_mul_f32 v[18:19], v[18:19], v[74:75]
    v_pk_mul_f32 v[22:23], v[22:23], v[78:79]
    v_exp_f32 v16, v16
    v_exp_f32 v20, v20
    v_exp_f32 v17, v17
    v_exp_f32 v21, v21
    v_exp_f32 v18, v18
    v_exp_f32 v22, v22
    v_exp_f32 v19, v19
    v_exp_f32 v23, v23
    v_pk_add_f32 v[16:17], v[16:17], 1.0 op_sel_hi:[1,0]
    v_pk_add_f32 v[20:21], v[20:21], 1.0 op_sel_hi:[1,0]
    v_pk_add_f32 v[18:19], v[18:19], 1.0 op_sel_hi:[1,0]
    v_pk_add_f32 v[22:23], v[22:23], 1.0 op_sel_hi:[1,0]
    v_rcp_f32 v16, v16
    v_rcp_f32 v20, v20
    v_rcp_f32 v17, v17
    v_rcp_f32 v21, v21
    v_rcp_f32 v18, v18
    v_rcp_f32 v22, v22
    v_rcp_f32 v19, v19
    v_rcp_f32 v23, v23
    v_pk_mul_f32 v[72:73], v[72:73], v[16:17]
    v_pk_mul_f32 v[76:77], v[76:77], v[20:21]
    v_pk_mul_f32 v[74:75], v[74:75], v[18:19]
    v_pk_mul_f32 v[78:79], v[78:79], v[22:23]
    buffer_load_dwordx4 v5, s[24:27], s69 offen lds
    s_add_u32 m0, m0, 1040
    s_add_u32 s69, s69, 4096
    v_pk_add_f32 v[32:33], v[64:65], v[72:73]
    v_pk_fma_f32 v[40:41], v[72:73], v[72:73], v[40:41]
    v_pk_add_f32 v[34:35], v[66:67], v[74:75]
    v_pk_fma_f32 v[42:43], v[74:75], v[74:75], v[42:43]
    v_pk_add_f32 v[36:37], v[68:69], v[76:77]
    v_pk_fma_f32 v[44:45], v[76:77], v[76:77], v[44:45]
    v_pk_add_f32 v[38:39], v[70:71], v[78:79]
    v_pk_fma_f32 v[46:47], v[78:79], v[78:79], v[46:47]
    v_pk_mul_f32 v[80:81], v[80:81], v[56:57]
    v_pk_mul_f32 v[84:85], v[84:85], v[60:61]
    v_pk_mul_f32 v[82:83], v[82:83], v[58:59]
    v_pk_mul_f32 v[86:87], v[86:87], v[62:63]
    v_pk_mul_f32 v[16:17], v[80:81], v[80:81]
    v_pk_mul_f32 v[20:21], v[84:85], v[84:85]
    v_pk_mul_f32 v[18:19], v[82:83], v[82:83]
    v_pk_mul_f32 v[22:23], v[86:87], v[86:87]
    v_pk_fma_f32 v[16:17], v[16:17], v[30:31], v[14:15] op_sel_hi:[1,0,0]
    v_pk_fma_f32 v[20:21], v[20:21], v[30:31], v[14:15] op_sel_hi:[1,0,0]
    v_pk_fma_f32 v[18:19], v[18:19], v[30:31], v[14:15] op_sel_hi:[1,0,0]
    v_pk_fma_f32 v[22:23], v[22:23], v[30:31], v[14:15] op_sel_hi:[1,0,0]
    v_pk_mul_f32 v[16:17], v[16:17], v[80:81]
    v_pk_mul_f32 v[20:21], v[20:21], v[84:85]
    v_pk_mul_f32 v[18:19], v[18:19], v[82:83]
    v_pk_mul_f32 v[22:23], v[22:23], v[86:87]
    v_exp_f32 v16, v16
    v_exp_f32 v20, v20
    v_exp_f32 v17, v17
    v_exp_f32 v21, v21
    v_exp_f32 v18, v18
    v_exp_f32 v22, v22
    v_exp_f32 v19, v19
    v_exp_f32 v23, v23
    v_pk_add_f32 v[16:17], v[16:17], 1.0 op_sel_hi:[1,0]
    v_pk_add_f32 v[20:21], v[20:21], 1.0 op_sel_hi:[1,0]
    v_pk_add_f32 v[18:19], v[18:19], 1.0 op_sel_hi:[1,0]
    v_pk_add_f32 v[22:23], v[22:23], 1.0 op_sel_hi:[1,0]
    v_rcp_f32 v16, v16
    v_rcp_f32 v20, v20
    v_rcp_f32 v17, v17
    v_rcp_f32 v21, v21
    v_rcp_f32 v18, v18
    v_rcp_f32 v22, v22
    v_rcp_f32 v19, v19
    v_rcp_f32 v23, v23
    v_pk_mul_f32 v[80:81], v[80:81], v[16:17]
    v_pk_mul_f32 v[84:85], v[84:85], v[20:21]
    v_pk_mul_f32 v[82:83], v[82:83], v[18:19]
    v_pk_mul_f32 v[86:87], v[86:87], v[22:23]
    buffer_load_dwordx4 v5, s[24:27], s69 offen lds
    s_add_u32 m0, m0, 1040
    s_add_u32 s69, s69, 4096
    v_pk_add_f32 v[32:33], v[32:33], v[80:81]
    v_pk_fma_f32 v[40:41], v[80:81], v[80:81], v[40:41]
    v_pk_add_f32 v[34:35], v[34:35], v[82:83]
    v_pk_fma_f32 v[42:43], v[82:83], v[82:83], v[42:43]
    v_pk_add_f32 v[36:37], v[36:37], v[84:85]
    v_pk_fma_f32 v[44:45], v[84:85], v[84:85], v[44:45]
    v_pk_add_f32 v[38:39], v[38:39], v[86:87]
    v_pk_fma_f32 v[46:47], v[86:87], v[86:87], v[46:47]
    v_pk_mul_f32 v[88:89], v[88:89], v[56:57]
    v_pk_mul_f32 v[92:93], v[92:93], v[60:61]
    v_pk_mul_f32 v[90:91], v[90:91], v[58:59]
    v_pk_mul_f32 v[94:95], v[94:95], v[62:63]
    v_pk_mul_f32 v[16:17], v[88:89], v[88:89]
    v_pk_mul_f32 v[20:21], v[92:93], v[92:93]
    v_pk_mul_f32 v[18:19], v[90:91], v[90:91]
    v_pk_mul_f32 v[22:23], v[94:95], v[94:95]
    v_pk_fma_f32 v[16:17], v[16:17], v[30:31], v[14:15] op_sel_hi:[1,0,0]
    v_pk_fma_f32 v[20:21], v[20:21], v[30:31], v[14:15] op_sel_hi:[1,0,0]
    v_pk_fma_f32 v[18:19], v[18:19], v[30:31], v[14:15] op_sel_hi:[1,0,0]
    v_pk_fma_f32 v[22:23], v[22:23], v[30:31], v[14:15] op_sel_hi:[1,0,0]
    v_pk_mul_f32 v[16:17], v[16:17], v[88:89]
    v_pk_mul_f32 v[20:21], v[20:21], v[92:93]
    v_pk_mul_f32 v[18:19], v[18:19], v[90:91]
    v_pk_mul_f32 v[22:23], v[22:23], v[94:95]
    v_exp_f32 v16, v16
    v_exp_f32 v20, v20
    v_exp_f32 v17, v17
    v_exp_f32 v21, v21
    v_exp_f32 v18, v18
    v_exp_f32 v22, v22
    v_exp_f32 v19, v19
    v_exp_f32 v23, v23
    v_pk_add_f32 v[16:17], v[16:17], 1.0 op_sel_hi:[1,0]
    v_pk_add_f32 v[20:21], v[20:21], 1.0 op_sel_hi:[1,0]
    v_pk_add_f32 v[18:19], v[18:19], 1.0 op_sel_hi:[1,0]
    v_pk_add_f32 v[22:23], v[22:23], 1.0 op_sel_hi:[1,0]
    v_rcp_f32 v16, v16
    v_rcp_f32 v20, v20
    v_rcp_f32 v17, v17
    v_rcp_f32 v21, v21
    v_rcp_f32 v18, v18
    v_rcp_f32 v22, v22
    v_rcp_f32 v19, v19
    v_rcp_f32 v23, v23
    v_pk_mul_f32 v[88:89], v[88:89], v[16:17]
    v_pk_mul_f32 v[92:93], v[92:93], v[20:21]
    v_pk_mul_f32 v[90:91], v[90:91], v[18:19]
    v_pk_mul_f32 v[94:95], v[94:95], v[22:23]
    buffer_load_dwordx4 v5, s[24:27], s69 offen lds
    s_add_u32 m0, m0, 1040
    s_add_u32 s69, s69, 4096
    v_pk_add_f32 v[32:33], v[32:33], v[88:89]
    v_pk_fma_f32 v[40:41], v[88:89], v[88:89], v[40:41]
    v_pk_add_f32 v[34:35], v[34:35], v[90:91]
    v_pk_fma_f32 v[42:43], v[90:91], v[90:91], v[42:43]
    v_pk_add_f32 v[36:37], v[36:37], v[92:93]
    v_pk_fma_f32 v[44:45], v[92:93], v[92:93], v[44:45]
    v_pk_add_f32 v[38:39], v[38:39], v[94:95]
    v_pk_fma_f32 v[46:47], v[94:95], v[94:95], v[46:47]
    v_add_f32_dpp v32, v32, v32 row_ror:8 row_mask:0xf bank_mask:0x3
    v_add_f32_dpp v33, v33, v33 row_ror:8 row_mask:0xf bank_mask:0x3
    v_add_f32_dpp v34, v34, v34 row_ror:8 row_mask:0xf bank_mask:0x3
    v_add_f32_dpp v35, v35, v35 row_ror:8 row_mask:0xf bank_mask:0x3
    v_add_f32_dpp v40, v40, v40 row_ror:8 row_mask:0xf bank_mask:0x3
    v_add_f32_dpp v41, v41, v41 row_ror:8 row_mask:0xf bank_mask:0x3
    v_add_f32_dpp v42, v42, v42 row_ror:8 row_mask:0xf bank_mask:0x3
    v_add_f32_dpp v43, v43, v43 row_ror:8 row_mask:0xf bank_mask:0x3
    v_add_f32_dpp v32, v36, v36 row_ror:8 row_mask:0xf bank_mask:0xc
    v_add_f32_dpp v33, v37, v37 row_ror:8 row_mask:0xf bank_mask:0xc
    v_add_f32_dpp v34, v38, v38 row_ror:8 row_mask:0xf bank_mask:0xc
    v_add_f32_dpp v35, v39, v39 row_ror:8 row_mask:0xf bank_mask:0xc
    v_add_f32_dpp v40, v44, v44 row_ror:8 row_mask:0xf bank_mask:0xc
    v_add_f32_dpp v41, v45, v45 row_ror:8 row_mask:0xf bank_mask:0xc
    v_add_f32_dpp v42, v46, v46 row_ror:8 row_mask:0xf bank_mask:0xc
    v_add_f32_dpp v43, v47, v47 row_ror:8 row_mask:0xf bank_mask:0xc
    v_mov_b32 v17, s45
    v_mov_b32 v19, s45
    v_add_f32_dpp v32, v32, v32 row_half_mirror row_mask:0xf bank_mask:0x5
    v_add_f32_dpp v33, v33, v33 row_half_mirror row_mask:0xf bank_mask:0x5
    v_add_f32_dpp v40, v40, v40 row_half_mirror row_mask:0xf bank_mask:0x5
    v_add_f32_dpp v41, v41, v41 row_half_mirror row_mask:0xf bank_mask:0x5
    v_add_f32_dpp v32, v34, v34 row_half_mirror row_mask:0xf bank_mask:0xa
    v_add_f32_dpp v33, v35, v35 row_half_mirror row_mask:0xf bank_mask:0xa
    v_add_f32_dpp v40, v42, v42 row_half_mirror row_mask:0xf bank_mask:0xa
    v_add_f32_dpp v41, v43, v43 row_half_mirror row_mask:0xf bank_mask:0xa
    v_add_f32_dpp v32, v32, v32 quad_perm:[1,0,3,2] row_mask:0xf bank_mask:0xf
    v_add_f32_dpp v33, v33, v33 quad_perm:[1,0,3,2] row_mask:0xf bank_mask:0xf
    v_add_f32_dpp v40, v40, v40 quad_perm:[1,0,3,2] row_mask:0xf bank_mask:0xf
    v_add_f32_dpp v41, v41, v41 quad_perm:[1,0,3,2] row_mask:0xf bank_mask:0xf
    v_add_f32_dpp v32, v32, v32 quad_perm:[2,3,0,1] row_mask:0xf bank_mask:0xf
    v_add_f32_dpp v33, v33, v33 quad_perm:[2,3,0,1] row_mask:0xf bank_mask:0xf
    v_add_f32_dpp v40, v40, v40 quad_perm:[2,3,0,1] row_mask:0xf bank_mask:0xf
    v_add_f32_dpp v41, v41, v41 quad_perm:[2,3,0,1] row_mask:0xf bank_mask:0xf
    v_cndmask_b32 v16, v32, v33, s[4:5]
    v_cndmask_b32 v18, v40, v41, s[4:5]
    s_not_b64 exec, s[6:7]
    buffer_store_dwordx4 v[16:19], v25, s[40:43], s13 offen sc1
    s_mov_b64 exec, -1
    s_waitcnt vmcnt(12)
    s_barrier
    ds_read_b128 v[32:35], v12 offset:32768
    ds_read_b128 v[36:39], v12 offset:33792
    ds_read_b128 v[40:43], v12 offset:34816
    ds_read_b128 v[44:47], v12 offset:35840
    ds_read_b128 v[48:51], v12 offset:36864
    s_waitcnt lgkmcnt(3)
    v_mfma_f32_16x16x32_bf16 v[56:59], v[32:35], v[128:131], 0
    buffer_load_dwordx4 v5, s[24:27], s69 offen lds
    v_mfma_f32_16x16x32_bf16 v[60:63], v[32:35], v[132:135], 0
    ds_read_b128 v[52:55], v12 offset:37888
    v_mfma_f32_16x16x32_bf16 v[56:59], v[36:39], v[136:139], v[56:59]
    s_mul_i32 s69, s44, 8320
    s_add_u32 s69, s69, 65536
    s_cmp_eq_u32 s44, 3
    s_cselect_b32 s69, 147456, s69
    v_mfma_f32_16x16x32_bf16 v[60:63], v[36:39], v[140:143], v[60:63]
    ds_read_b128 v[32:35], v12 offset:38912
    s_mov_b32 m0, s69
    s_waitcnt lgkmcnt(3)
    v_mfma_f32_16x16x32_bf16 v[56:59], v[40:43], v[144:147], v[56:59]
    s_add_u32 s69, s44, 3
    s_and_b32 s69, s69, 3
    s_lshl_b32 s69, s69, 16
    v_mfma_f32_16x16x32_bf16 v[60:63], v[40:43], v[148:151], v[60:63]
    ds_read_b128 v[36:39], v12 offset:39936
    s_add_u32 s69, s69, s61
    buffer_load_dwordx4 v5, s[24:27], s69 offen lds
    v_mfma_f32_16x16x32_bf16 v[56:59], v[44:47], v[152:155], v[56:59]
    s_add_u32 m0, m0, 1040
    s_add_u32 s69, s69, 4096
    buffer_load_dwordx4 v5, s[24:27], s69 offen lds
    v_mfma_f32_16x16x32_bf16 v[60:63], v[44:47], v[156:159], v[60:63]
    ds_read_b128 v[40:43], v12 offset:40960
    s_add_u32 m0, m0, 1040
    s_waitcnt lgkmcnt(3)
    v_mfma_f32_16x16x32_bf16 v[56:59], v[48:51], v[160:163], v[56:59]
    s_add_u32 s69, s69, 4096
    buffer_load_dwordx4 v5, s[24:27], s69 offen lds
    s_add_u32 m0, m0, 1040
    v_mfma_f32_16x16x32_bf16 v[60:63], v[48:51], v[164:167], v[60:63]
    ds_read_b128 v[44:47], v12 offset:41984
    s_add_u32 s69, s69, 4096
    buffer_load_dwordx4 v5, s[24:27], s69 offen lds
    v_mfma_f32_16x16x32_bf16 v[56:59], v[52:55], v[168:171], v[56:59]
    s_add_u32 m0, m0, 1040
    s_add_u32 s69, s69, 4096
    buffer_load_dwordx4 v5, s[24:27], s69 offen lds
    v_mfma_f32_16x16x32_bf16 v[60:63], v[52:55], v[172:175], v[60:63]
    ds_read_b128 v[48:51], v12 offset:43008
    s_add_u32 m0, m0, 1040
    s_waitcnt lgkmcnt(3)
    v_mfma_f32_16x16x32_bf16 v[56:59], v[32:35], v[176:179], v[56:59]
    s_add_u32 s69, s69, 4096
    buffer_load_dwordx4 v5, s[24:27], s69 offen lds
    s_add_u32 m0, m0, 1040
    v_mfma_f32_16x16x32_bf16 v[60:63], v[32:35], v[180:183], v[60:63]
    ds_read_b128 v[52:55], v12 offset:44032
    s_add_u32 s69, s69, 4096
    buffer_load_dwordx4 v5, s[24:27], s69 offen lds
    v_mfma_f32_16x16x32_bf16 v[56:59], v[36:39], v[184:187], v[56:59]
    s_add_u32 m0, m0, 1040
    s_add_u32 s69, s69, 4096
    buffer_load_dwordx4 v5, s[24:27], s69 offen lds
    v_mfma_f32_16x16x32_bf16 v[60:63], v[36:39], v[188:191], v[60:63]
    ds_read_b128 v[32:35], v12 offset:45056
    s_lshl_b32 s17, s66, 3
    s_waitcnt lgkmcnt(3)
    v_mfma_f32_16x16x32_bf16 v[56:59], v[40:43], v[192:195], v[56:59]
    s_lshl_b32 s49, s44, 1
    s_add_u32 s17, s17, s49
    s_mul_i32 s14, s17, 56
    v_mfma_f32_16x16x32_bf16 v[60:63], v[40:43], v[196:199], v[60:63]
    ds_read_b128 v[36:39], v12 offset:46080
    s_add_u32 s14, s14, s68
    s_add_u32 s14, s14, 0
    v_mfma_f32_16x16x32_bf16 v[56:59], v[44:47], v[200:203], v[56:59]
    s_lshl_b32 s14, s14, 9
    s_add_u32 s14, s14, 9961472
    s_add_u32 s15, s14, 28672
    v_mfma_f32_16x16x32_bf16 v[60:63], v[44:47], v[204:207], v[60:63]
    ds_read_b128 v[40:43], v12 offset:47104
    s_lshl_b32 s17, s17, 4
    s_waitcnt lgkmcnt(3)
    v_mfma_f32_16x16x32_bf16 v[56:59], v[48:51], v[208:211], v[56:59]
    s_add_u32 s17, s17, s67
    s_lshl_b32 s17, s17, 10
    s_add_u32 s17, s17, 17825792
    v_mfma_f32_16x16x32_bf16 v[60:63], v[48:51], v[212:215], v[60:63]
    ds_read_b128 v[44:47], v12 offset:48128
    s_lshl_b32 s48, s44, 10
    s_add_u32 s48, s48, 90496
    v_mfma_f32_16x16x32_bf16 v[56:59], v[52:55], v[216:219], v[56:59]
    v_and_b32 v18, 31, v1
    v_lshl_add_u32 v9, v18, 2, s48
    v_lshl_add_u32 v13, v4, 4, s48
    v_mfma_f32_16x16x32_bf16 v[60:63], v[52:55], v[220:223], v[60:63]
    ds_read_b128 v[48:51], v12 offset:49152
    s_waitcnt lgkmcnt(3)
    v_mfma_f32_16x16x32_bf16 v[56:59], v[32:35], v[224:227], v[56:59]
    v_mfma_f32_16x16x32_bf16 v[60:63], v[32:35], v[228:231], v[60:63]
    ds_read_b128 v[52:55], v12 offset:50176
    v_mfma_f32_16x16x32_bf16 v[56:59], v[36:39], v[232:235], v[56:59]
    v_mfma_f32_16x16x32_bf16 v[60:63], v[36:39], v[236:239], v[60:63]
    ds_read_b128 v[32:35], v12 offset:51200
    s_waitcnt lgkmcnt(3)
    v_mfma_f32_16x16x32_bf16 v[56:59], v[40:43], v[240:243], v[56:59]
    v_mfma_f32_16x16x32_bf16 v[60:63], v[40:43], v[244:247], v[60:63]
    ds_read_b128 v[36:39], v12 offset:52224
    v_mfma_f32_16x16x32_bf16 v[56:59], v[44:47], v[248:251], v[56:59]
    s_mul_i32 s62, s44, 8320
    s_add_u32 s62, s62, 0
    s_cmp_eq_u32 s44, 3
    s_cselect_b32 s62, 24960, s62
    v_mfma_f32_16x16x32_bf16 v[60:63], v[44:47], v[252:255], v[60:63]
    ds_read_b128 v[40:43], v12 offset:53248
    v_add_u32 v6, s62, v27
    s_waitcnt lgkmcnt(3)
    v_mfma_f32_16x16x32_bf16 v[112:115], v[48:51], v[128:131], 0
    v_add_u32 v7, s62, v31
    s_waitcnt vmcnt(8)
    v_mfma_f32_16x16x32_bf16 v[116:119], v[48:51], v[132:135], 0
    ds_read_b128 v[44:47], v12 offset:54272
    v_mfma_f32_16x16x32_bf16 v[112:115], v[52:55], v[136:139], v[112:115]
    ds_read_b128 a[160:163], v6 offset:0
    v_mfma_f32_16x16x32_bf16 v[116:119], v[52:55], v[140:143], v[116:119]
    ds_read_b128 v[48:51], v12 offset:55296
    s_waitcnt lgkmcnt(4)
    v_mfma_f32_16x16x32_bf16 v[112:115], v[32:35], v[144:147], v[112:115]
    ds_read_b128 a[164:167], v6 offset:64
    v_mfma_f32_16x16x32_bf16 v[116:119], v[32:35], v[148:151], v[116:119]
    ds_read_b128 v[52:55], v12 offset:56320
    v_mfma_f32_16x16x32_bf16 v[112:115], v[36:39], v[152:155], v[112:115]
    ds_read_b128 a[168:171], v7 offset:0
    v_mfma_f32_16x16x32_bf16 v[116:119], v[36:39], v[156:159], v[116:119]
    ds_read_b128 v[32:35], v12 offset:57344
    s_waitcnt lgkmcnt(6)
    v_mfma_f32_16x16x32_bf16 v[112:115], v[40:43], v[160:163], v[112:115]
    ds_read_b128 a[172:175], v7 offset:64
    v_mfma_f32_16x16x32_bf16 v[116:119], v[40:43], v[164:167], v[116:119]
    ds_read_b128 v[36:39], v12 offset:58368
    v_mfma_f32_16x16x32_bf16 v[112:115], v[44:47], v[168:171], v[112:115]
    ds_read_b128 a[176:179], v6 offset:256
    v_mfma_f32_16x16x32_bf16 v[116:119], v[44:47], v[172:175], v[116:119]
    ds_read_b128 v[40:43], v12 offset:59392
    s_waitcnt lgkmcnt(6)
    v_mfma_f32_16x16x32_bf16 v[112:115], v[48:51], v[176:179], v[112:115]
    ds_read_b128 a[180:183], v6 offset:320
    v_mfma_f32_16x16x32_bf16 v[116:119], v[48:51], v[180:183], v[116:119]
    ds_read_b128 v[44:47], v12 offset:60416
    v_mfma_f32_16x16x32_bf16 v[112:115], v[52:55], v[184:187], v[112:115]
    ds_read_b128 a[184:187], v7 offset:256
    v_mfma_f32_16x16x32_bf16 v[116:119], v[52:55], v[188:191], v[116:119]
    ds_read_b128 v[48:51], v12 offset:61440
    s_waitcnt lgkmcnt(6)
    v_mfma_f32_16x16x32_bf16 v[112:115], v[32:35], v[192:195], v[112:115]
    ds_read_b128 a[188:191], v7 offset:320
    v_and_b32 v17, 3, v1
    v_lshlrev_b32 v17, 6, v17
    v_mfma_f32_16x16x32_bf16 v[116:119], v[32:35], v[196:199], v[116:119]
    ds_read_b128 v[52:55], v12 offset:62464
    v_and_b32 v19, 60, v1
    v_add_u32 v17, v17, v19
    v_mfma_f32_16x16x32_bf16 v[112:115], v[36:39], v[200:203], v[112:115]
    v_mov_b32 v16, 0x3d800000
    s_add_u32 s50, s17, 16384
    v_fma_f32 v96, v96, v16, v10
    v_mfma_f32_16x16x32_bf16 v[116:119], v[36:39], v[204:207], v[116:119]
    ds_read_b128 v[32:35], v12 offset:63488
    v_fma_f32 v97, v97, v16, v10
    s_waitcnt lgkmcnt(5)
    v_mfma_f32_16x16x32_bf16 v[112:115], v[40:43], v[208:211], v[112:115]
    v_fma_f32 v98, v98, v16, v10
    v_fma_f32 v99, v99, v16, v10
    v_fma_f32 v100, v100, v16, v10
    v_mfma_f32_16x16x32_bf16 v[116:119], v[40:43], v[212:215], v[116:119]
    ds_read_b128 v[36:39], v12 offset:64512
    v_fma_f32 v101, v101, v16, v10
    s_waitcnt lgkmcnt(3)
    v_mfma_f32_16x16x32_bf16 v[112:115], v[44:47], v[216:219], v[112:115]
    s_mul_i32 s69, s44, 8320
    s_add_u32 s69, s69, 0
    s_cmp_eq_u32 s44, 3
    s_cselect_b32 s69, 24960, s69
    v_mfma_f32_16x16x32_bf16 v[116:119], v[44:47], v[220:223], v[116:119]
    ds_read_b128 v[40:43], v8 offset:0
    s_mov_b32 m0, s69
    s_waitcnt lgkmcnt(3)
    v_mfma_f32_16x16x32_bf16 v[112:115], v[48:51], v[224:227], v[112:115]
    s_add_u32 s69, s44, 3
    s_and_b32 s69, s69, 3
    s_lshl_b32 s69, s69, 16
    v_mfma_f32_16x16x32_bf16 v[116:119], v[48:51], v[228:231], v[116:119]
    ds_read_b128 v[44:47], v8 offset:1024
    s_add_u32 s69, s69, s61
    s_xor_b32 s69, s69, 512
    v_mfma_f32_16x16x32_bf16 v[112:115], v[52:55], v[232:235], v[112:115]
    buffer_load_dwordx4 v5, s[24:27], s69 offen lds
    s_add_u32 m0, m0, 1040
    s_add_u32 s69, s69, 4096
    v_mfma_f32_16x16x32_bf16 v[116:119], v[52:55], v[236:239], v[116:119]
    ds_read_b128 v[48:51], v8 offset:2048
    v_fma_f32 v102, v102, v16, v10
    s_waitcnt lgkmcnt(3)
    v_mfma_f32_16x16x32_bf16 v[112:115], v[32:35], v[240:243], v[112:115]
    v_fma_f32 v103, v103, v16, v10
    v_mfma_f32_16x16x32_bf16 v[116:119], v[32:35], v[244:247], v[116:119]
    ds_read_b128 v[52:55], v8 offset:3072
    buffer_load_dwordx4 v5, s[24:27], s69 offen lds
    s_add_u32 m0, m0, 1040
    v_mfma_f32_16x16x32_bf16 v[112:115], v[36:39], v[248:251], v[112:115]
    s_add_u32 s69, s69, 4096
    v_cvt_pk_bf16_f32 v96, v96, v97
    v_cvt_pk_bf16_f32 v97, v98, v99
    v_mfma_f32_16x16x32_bf16 v[116:119], v[36:39], v[252:255], v[116:119]
    ds_read_b128 v[32:35], v8 offset:4096
    buffer_load_dwordx4 v5, s[24:27], s69 offen lds
    s_waitcnt lgkmcnt(3)
    v_mfma_f32_16x16x32_bf16 v[120:123], v[40:43], v[128:131], 0
    s_add_u32 m0, m0, 1040
    s_add_u32 s69, s69, 4096
    v_cvt_pk_bf16_f32 v98, v100, v101
    v_mfma_f32_16x16x32_bf16 v[124:127], v[40:43], v[132:135], 0
    ds_read_b128 v[36:39], v8 offset:5120
    v_cvt_pk_bf16_f32 v99, v102, v103
    v_mfma_f32_16x16x32_bf16 v[120:123], v[44:47], v[136:139], v[120:123]
    buffer_load_dwordx4 v5, s[24:27], s69 offen lds
    s_add_u32 m0, m0, 1040
    s_add_u32 s69, s69, 4096
    v_mfma_f32_16x16x32_bf16 v[124:127], v[44:47], v[140:143], v[124:127]
    ds_read_b128 v[40:43], v8 offset:6144
    ds_bpermute_b32 v100, v17, v96
    s_waitcnt lgkmcnt(4)
    v_mfma_f32_16x16x32_bf16 v[120:123], v[48:51], v[144:147], v[120:123]
    ds_bpermute_b32 v101, v17, v97
    buffer_load_dwordx4 v5, s[24:27], s69 offen lds
    s_add_u32 m0, m0, 1040
    v_mfma_f32_16x16x32_bf16 v[124:127], v[48:51], v[148:151], v[124:127]
    ds_read_b128 v[44:47], v8 offset:7168
    s_add_u32 s69, s69, 4096
    ds_bpermute_b32 v102, v17, v98
    v_mfma_f32_16x16x32_bf16 v[120:123], v[52:55], v[152:155], v[120:123]
    ds_bpermute_b32 v103, v17, v99
    buffer_load_dwordx4 v5, s[24:27], s69 offen lds
    s_add_u32 m0, m0, 1040
    v_mfma_f32_16x16x32_bf16 v[124:127], v[52:55], v[156:159], v[124:127]
    ds_read_b128 v[48:51], v8 offset:8192
    s_add_u32 s69, s69, 4096
    s_waitcnt lgkmcnt(7)
    v_mfma_f32_16x16x32_bf16 v[120:123], v[32:35], v[160:163], v[120:123]
    v_fma_f32 v104, v104, v16, v11
    v_mfma_f32_16x16x32_bf16 v[124:127], v[32:35], v[164:167], v[124:127]
    ds_read_b128 v[52:55], v8 offset:9216
    buffer_load_dwordx4 v5, s[24:27], s69 offen lds
    s_add_u32 m0, m0, 1040
    v_mfma_f32_16x16x32_bf16 v[120:123], v[36:39], v[168:171], v[120:123]
    s_add_u32 s69, s69, 4096
    v_fma_f32 v105, v105, v16, v11
    v_fma_f32 v106, v106, v16, v11
    v_mfma_f32_16x16x32_bf16 v[124:127], v[36:39], v[172:175], v[124:127]
    ds_read_b128 v[32:35], v8 offset:10240
    buffer_load_dwordx4 v5, s[24:27], s69 offen lds
    s_waitcnt lgkmcnt(5)
    v_mfma_f32_16x16x32_bf16 v[120:123], v[40:43], v[176:179], v[120:123]
    v_fma_f32 v107, v107, v16, v11
    v_fma_f32 v108, v108, v16, v11
    v_fma_f32 v109, v109, v16, v11
    v_mfma_f32_16x16x32_bf16 v[124:127], v[40:43], v[180:183], v[124:127]
    ds_read_b128 v[36:39], v8 offset:11264
    v_fma_f32 v110, v110, v16, v11
    v_fma_f32 v111, v111, v16, v11
    v_mfma_f32_16x16x32_bf16 v[120:123], v[44:47], v[184:187], v[120:123]
    v_cvt_pk_bf16_f32 v104, v104, v105
    v_cvt_pk_bf16_f32 v105, v106, v107
    v_cvt_pk_bf16_f32 v106, v108, v109
    v_mfma_f32_16x16x32_bf16 v[124:127], v[44:47], v[188:191], v[124:127]
    ds_read_b128 v[40:43], v8 offset:12288
    v_cvt_pk_bf16_f32 v107, v110, v111
    s_waitcnt lgkmcnt(3)
    v_mfma_f32_16x16x32_bf16 v[120:123], v[48:51], v[192:195], v[120:123]
    ds_bpermute_b32 v108, v17, v104
    ds_bpermute_b32 v109, v17, v105
    ds_bpermute_b32 v110, v17, v106
    v_mfma_f32_16x16x32_bf16 v[124:127], v[48:51], v[196:199], v[124:127]
    ds_read_b128 v[44:47], v8 offset:13312
    ds_bpermute_b32 v111, v17, v107
    s_waitcnt lgkmcnt(9)
    v_mfma_f32_16x16x32_bf16 v[120:123], v[52:55], v[200:203], v[120:123]
    buffer_store_dwordx4 v[100:103], v2, s[40:43], s17 offen sc1
    s_waitcnt lgkmcnt(0)
    v_mfma_f32_16x16x32_bf16 v[124:127], v[52:55], v[204:207], v[124:127]
    ds_read_b128 v[48:51], v8 offset:14336
    s_waitcnt lgkmcnt(7)
    v_mfma_f32_16x16x32_bf16 v[120:123], v[32:35], v[208:211], v[120:123]
    buffer_store_dwordx4 v[108:111], v2, s[40:43], s50 offen sc1
    v_mfma_f32_16x16x32_bf16 v[124:127], v[32:35], v[212:215], v[124:127]
    ds_read_b128 v[52:55], v8 offset:15360
    v_mfma_f32_16x16x32_bf16 v[120:123], v[36:39], v[216:219], v[120:123]
    s_or_b32 s50, s2, s44
    s_cmp_eq_u32 s50, 0
    s_cselect_b32 exec_lo, 1, 0
    s_mov_b32 exec_hi, 0
    v_mov_b32 v6, s45
    v_mov_b32_e64 v7, 0
    buffer_store_dword v6, v7, s[40:43], 0 offen offset:0 sc1
    s_mov_b64 exec, -1
    v_mfma_f32_16x16x32_bf16 v[124:127], v[36:39], v[220:223], v[124:127]
    s_add_u32 s49, s12, 0
    buffer_load_dwordx4 v[96:99], v24, s[40:43], s49 offen sc1
    s_waitcnt lgkmcnt(3)
    v_mfma_f32_16x16x32_bf16 v[120:123], v[40:43], v[224:227], v[120:123]
    s_add_u32 s49, s12, 4096
    buffer_load_dwordx4 v[100:103], v24, s[40:43], s49 offen sc1
    s_add_u32 s49, s12, 8192
    v_mfma_f32_16x16x32_bf16 v[124:127], v[40:43], v[228:231], v[124:127]
    buffer_load_dwordx4 v[104:107], v24, s[40:43], s49 offen sc1
    s_add_u32 s49, s12, 12288
    buffer_load_dwordx4 v[108:111], v24, s[40:43], s49 offen sc1
    v_mfma_f32_16x16x32_bf16 v[120:123], v[44:47], v[232:235], v[120:123]
    s_add_u32 s49, s12, 16384
    buffer_load_dwordx4 v[16:19], v24, s[40:43], s49 offen sc1
    s_add_u32 s49, s12, 20480
    v_mfma_f32_16x16x32_bf16 v[124:127], v[44:47], v[236:239], v[124:127]
    buffer_load_dwordx4 v[20:23], v24, s[40:43], s49 offen sc1
    s_add_u32 s49, s12, 24576
    s_waitcnt lgkmcnt(0)
    v_mfma_f32_16x16x32_bf16 v[120:123], v[48:51], v[240:243], v[120:123]
    buffer_load_dwordx4 a[248:251], v24, s[40:43], s49 offen sc1
    s_add_u32 s49, s12, 28672
    buffer_load_dwordx4 a[252:255], v24, s[40:43], s49 offen sc1
    v_mfma_f32_16x16x32_bf16 v[124:127], v[48:51], v[244:247], v[124:127]
    v_mfma_f32_16x16x32_bf16 v[120:123], v[52:55], v[248:251], v[120:123]
    v_mfma_f32_16x16x32_bf16 v[124:127], v[52:55], v[252:255], v[124:127]
    s_waitcnt vmcnt(0)
    v_accvgpr_read_b32 v36, a248
    v_accvgpr_read_b32 v37, a249
    v_accvgpr_read_b32 v38, a250
    v_accvgpr_read_b32 v39, a251
    v_accvgpr_read_b32 v40, a252
    v_accvgpr_read_b32 v41, a253
    v_accvgpr_read_b32 v42, a254
    v_accvgpr_read_b32 v43, a255
    v_min_u32 v32, v97, v99
    v_max_u32_e64 v33, v97, v99
    v_min3_u32 v32, v32, v101, v103
    v_max3_u32 v33, v33, v101, v103
    v_min3_u32 v32, v32, v105, v107
    v_max3_u32 v33, v33, v105, v107
    v_min3_u32 v32, v32, v109, v111
    v_max3_u32 v33, v33, v109, v111
    v_min3_u32 v32, v32, v17, v19
    v_max3_u32 v33, v33, v17, v19
    v_min3_u32 v32, v32, v21, v23
    v_max3_u32 v33, v33, v21, v23
    v_min3_u32 v32, v32, v37, v39
    v_max3_u32 v33, v33, v37, v39
    v_min3_u32 v32, v32, v41, v43
    v_max3_u32 v33, v33, v41, v43
    v_cmp_ne_u32_e64 vcc, s45, v32
    v_cmp_ne_u32 s[62:63], s45, v33
    s_nop 0
    s_or_b64 vcc, vcc, s[62:63]
    s_cbranch_vccnz L_slow_12
L_back_13:
    v_add_f32 v96, v96, v16
    v_add_f32 v98, v98, v18
    v_add_f32 v100, v100, v20
    v_add_f32 v102, v102, v22
    v_add_f32 v104, v104, v36
    v_add_f32 v106, v106, v38
    v_add_f32 v108, v108, v40
    v_add_f32 v110, v110, v42
    v_add_f32 v96, v96, v104
    v_add_f32 v98, v98, v106
    v_add_f32 v100, v100, v108
    v_add_f32 v102, v102, v110
    v_add_f32 v96, v96, v100
    v_add_f32 v98, v98, v102
    v_mov_b32 v97, v96
    v_mov_b32 v99, v98
    s_nop 0
    v_permlane32_swap_b32 v96, v97
    v_permlane32_swap_b32 v98, v99
    v_add_f32 v96, v96, v97
    v_add_f32 v98, v98, v99
    v_mul_f32 v96, 0x3a924925, v96
    v_mul_f32 v98, 0x3a924925, v98
    v_fma_f32 v98, -v96, v96, v98
    v_max_f32_e64 v98, 0, v98
    v_add_f32 v98, 0x3727c5ac, v98
    v_rsq_f32 v98, v98
    s_nop 0
    v_mul_f32 v96, -v96, v98
    ds_write2_b32 v9, v96, v98 offset0:32 offset1:64
    s_waitcnt lgkmcnt(0)
    ds_read_b128 v[36:39], v13 offset:128
    ds_read_b128 v[44:47], v13 offset:256
    ds_read_b128 v[40:43], v13 offset:192
    ds_read_b128 v[48:51], v13 offset:320
    s_mul_i32 s62, s44, 8320
    s_add_u32 s62, s62, 65536
    s_cmp_eq_u32 s44, 3
    s_cselect_b32 s62, 147456, s62
    v_add_u32 v6, s62, v27
    v_add_u32 v7, s62, v31
    s_waitcnt vmcnt(18)
    ds_read_b128 a[192:195], v6 offset:0
    ds_read_b128 a[196:199], v6 offset:64
    ds_read_b128 a[200:203], v7 offset:0
    ds_read_b128 a[204:207], v7 offset:64
    ds_read_b128 a[208:211], v6 offset:256
    ds_read_b128 a[212:215], v6 offset:320
    ds_read_b128 a[216:219], v7 offset:256
    ds_read_b128 a[220:223], v7 offset:320
    s_mul_i32 s62, s44, 8320
    s_add_u32 s62, s62, 0
    s_cmp_eq_u32 s44, 3
    s_cselect_b32 s62, 24960, s62
    v_add_u32 v6, s62, v27
    v_add_u32 v7, s62, v31
    s_waitcnt vmcnt(10)
    ds_read_b128 a[224:227], v6 offset:0
    ds_read_b128 a[228:231], v6 offset:64
    ds_read_b128 a[232:235], v7 offset:0
    ds_read_b128 a[236:239], v7 offset:64
    ds_read_b128 a[240:243], v6 offset:256
    ds_read_b128 a[244:247], v6 offset:320
    ds_read_b128 a[248:251], v7 offset:256
    ds_read_b128 a[252:255], v7 offset:320
    s_waitcnt lgkmcnt(15)
    v_pk_fma_f32 v[64:65], v[64:65], v[44:45], v[36:37]
    v_pk_fma_f32 v[66:67], v[66:67], v[46:47], v[38:39]
    v_pk_fma_f32 v[68:69], v[68:69], v[48:49], v[40:41]
    v_pk_fma_f32 v[70:71], v[70:71], v[50:51], v[42:43]
    v_cvt_pk_bf16_f32 v64, v64, v65
    v_cvt_pk_bf16_f32 v65, v66, v67
    v_cvt_pk_bf16_f32 v66, v68, v69
    v_cvt_pk_bf16_f32 v67, v70, v71
    s_nop 0
    v_permlane32_swap_b32 v64, v66
    v_permlane32_swap_b32 v65, v67
    s_nop 0
    v_permlane16_swap_b32 v64, v66
    v_permlane16_swap_b32 v65, v67
    buffer_store_dwordx4 v[64:67], v2, s[40:43], s16 offen sc1
    s_add_u32 s16, s16, 65536
    v_pk_fma_f32 v[72:73], v[72:73], v[44:45], v[36:37]
    v_pk_fma_f32 v[74:75], v[74:75], v[46:47], v[38:39]
    v_pk_fma_f32 v[76:77], v[76:77], v[48:49], v[40:41]
    v_pk_fma_f32 v[78:79], v[78:79], v[50:51], v[42:43]
    v_cvt_pk_bf16_f32 v72, v72, v73
    v_cvt_pk_bf16_f32 v73, v74, v75
    v_cvt_pk_bf16_f32 v74, v76, v77
    v_cvt_pk_bf16_f32 v75, v78, v79
    s_nop 0
    v_permlane32_swap_b32 v72, v74
    v_permlane32_swap_b32 v73, v75
    s_nop 0
    v_permlane16_swap_b32 v72, v74
    v_permlane16_swap_b32 v73, v75
    buffer_store_dwordx4 v[72:75], v2, s[40:43], s16 offen sc1
    s_add_u32 s16, s16, 65536
    v_pk_fma_f32 v[80:81], v[80:81], v[44:45], v[36:37]
    v_pk_fma_f32 v[82:83], v[82:83], v[46:47], v[38:39]
    v_pk_fma_f32 v[84:85], v[84:85], v[48:49], v[40:41]
    v_pk_fma_f32 v[86:87], v[86:87], v[50:51], v[42:43]
    v_cvt_pk_bf16_f32 v80, v80, v81
    v_cvt_pk_bf16_f32 v81, v82, v83
    v_cvt_pk_bf16_f32 v82, v84, v85
    v_cvt_pk_bf16_f32 v83, v86, v87
    s_nop 0
    v_permlane32_swap_b32 v80, v82
    v_permlane32_swap_b32 v81, v83
    s_nop 0
    v_permlane16_swap_b32 v80, v82
    v_permlane16_swap_b32 v81, v83
    buffer_store_dwordx4 v[80:83], v2, s[40:43], s16 offen sc1
    s_add_u32 s16, s16, 65536
    v_pk_fma_f32 v[88:89], v[88:89], v[44:45], v[36:37]
    v_pk_fma_f32 v[90:91], v[90:91], v[46:47], v[38:39]
    v_pk_fma_f32 v[92:93], v[92:93], v[48:49], v[40:41]
    v_pk_fma_f32 v[94:95], v[94:95], v[50:51], v[42:43]
    v_cvt_pk_bf16_f32 v88, v88, v89
    v_cvt_pk_bf16_f32 v89, v90, v91
    v_cvt_pk_bf16_f32 v90, v92, v93
    v_cvt_pk_bf16_f32 v91, v94, v95
    s_nop 0
    v_permlane32_swap_b32 v88, v90
    v_permlane32_swap_b32 v89, v91
    s_nop 0
    v_permlane16_swap_b32 v88, v90
    v_permlane16_swap_b32 v89, v91
    buffer_store_dwordx4 v[88:91], v2, s[40:43], s16 offen sc1
    v_lshrrev_b32 v24, 3, v1
    v_and_b32 v25, 7, v1
    v_and_b32 v15, 6, v24
    v_xor_b32 v25, v25, v15
    v_lshlrev_b32 v24, 10, v24
    v_lshl_add_u32 v15, v25, 4, v24
    s_mul_i32 s69, s44, 229376
    s_lshl_b32 s49, s60, 7
    s_add_u32 s69, s69, s49
    s_mul_i32 m0, s44, 28672
    v_lshlrev_b32 v8, 3, v1
    s_waitcnt lgkmcnt(0)
    s_barrier
    v_pk_mul_f32 v[56:57], v[56:57], v[26:27] op_sel_hi:[1,0]
    v_pk_mul_f32 v[60:61], v[60:61], v[28:29] op_sel_hi:[1,0]
    v_pk_mul_f32 v[58:59], v[58:59], v[26:27] op_sel_hi:[1,0]
    v_pk_mul_f32 v[62:63], v[62:63], v[28:29] op_sel_hi:[1,0]
    v_pk_mul_f32 v[16:17], v[56:57], v[56:57]
    v_pk_mul_f32 v[20:21], v[60:61], v[60:61]
    v_pk_mul_f32 v[18:19], v[58:59], v[58:59]
    v_pk_mul_f32 v[22:23], v[62:63], v[62:63]
    v_pk_fma_f32 v[16:17], v[16:17], v[30:31], v[14:15] op_sel_hi:[1,0,0]
    v_pk_fma_f32 v[20:21], v[20:21], v[30:31], v[14:15] op_sel_hi:[1,0,0]
    v_pk_fma_f32 v[18:19], v[18:19], v[30:31], v[14:15] op_sel_hi:[1,0,0]
    v_pk_fma_f32 v[22:23], v[22:23], v[30:31], v[14:15] op_sel_hi:[1,0,0]
    v_pk_mul_f32 v[16:17], v[16:17], v[56:57]
    v_pk_mul_f32 v[20:21], v[20:21], v[60:61]
    v_pk_mul_f32 v[18:19], v[18:19], v[58:59]
    v_pk_mul_f32 v[22:23], v[22:23], v[62:63]
    v_exp_f32 v16, v16
    v_exp_f32_e64 v20, v20
    buffer_load_dwordx4 v15, s[32:35], s69 offen lds
    s_add_u32 m0, m0, 1024
    s_add_u32 s69, s69, 8192
    v_exp_f32 v17, v17
    v_exp_f32 v21, v21
    v_exp_f32 v18, v18
    v_exp_f32 v22, v22
    v_exp_f32 v19, v19
    v_exp_f32 v23, v23
    v_pk_add_f32 v[16:17], v[16:17], 1.0 op_sel_hi:[1,0]
    v_pk_add_f32 v[20:21], v[20:21], 1.0 op_sel_hi:[1,0]
    v_pk_add_f32 v[18:19], v[18:19], 1.0 op_sel_hi:[1,0]
    v_pk_add_f32 v[22:23], v[22:23], 1.0 op_sel_hi:[1,0]
    v_rcp_f32 v16, v16
    v_rcp_f32 v20, v20
    v_rcp_f32 v17, v17
    v_rcp_f32 v21, v21
    v_rcp_f32 v18, v18
    v_rcp_f32 v22, v22
    v_rcp_f32_e64 v19, v19
    buffer_load_dwordx4 v15, s[32:35], s69 offen lds
    s_add_u32 m0, m0, 1024
    s_add_u32 s69, s69, 8192
    v_rcp_f32_e64 v23, v23
    v_pk_mul_f32 v[56:57], v[56:57], v[16:17]
    v_pk_mul_f32 v[60:61], v[60:61], v[20:21]
    v_pk_mul_f32 v[58:59], v[58:59], v[18:19]
    v_pk_mul_f32 v[62:63], v[62:63], v[22:23]
    v_cvt_pk_bf16_f32 v56, v56, v57
    v_cvt_pk_bf16_f32 v57, v58, v59
    v_cvt_pk_bf16_f32 v60, v60, v61
    v_cvt_pk_bf16_f32 v61, v62, v63
    v_pk_mul_f32 v[112:113], v[112:113], v[26:27] op_sel_hi:[1,0]
    v_pk_mul_f32 v[116:117], v[116:117], v[28:29] op_sel_hi:[1,0]
    v_pk_mul_f32 v[114:115], v[114:115], v[26:27] op_sel_hi:[1,0]
    v_pk_mul_f32 v[118:119], v[118:119], v[28:29] op_sel_hi:[1,0]
    v_pk_mul_f32 v[16:17], v[112:113], v[112:113]
    v_pk_mul_f32 v[20:21], v[116:117], v[116:117]
    v_pk_mul_f32 v[18:19], v[114:115], v[114:115]
    v_pk_mul_f32 v[22:23], v[118:119], v[118:119]
    v_pk_fma_f32 v[16:17], v[16:17], v[30:31], v[14:15] op_sel_hi:[1,0,0]
    buffer_load_dwordx4 v15, s[32:35], s69 offen lds
    s_add_u32 m0, m0, 1024
    s_add_u32 s69, s69, 8192
    v_pk_fma_f32 v[20:21], v[20:21], v[30:31], v[14:15] op_sel_hi:[1,0,0]
    v_pk_fma_f32 v[18:19], v[18:19], v[30:31], v[14:15] op_sel_hi:[1,0,0]
    v_pk_fma_f32 v[22:23], v[22:23], v[30:31], v[14:15] op_sel_hi:[1,0,0]
    v_pk_mul_f32 v[16:17], v[16:17], v[112:113]
    v_pk_mul_f32 v[20:21], v[20:21], v[116:117]
    v_pk_mul_f32 v[18:19], v[18:19], v[114:115]
    v_pk_mul_f32 v[22:23], v[22:23], v[118:119]
    v_exp_f32 v16, v16
    v_exp_f32 v20, v20
    v_exp_f32 v17, v17
    v_exp_f32 v21, v21
    v_exp_f32 v18, v18
    v_exp_f32 v22, v22
    v_exp_f32 v19, v19
    v_exp_f32 v23, v23
    v_pk_add_f32 v[16:17], v[16:17], 1.0 op_sel_hi:[1,0]
    v_pk_add_f32 v[20:21], v[20:21], 1.0 op_sel_hi:[1,0]
    buffer_load_dwordx4 v15, s[32:35], s69 offen lds
    s_add_u32 m0, m0, 1024
    s_add_u32 s69, s69, 8192
    v_pk_add_f32 v[18:19], v[18:19], 1.0 op_sel_hi:[1,0]
    v_pk_add_f32 v[22:23], v[22:23], 1.0 op_sel_hi:[1,0]
    v_rcp_f32 v16, v16
    v_rcp_f32 v20, v20
    v_rcp_f32 v17, v17
    v_rcp_f32 v21, v21
    v_rcp_f32 v18, v18
    v_rcp_f32 v22, v22
    v_rcp_f32 v19, v19
    v_rcp_f32 v23, v23
    v_pk_mul_f32 v[112:113], v[112:113], v[16:17]
    v_pk_mul_f32 v[116:117], v[116:117], v[20:21]
    v_pk_mul_f32 v[114:115], v[114:115], v[18:19]
    v_pk_mul_f32 v[118:119], v[118:119], v[22:23]
    v_cvt_pk_bf16_f32 v58, v112, v113
    v_cvt_pk_bf16_f32 v59, v114, v115
    buffer_store_dwordx4 v[56:59], v2, s[40:43], s14 offen offset:0 sc1
    v_cvt_pk_bf16_f32 v62, v116, v117
    v_cvt_pk_bf16_f32 v63, v118, v119
    buffer_store_dwordx4 v[60:63], v2, s[40:43], s15 offen offset:0 sc1
    s_waitcnt vmcnt(6)
    s_barrier
    s_cmp_eq_u32 s44, 0
    s_cbranch_scc0 L_nf_14
    s_lshl_b32 s48, s2, 7
    s_add_u32 s48, s48, 163840
    v_mov_b32 v6, s45
    v_mov_b32 v7, 0
    s_mov_b64 exec, 1
    buffer_store_dword v6, v7, s[40:43], s48 offen sc1
    s_mov_b64 exec, -1
L_nf_14:
    v_pk_mul_f32 v[120:121], v[120:121], v[26:27] op_sel_hi:[1,0]
    v_pk_mul_f32 v[124:125], v[124:125], v[28:29] op_sel_hi:[1,0]
    v_pk_mul_f32 v[122:123], v[122:123], v[26:27] op_sel_hi:[1,0]
    buffer_load_dwordx4 v15, s[32:35], s69 offen lds
    s_add_u32 m0, m0, 1024
    s_add_u32 s69, s69, 8192
    v_pk_mul_f32 v[126:127], v[126:127], v[28:29] op_sel_hi:[1,0]
    v_pk_mul_f32 v[16:17], v[120:121], v[120:121]
    buffer_load_dwordx4 v15, s[32:35], s69 offen lds
    s_add_u32 m0, m0, 1024
    s_add_u32 s69, s69, 8192
    v_pk_mul_f32 v[20:21], v[124:125], v[124:125]
    v_pk_mul_f32 v[18:19], v[122:123], v[122:123]
    v_pk_mul_f32 v[22:23], v[126:127], v[126:127]
    buffer_load_dwordx4 v15, s[32:35], s69 offen lds
    s_add_u32 m0, m0, 1024
    s_add_u32 s69, s69, 8192
    v_pk_fma_f32 v[16:17], v[16:17], v[30:31], v[14:15] op_sel_hi:[1,0,0]
    v_pk_fma_f32 v[20:21], v[20:21], v[30:31], v[14:15] op_sel_hi:[1,0,0]
    buffer_load_dwordx4 v15, s[32:35], s69 offen lds
    s_add_u32 m0, m0, 7168
    s_add_u32 s69, s69, 57344
    v_pk_fma_f32 v[18:19], v[18:19], v[30:31], v[14:15] op_sel_hi:[1,0,0]
    v_pk_fma_f32 v[22:23], v[22:23], v[30:31], v[14:15] op_sel_hi:[1,0,0]
    v_pk_mul_f32 v[16:17], v[16:17], v[120:121]
    buffer_load_dwordx4 v15, s[32:35], s69 offen lds
    s_add_u32 m0, m0, 1024
    s_add_u32 s69, s69, 8192
    v_pk_mul_f32 v[20:21], v[20:21], v[124:125]
    v_pk_mul_f32 v[18:19], v[18:19], v[122:123]
    buffer_load_dwordx4 v15, s[32:35], s69 offen lds
    s_add_u32 m0, m0, 1024
    s_add_u32 s69, s69, 8192
    v_pk_mul_f32 v[22:23], v[22:23], v[126:127]
    v_exp_f32 v16, v16
    v_exp_f32_e64 v20, v20
    buffer_load_dwordx4 v15, s[32:35], s69 offen lds
    s_add_u32 m0, m0, 1024
    s_add_u32 s69, s69, 8192
    v_exp_f32 v17, v17
    v_exp_f32 v21, v21
    buffer_load_dwordx4 v15, s[32:35], s69 offen lds
    s_add_u32 m0, m0, 1024
    s_add_u32 s69, s69, 8192
    v_exp_f32 v18, v18
    v_exp_f32 v22, v22
    v_exp_f32_e64 v19, v19
    buffer_load_dwordx4 v15, s[32:35], s69 offen lds
    s_add_u32 m0, m0, 1024
    s_add_u32 s69, s69, 8192
    v_exp_f32_e64 v23, v23
    v_pk_add_f32 v[16:17], v[16:17], 1.0 op_sel_hi:[1,0]
    buffer_load_dwordx4 v15, s[32:35], s69 offen lds
    s_add_u32 m0, m0, 1024
    s_add_u32 s69, s69, 8192
    v_pk_add_f32 v[20:21], v[20:21], 1.0 op_sel_hi:[1,0]
    v_pk_add_f32 v[18:19], v[18:19], 1.0 op_sel_hi:[1,0]
    v_pk_add_f32 v[22:23], v[22:23], 1.0 op_sel_hi:[1,0]
    buffer_load_dwordx4 v15, s[32:35], s69 offen lds
    s_add_u32 m0, m0, 1024
    s_add_u32 s69, s69, 8192
    v_rcp_f32 v16, v16
    v_rcp_f32 v20, v20
    buffer_load_dwordx4 v15, s[32:35], s69 offen lds
    s_add_u32 m0, m0, -13312
    s_add_u32 s69, s69, -106496
    v_rcp_f32 v17, v17
    v_rcp_f32 v21, v21
    v_rcp_f32 v18, v18
    v_rcp_f32 v22, v22
    v_rcp_f32 v19, v19
    v_rcp_f32 v23, v23
    v_pk_mul_f32 v[120:121], v[120:121], v[16:17]
    v_pk_mul_f32 v[124:125], v[124:125], v[20:21]
    v_pk_mul_f32 v[122:123], v[122:123], v[18:19]
    v_pk_mul_f32 v[126:127], v[126:127], v[22:23]
    v_cvt_pk_bf16_f32 v120, v120, v121
    v_cvt_pk_bf16_f32 v121, v122, v123
    buffer_store_dwordx2 v[120:121], v8, s[40:43], s14 offen offset:1024 sc1
    v_cvt_pk_bf16_f32 v124, v124, v125
    v_cvt_pk_bf16_f32 v125, v126, v127
    buffer_store_dwordx2 v[124:125], v8, s[40:43], s15 offen offset:1024 sc1
    v_bfe_u32 v32, v1, 1, 2
    v_lshl_add_u32 v32, s44, 2, v32
    v_and_b32 v33, 1, v1
    s_lshl_b32 s48, s65, 1
    v_add_u32 v33, s48, v33
    s_lshr_b32 s48, s64, 1
    v_mov_b32 v13, s48
    v_lshrrev_b32 v34, 2, v32
    v_and_b32_e64 v32, 3, v32
    v_lshl_add_u32 v32, v32, 3, v34
    v_lshrrev_b32_e64 v34, 3, v33
    v_lshl_add_u32 v32, v34, 2, v32
    v_and_b32_e64 v34, 7, v33
    v_lshl_add_u32 v32, v34, 5, v32
    v_lshrrev_b32 v34, 2, v13
    v_and_b32 v13, 3, v13
    v_lshl_add_u32 v13, v13, 3, v34
    v_lshrrev_b32_e64 v34, 3, v33
    v_lshl_add_u32 v13, v34, 2, v13
    v_and_b32_e64 v34, 7, v33
    v_lshl_add_u32 v13, v34, 5, v13
    v_lshlrev_b32_e64 v32, 7, v32
    v_add_u32 v32, 163840, v32
    s_mul_i32 s52, s65, 458752
    s_lshl_b32 s48, s44, 14
    s_add_u32 s52, s52, s48
    s_add_u32 s52, s52, 13631488
    s_lshl_b32 s48, s64, 7
    s_lshl_b32 s49, s44, 5
    s_add_u32 s48, s48, s49
    v_lshlrev_b32 v33, 1, v3
    buffer_load_ushort v9, v33, s[28:31], s48 offen
    s_mov_b32 s48, 0
L_poll_15:
    buffer_load_dword v6, v32, s[40:43], 0 offen sc1
    s_add_u32 s48, s48, 1
    s_cmp_ge_u32 s48, 65536
    s_cbranch_scc1 L_pdone_16
    s_waitcnt vmcnt(0)
    v_cmp_ne_u32 vcc, s45, v6
    s_nop 0
    s_and_b64 exec, exec, vcc
    s_nop 2
    s_cbranch_scc1 L_poll_15
L_pdone_16:
    s_mov_b64 exec, -1
    s_waitcnt vmcnt(0)
    s_add_u32 s51, s52, 0
    buffer_load_dwordx4 v[128:131], v2, s[40:43], s51 offen offset:0 sc1
    buffer_load_dwordx4 v[132:135], v2, s[40:43], s51 offen offset:1024 sc1
    buffer_load_dwordx4 v[136:139], v2, s[40:43], s51 offen offset:2048 sc1
    buffer_load_dwordx4 v[140:143], v2, s[40:43], s51 offen offset:3072 sc1
    s_add_u32 s51, s52, 4096
    buffer_load_dwordx4 v[144:147], v2, s[40:43], s51 offen offset:0 sc1
    buffer_load_dwordx4 v[148:151], v2, s[40:43], s51 offen offset:1024 sc1
    buffer_load_dwordx4 v[152:155], v2, s[40:43], s51 offen offset:2048 sc1
    buffer_load_dwordx4 v[156:159], v2, s[40:43], s51 offen offset:3072 sc1
    s_add_u32 s51, s52, 8192
    buffer_load_dwordx4 v[160:163], v2, s[40:43], s51 offen offset:0 sc1
    buffer_load_dwordx4 v[164:167], v2, s[40:43], s51 offen offset:1024 sc1
    buffer_load_dwordx4 v[168:171], v2, s[40:43], s51 offen offset:2048 sc1
    buffer_load_dwordx4 v[172:175], v2, s[40:43], s51 offen offset:3072 sc1
    s_branch L_p4join_11
L_par1_10:
    s_waitcnt vmcnt(8)
    s_waitcnt lgkmcnt(0)
    s_barrier
    ds_read_b64_tr_b16 v[128:129], v10 offset:0
    ds_read_b64_tr_b16 v[130:131], v10 offset:256
    ds_read_b64_tr_b16 v[132:133], v11 offset:0
    ds_read_b64_tr_b16 v[134:135], v11 offset:256
    ds_read_b64_tr_b16 v[136:137], v10 offset:8192
    ds_read_b64_tr_b16 v[138:139], v10 offset:8448
    ds_read_b64_tr_b16 v[140:141], v11 offset:8192
    ds_read_b64_tr_b16 v[142:143], v11 offset:8448
    ds_read_b128 v[32:35], v2 offset:0
    ds_read_b128 v[36:39], v2 offset:16384
    ds_read_b128 v[40:43], v2 offset:32768
    ds_read_b128 v[44:47], v12 offset:0
    ds_read_b128 v[48:51], v12 offset:16384
    ds_read_b128 v[52:55], v2 offset:1024
    ds_read_b128 v[112:115], v2 offset:17408
    ds_read_b128 v[116:119], v2 offset:33792
    s_add_u32 m0, s18, 147456
    s_add_u32 s48, s19, 49152
    buffer_load_dwordx4 v20, s[40:43], s48 offen offset:0 sc1 lds
    buffer_load_dwordx4 v21, s[40:43], s48 offen offset:1024 sc1 lds
    buffer_load_dwordx4 v22, s[40:43], s48 offen offset:2048 sc1 lds
    buffer_load_dwordx4 v23, s[40:43], s48 offen offset:3072 sc1 lds
    s_lshl_b32 s49, s66, 2
    s_add_u32 s49, s49, s44
    s_lshl_b32 s49, s49, 2
    s_add_u32 s49, s49, 294912
    s_add_u32 s50, s49, 4096
    v_lshlrev_b32 v16, 8, v3
    buffer_load_dword v18, v16, s[40:43], s49 offen sc1
    buffer_load_dword v19, v16, s[40:43], s50 offen sc1
    v_add_u32 v8, 131072, v2
    s_waitcnt lgkmcnt(8)
    v_mfma_f32_16x16x32_bf16 v[56:59], v[128:131], v[128:131], 0
    v_mfma_f32_16x16x32_bf16 v[60:63], v[132:135], v[132:135], 0
    v_mfma_f32_16x16x32_bf16 v[56:59], v[136:139], v[136:139], v[56:59]
    v_mfma_f32_16x16x32_bf16 v[60:63], v[140:143], v[140:143], v[60:63]
    s_waitcnt vmcnt(10)
    s_barrier
    s_waitcnt lgkmcnt(7)
    v_mfma_f32_16x16x32_bf16 v[64:67], v[128:131], v[32:35], 0
    s_add_u32 m0, s18, 98304
    s_add_u32 s48, s19, 65536
    v_mfma_f32_16x16x32_bf16 v[68:71], v[132:135], v[32:35], 0
    ds_read_b128 v[120:123], v12 offset:1024
    s_waitcnt lgkmcnt(7)
    v_mfma_f32_16x16x32_bf16 v[72:75], v[128:131], v[36:39], 0
    buffer_load_dwordx4 v20, s[40:43], s48 offen offset:0 sc1 lds
    buffer_load_dwordx4 v21, s[40:43], s48 offen offset:1024 sc1 lds
    v_mfma_f32_16x16x32_bf16 v[76:79], v[132:135], v[36:39], 0
    ds_read_b128 v[32:35], v12 offset:17408
    s_waitcnt lgkmcnt(7)
    v_mfma_f32_16x16x32_bf16 v[80:83], v[128:131], v[40:43], 0
    ds_read_b64_tr_b16 v[144:145], v10 offset:16384
    v_mfma_f32_16x16x32_bf16 v[84:87], v[132:135], v[40:43], 0
    ds_read_b128 v[36:39], v2 offset:2048
    s_waitcnt lgkmcnt(8)
    v_mfma_f32_16x16x32_bf16 v[96:99], v[44:47], v[128:131], 0
    ds_read_b64_tr_b16 v[146:147], v10 offset:16640
    v_mfma_f32_16x16x32_bf16 v[104:107], v[44:47], v[132:135], 0
    ds_read_b128 v[40:43], v2 offset:18432
    s_waitcnt lgkmcnt(9)
    v_mfma_f32_16x16x32_bf16 v[100:103], v[48:51], v[128:131], 0
    ds_read_b64_tr_b16 v[148:149], v11 offset:16384
    v_mfma_f32_16x16x32_bf16 v[108:111], v[48:51], v[132:135], 0
    ds_read_b128 v[44:47], v2 offset:34816
    s_waitcnt lgkmcnt(10)
    v_mfma_f32_16x16x32_bf16 v[64:67], v[136:139], v[52:55], v[64:67]
    ds_read_b64_tr_b16 v[150:151], v11 offset:16640
    v_mfma_f32_16x16x32_bf16 v[68:71], v[140:143], v[52:55], v[68:71]
    ds_read_b128 v[48:51], v12 offset:2048
    s_waitcnt lgkmcnt(11)
    v_mfma_f32_16x16x32_bf16 v[72:75], v[136:139], v[112:115], v[72:75]
    ds_read_b64_tr_b16 v[152:153], v10 offset:24576
    v_mfma_f32_16x16x32_bf16 v[76:79], v[140:143], v[112:115], v[76:79]
    ds_read_b128 v[52:55], v12 offset:18432
    s_waitcnt lgkmcnt(12)
    v_mfma_f32_16x16x32_bf16 v[80:83], v[136:139], v[116:119], v[80:83]
    ds_read_b64_tr_b16 v[154:155], v10 offset:24832
    v_mfma_f32_16x16x32_bf16 v[84:87], v[140:143], v[116:119], v[84:87]
    ds_read_b128 v[112:115], v2 offset:3072
    s_waitcnt lgkmcnt(13)
    v_mfma_f32_16x16x32_bf16 v[96:99], v[120:123], v[136:139], v[96:99]
    ds_read_b64_tr_b16 v[156:157], v11 offset:24576
    v_mfma_f32_16x16x32_bf16 v[104:107], v[120:123], v[140:143], v[104:107]
    ds_read_b128 v[116:119], v2 offset:19456
    s_waitcnt lgkmcnt(14)
    v_mfma_f32_16x16x32_bf16 v[100:103], v[32:35], v[136:139], v[100:103]
    ds_read_b64_tr_b16 v[158:159], v11 offset:24832
    buffer_load_dwordx4 v22, s[40:43], s48 offen offset:2048 sc1 lds
    v_mfma_f32_16x16x32_bf16 v[108:111], v[32:35], v[140:143], v[108:111]
    ds_read_b128 v[120:123], v2 offset:35840
    buffer_load_dwordx4 v23, s[40:43], s48 offen offset:3072 sc1 lds
    s_waitcnt lgkmcnt(1)
    v_mfma_f32_16x16x32_bf16 v[56:59], v[144:147], v[144:147], v[56:59]
    v_mfma_f32_16x16x32_bf16 v[60:63], v[148:151], v[148:151], v[60:63]
    v_mfma_f32_16x16x32_bf16 v[56:59], v[152:155], v[152:155], v[56:59]
    v_mfma_f32_16x16x32_bf16 v[60:63], v[156:159], v[156:159], v[60:63]
    s_waitcnt vmcnt(10)
    s_barrier
    s_waitcnt lgkmcnt(14)
    v_mfma_f32_16x16x32_bf16 v[64:67], v[144:147], v[36:39], v[64:67]
    s_add_u32 m0, s18, 114688
    s_add_u32 s48, s19, 81920
    v_mfma_f32_16x16x32_bf16 v[68:71], v[148:151], v[36:39], v[68:71]
    ds_read_b128 v[32:35], v12 offset:3072
    s_waitcnt lgkmcnt(13)
    v_mfma_f32_16x16x32_bf16 v[72:75], v[144:147], v[40:43], v[72:75]
    buffer_load_dwordx4 v20, s[40:43], s48 offen offset:0 sc1 lds
    buffer_load_dwordx4 v21, s[40:43], s48 offen offset:1024 sc1 lds
    v_mfma_f32_16x16x32_bf16 v[76:79], v[148:151], v[40:43], v[76:79]
    ds_read_b128 v[36:39], v12 offset:19456
    s_waitcnt lgkmcnt(12)
    v_mfma_f32_16x16x32_bf16 v[80:83], v[144:147], v[44:47], v[80:83]
    ds_read_b64_tr_b16 v[160:161], v10 offset:32768
    v_mfma_f32_16x16x32_bf16 v[84:87], v[148:151], v[44:47], v[84:87]
    ds_read_b128 v[40:43], v2 offset:4096
    s_waitcnt lgkmcnt(12)
    v_mfma_f32_16x16x32_bf16 v[96:99], v[48:51], v[144:147], v[96:99]
    ds_read_b64_tr_b16 v[162:163], v10 offset:33024
    v_mfma_f32_16x16x32_bf16 v[104:107], v[48:51], v[148:151], v[104:107]
    ds_read_b128 v[44:47], v2 offset:20480
    s_waitcnt lgkmcnt(12)
    v_mfma_f32_16x16x32_bf16 v[100:103], v[52:55], v[144:147], v[100:103]
    ds_read_b64_tr_b16 v[164:165], v11 offset:32768
    v_mfma_f32_16x16x32_bf16 v[108:111], v[52:55], v[148:151], v[108:111]
    ds_read_b128 v[48:51], v2 offset:36864
    s_waitcnt lgkmcnt(12)
    v_mfma_f32_16x16x32_bf16 v[64:67], v[152:155], v[112:115], v[64:67]
    ds_read_b64_tr_b16 v[166:167], v11 offset:33024
    v_mfma_f32_16x16x32_bf16 v[68:71], v[156:159], v[112:115], v[68:71]
    ds_read_b128 v[52:55], v12 offset:4096
    s_waitcnt lgkmcnt(12)
    v_mfma_f32_16x16x32_bf16 v[72:75], v[152:155], v[116:119], v[72:75]
    ds_read_b64_tr_b16 v[168:169], v10 offset:40960
    v_mfma_f32_16x16x32_bf16 v[76:79], v[156:159], v[116:119], v[76:79]
    ds_read_b128 v[112:115], v12 offset:20480
    s_waitcnt lgkmcnt(12)
    v_mfma_f32_16x16x32_bf16 v[80:83], v[152:155], v[120:123], v[80:83]
    ds_read_b64_tr_b16 v[170:171], v10 offset:41216
    v_mfma_f32_16x16x32_bf16 v[84:87], v[156:159], v[120:123], v[84:87]
    ds_read_b128 v[116:119], v2 offset:5120
    s_waitcnt lgkmcnt(13)
    v_mfma_f32_16x16x32_bf16 v[96:99], v[32:35], v[152:155], v[96:99]
    ds_read_b64_tr_b16 v[172:173], v11 offset:40960
    v_mfma_f32_16x16x32_bf16 v[104:107], v[32:35], v[156:159], v[104:107]
    ds_read_b128 v[120:123], v2 offset:21504
    s_waitcnt lgkmcnt(14)
    v_mfma_f32_16x16x32_bf16 v[100:103], v[36:39], v[152:155], v[100:103]
    ds_read_b64_tr_b16 v[174:175], v11 offset:41216
    buffer_load_dwordx4 v22, s[40:43], s48 offen offset:2048 sc1 lds
    v_mfma_f32_16x16x32_bf16 v[108:111], v[36:39], v[156:159], v[108:111]
    ds_read_b128 v[32:35], v2 offset:37888
    buffer_load_dwordx4 v23, s[40:43], s48 offen offset:3072 sc1 lds
    s_waitcnt lgkmcnt(1)
    v_mfma_f32_16x16x32_bf16 v[56:59], v[160:163], v[160:163], v[56:59]
    v_mfma_f32_16x16x32_bf16 v[60:63], v[164:167], v[164:167], v[60:63]
    v_mfma_f32_16x16x32_bf16 v[56:59], v[168:171], v[168:171], v[56:59]
    v_mfma_f32_16x16x32_bf16 v[60:63], v[172:175], v[172:175], v[60:63]
    s_waitcnt vmcnt(10)
    s_barrier
    s_waitcnt lgkmcnt(14)
    v_mfma_f32_16x16x32_bf16 v[64:67], v[160:163], v[40:43], v[64:67]
    s_add_u32 m0, s18, 131072
    s_add_u32 s48, s19, 98304
    v_mfma_f32_16x16x32_bf16 v[68:71], v[164:167], v[40:43], v[68:71]
    ds_read_b128 v[36:39], v12 offset:5120
    s_waitcnt lgkmcnt(13)
    v_mfma_f32_16x16x32_bf16 v[72:75], v[160:163], v[44:47], v[72:75]
    buffer_load_dwordx4 v20, s[40:43], s48 offen offset:0 sc1 lds
    buffer_load_dwordx4 v21, s[40:43], s48 offen offset:1024 sc1 lds
    v_mfma_f32_16x16x32_bf16 v[76:79], v[164:167], v[44:47], v[76:79]
    ds_read_b128 v[40:43], v12 offset:21504
    s_waitcnt lgkmcnt(12)
    v_mfma_f32_16x16x32_bf16 v[80:83], v[160:163], v[48:51], v[80:83]
    ds_read_b64_tr_b16 v[176:177], v10 offset:49152
    v_mfma_f32_16x16x32_bf16 v[84:87], v[164:167], v[48:51], v[84:87]
    ds_read_b128 v[44:47], v2 offset:6144
    s_waitcnt lgkmcnt(12)
    v_mfma_f32_16x16x32_bf16 v[96:99], v[52:55], v[160:163], v[96:99]
    ds_read_b64_tr_b16 v[178:179], v10 offset:49408
    v_mfma_f32_16x16x32_bf16 v[104:107], v[52:55], v[164:167], v[104:107]
    ds_read_b128 v[48:51], v2 offset:22528
    s_waitcnt lgkmcnt(12)
    v_mfma_f32_16x16x32_bf16 v[100:103], v[112:115], v[160:163], v[100:103]
    ds_read_b64_tr_b16 v[180:181], v11 offset:49152
    v_mfma_f32_16x16x32_bf16 v[108:111], v[112:115], v[164:167], v[108:111]
    ds_read_b128 v[52:55], v2 offset:38912
    s_waitcnt lgkmcnt(12)
    v_mfma_f32_16x16x32_bf16 v[64:67], v[168:171], v[116:119], v[64:67]
    ds_read_b64_tr_b16 v[182:183], v11 offset:49408
    v_mfma_f32_16x16x32_bf16 v[68:71], v[172:175], v[116:119], v[68:71]
    ds_read_b128 v[112:115], v12 offset:6144
    s_waitcnt lgkmcnt(12)
    v_mfma_f32_16x16x32_bf16 v[72:75], v[168:171], v[120:123], v[72:75]
    ds_read_b64_tr_b16 v[184:185], v10 offset:57344
    v_mfma_f32_16x16x32_bf16 v[76:79], v[172:175], v[120:123], v[76:79]
    ds_read_b128 v[116:119], v12 offset:22528
    s_waitcnt lgkmcnt(12)
    v_mfma_f32_16x16x32_bf16 v[80:83], v[168:171], v[32:35], v[80:83]
    ds_read_b64_tr_b16 v[186:187], v10 offset:57600
    v_mfma_f32_16x16x32_bf16 v[84:87], v[172:175], v[32:35], v[84:87]
    ds_read_b128 v[120:123], v2 offset:7168
    s_waitcnt lgkmcnt(13)
    v_mfma_f32_16x16x32_bf16 v[96:99], v[36:39], v[168:171], v[96:99]
    ds_read_b64_tr_b16 v[188:189], v11 offset:57344
    v_mfma_f32_16x16x32_bf16 v[104:107], v[36:39], v[172:175], v[104:107]
    ds_read_b128 v[32:35], v2 offset:23552
    s_waitcnt lgkmcnt(14)
    v_mfma_f32_16x16x32_bf16 v[100:103], v[40:43], v[168:171], v[100:103]
    ds_read_b64_tr_b16 v[190:191], v11 offset:57600
    buffer_load_dwordx4 v22, s[40:43], s48 offen offset:2048 sc1 lds
    v_mfma_f32_16x16x32_bf16 v[108:111], v[40:43], v[172:175], v[108:111]
    ds_read_b128 v[36:39], v2 offset:39936
    buffer_load_dwordx4 v23, s[40:43], s48 offen offset:3072 sc1 lds
    s_waitcnt lgkmcnt(1)
    v_mfma_f32_16x16x32_bf16 v[56:59], v[176:179], v[176:179], v[56:59]
    v_mfma_f32_16x16x32_bf16 v[60:63], v[180:183], v[180:183], v[60:63]
    v_mfma_f32_16x16x32_bf16 v[56:59], v[184:187], v[184:187], v[56:59]
    v_mfma_f32_16x16x32_bf16 v[60:63], v[188:191], v[188:191], v[60:63]
    s_waitcnt vmcnt(8)
    s_barrier
    s_waitcnt lgkmcnt(14)
    v_mfma_f32_16x16x32_bf16 v[64:67], v[176:179], v[44:47], v[64:67]
    s_add_u32 m0, s18, 147456
    s_add_u32 s48, s19, 114688
    v_mfma_f32_16x16x32_bf16 v[68:71], v[180:183], v[44:47], v[68:71]
    ds_read_b128 v[40:43], v12 offset:7168
    s_waitcnt lgkmcnt(13)
    v_mfma_f32_16x16x32_bf16 v[72:75], v[176:179], v[48:51], v[72:75]
    buffer_load_dwordx4 v20, s[40:43], s48 offen offset:0 sc1 lds
    buffer_load_dwordx4 v21, s[40:43], s48 offen offset:1024 sc1 lds
    v_mfma_f32_16x16x32_bf16 v[76:79], v[180:183], v[48:51], v[76:79]
    ds_read_b128 v[44:47], v12 offset:23552
    s_waitcnt lgkmcnt(12)
    v_mfma_f32_16x16x32_bf16 v[80:83], v[176:179], v[52:55], v[80:83]
    ds_read_b64_tr_b16 v[192:193], v10 offset:0
    v_mfma_f32_16x16x32_bf16 v[84:87], v[180:183], v[52:55], v[84:87]
    ds_read_b128 v[48:51], v2 offset:8192
    s_waitcnt lgkmcnt(12)
    v_mfma_f32_16x16x32_bf16 v[96:99], v[112:115], v[176:179], v[96:99]
    ds_read_b64_tr_b16 v[194:195], v10 offset:256
    v_mfma_f32_16x16x32_bf16 v[104:107], v[112:115], v[180:183], v[104:107]
    ds_read_b128 v[52:55], v2 offset:24576
    s_waitcnt lgkmcnt(12)
    v_mfma_f32_16x16x32_bf16 v[100:103], v[116:119], v[176:179], v[100:103]
    ds_read_b64_tr_b16 v[196:197], v11 offset:0
    v_mfma_f32_16x16x32_bf16 v[108:111], v[116:119], v[180:183], v[108:111]
    ds_read_b128 v[112:115], v2 offset:40960
    s_waitcnt lgkmcnt(12)
    v_mfma_f32_16x16x32_bf16 v[64:67], v[184:187], v[120:123], v[64:67]
    ds_read_b64_tr_b16 v[198:199], v11 offset:256
    v_mfma_f32_16x16x32_bf16 v[68:71], v[188:191], v[120:123], v[68:71]
    ds_read_b128 v[116:119], v12 offset:8192
    s_waitcnt lgkmcnt(12)
    v_mfma_f32_16x16x32_bf16 v[72:75], v[184:187], v[32:35], v[72:75]
    ds_read_b64_tr_b16 v[200:201], v10 offset:8192
    v_mfma_f32_16x16x32_bf16 v[76:79], v[188:191], v[32:35], v[76:79]
    ds_read_b128 v[120:123], v12 offset:24576
    s_waitcnt lgkmcnt(12)
    v_mfma_f32_16x16x32_bf16 v[80:83], v[184:187], v[36:39], v[80:83]
    ds_read_b64_tr_b16 v[202:203], v10 offset:8448
    v_mfma_f32_16x16x32_bf16 v[84:87], v[188:191], v[36:39], v[84:87]
    ds_read_b128 v[32:35], v2 offset:9216
    s_waitcnt lgkmcnt(13)
    v_mfma_f32_16x16x32_bf16 v[96:99], v[40:43], v[184:187], v[96:99]
    ds_read_b64_tr_b16 v[204:205], v11 offset:8192
    v_mfma_f32_16x16x32_bf16 v[104:107], v[40:43], v[188:191], v[104:107]
    ds_read_b128 v[36:39], v2 offset:25600
    s_waitcnt lgkmcnt(14)
    v_mfma_f32_16x16x32_bf16 v[100:103], v[44:47], v[184:187], v[100:103]
    ds_read_b64_tr_b16 v[206:207], v11 offset:8448
    buffer_load_dwordx4 v22, s[40:43], s48 offen offset:2048 sc1 lds
    v_mfma_f32_16x16x32_bf16 v[108:111], v[44:47], v[188:191], v[108:111]
    ds_read_b128 v[40:43], v2 offset:41984
    buffer_load_dwordx4 v23, s[40:43], s48 offen offset:3072 sc1 lds
    s_waitcnt lgkmcnt(1)
    v_mfma_f32_16x16x32_bf16 v[56:59], v[192:195], v[192:195], v[56:59]
    v_mfma_f32_16x16x32_bf16 v[60:63], v[196:199], v[196:199], v[60:63]
    v_mfma_f32_16x16x32_bf16 v[56:59], v[200:203], v[200:203], v[56:59]
    v_mfma_f32_16x16x32_bf16 v[60:63], v[204:207], v[204:207], v[60:63]
    s_waitcnt vmcnt(8)
    s_barrier
    s_waitcnt lgkmcnt(14)
    v_mfma_f32_16x16x32_bf16 v[64:67], v[192:195], v[48:51], v[64:67]
    s_lshl_b32 s51, s44, 12
    s_add_u32 m0, s51, 98304
    v_mfma_f32_16x16x32_bf16 v[68:71], v[196:199], v[48:51], v[68:71]
    ds_read_b128 v[44:47], v12 offset:9216
    s_waitcnt lgkmcnt(13)
    v_mfma_f32_16x16x32_bf16 v[72:75], v[192:195], v[52:55], v[72:75]
    s_add_u32 s51, s51, s20
    buffer_load_dwordx4 v2, s[40:43], s51 offen sc1 lds
    v_mfma_f32_16x16x32_bf16 v[76:79], v[196:199], v[52:55], v[76:79]
    ds_read_b128 v[48:51], v12 offset:25600
    s_waitcnt lgkmcnt(12)
    v_mfma_f32_16x16x32_bf16 v[80:83], v[192:195], v[112:115], v[80:83]
    buffer_load_dwordx4 v2, s[40:43], s51 offen offset:1024 sc1 lds
    ds_read_b64_tr_b16 v[208:209], v10 offset:16384
    v_mfma_f32_16x16x32_bf16 v[84:87], v[196:199], v[112:115], v[84:87]
    ds_read_b128 v[52:55], v2 offset:10240
    s_waitcnt lgkmcnt(12)
    v_mfma_f32_16x16x32_bf16 v[96:99], v[116:119], v[192:195], v[96:99]
    ds_read_b64_tr_b16 v[210:211], v10 offset:16640
    v_mfma_f32_16x16x32_bf16 v[104:107], v[116:119], v[196:199], v[104:107]
    ds_read_b128 v[112:115], v2 offset:26624
    s_waitcnt lgkmcnt(12)
    v_mfma_f32_16x16x32_bf16 v[100:103], v[120:123], v[192:195], v[100:103]
    ds_read_b64_tr_b16 v[212:213], v11 offset:16384
    v_mfma_f32_16x16x32_bf16 v[108:111], v[120:123], v[196:199], v[108:111]
    ds_read_b128 v[116:119], v2 offset:43008
    s_waitcnt lgkmcnt(12)
    v_mfma_f32_16x16x32_bf16 v[64:67], v[200:203], v[32:35], v[64:67]
    ds_read_b64_tr_b16 v[214:215], v11 offset:16640
    v_mfma_f32_16x16x32_bf16 v[68:71], v[204:207], v[32:35], v[68:71]
    ds_read_b128 v[120:123], v12 offset:10240
    s_waitcnt lgkmcnt(12)
    v_mfma_f32_16x16x32_bf16 v[72:75], v[200:203], v[36:39], v[72:75]
    ds_read_b64_tr_b16 v[216:217], v10 offset:24576
    v_mfma_f32_16x16x32_bf16 v[76:79], v[204:207], v[36:39], v[76:79]
    ds_read_b128 v[32:35], v12 offset:26624
    s_waitcnt lgkmcnt(12)
    v_mfma_f32_16x16x32_bf16 v[80:83], v[200:203], v[40:43], v[80:83]
    ds_read_b64_tr_b16 v[218:219], v10 offset:24832
    v_mfma_f32_16x16x32_bf16 v[84:87], v[204:207], v[40:43], v[84:87]
    ds_read_b128 v[36:39], v2 offset:11264
    s_waitcnt lgkmcnt(13)
    v_mfma_f32_16x16x32_bf16 v[96:99], v[44:47], v[200:203], v[96:99]
    ds_read_b64_tr_b16 v[220:221], v11 offset:24576
    v_mfma_f32_16x16x32_bf16 v[104:107], v[44:47], v[204:207], v[104:107]
    ds_read_b128 v[40:43], v2 offset:27648
    s_waitcnt lgkmcnt(14)
    v_mfma_f32_16x16x32_bf16 v[100:103], v[48:51], v[200:203], v[100:103]
    ds_read_b64_tr_b16 v[222:223], v11 offset:24832
    buffer_load_dwordx4 v2, s[40:43], s51 offen offset:2048 sc1 lds
    v_mfma_f32_16x16x32_bf16 v[108:111], v[48:51], v[204:207], v[108:111]
    ds_read_b128 v[44:47], v2 offset:44032
    buffer_load_dwordx4 v2, s[40:43], s51 offen offset:3072 sc1 lds
    s_waitcnt lgkmcnt(1)
    v_mfma_f32_16x16x32_bf16 v[56:59], v[208:211], v[208:211], v[56:59]
    v_mfma_f32_16x16x32_bf16 v[60:63], v[212:215], v[212:215], v[60:63]
    v_mfma_f32_16x16x32_bf16 v[56:59], v[216:219], v[216:219], v[56:59]
    v_mfma_f32_16x16x32_bf16 v[60:63], v[220:223], v[220:223], v[60:63]
    s_waitcnt vmcnt(8)
    s_barrier
    s_waitcnt lgkmcnt(14)
    v_mfma_f32_16x16x32_bf16 v[64:67], v[208:211], v[52:55], v[64:67]
    s_lshl_b32 s51, s44, 12
    s_add_u32 m0, s51, 114688
    v_mfma_f32_16x16x32_bf16 v[68:71], v[212:215], v[52:55], v[68:71]
    ds_read_b128 v[48:51], v12 offset:11264
    s_waitcnt lgkmcnt(13)
    v_mfma_f32_16x16x32_bf16 v[72:75], v[208:211], v[112:115], v[72:75]
    s_add_u32 s51, s51, s21
    buffer_load_dwordx4 v2, s[40:43], s51 offen sc1 lds
    v_mfma_f32_16x16x32_bf16 v[76:79], v[212:215], v[112:115], v[76:79]
    ds_read_b128 v[52:55], v12 offset:27648
    s_waitcnt lgkmcnt(12)
    v_mfma_f32_16x16x32_bf16 v[80:83], v[208:211], v[116:119], v[80:83]
    buffer_load_dwordx4 v2, s[40:43], s51 offen offset:1024 sc1 lds
    ds_read_b64_tr_b16 v[224:225], v10 offset:32768
    v_mfma_f32_16x16x32_bf16 v[84:87], v[212:215], v[116:119], v[84:87]
    ds_read_b128 v[112:115], v2 offset:12288
    s_waitcnt lgkmcnt(12)
    v_mfma_f32_16x16x32_bf16 v[96:99], v[120:123], v[208:211], v[96:99]
    ds_read_b64_tr_b16 v[226:227], v10 offset:33024
    v_mfma_f32_16x16x32_bf16 v[104:107], v[120:123], v[212:215], v[104:107]
    ds_read_b128 v[116:119], v2 offset:28672
    s_waitcnt lgkmcnt(12)
    v_mfma_f32_16x16x32_bf16 v[100:103], v[32:35], v[208:211], v[100:103]
    ds_read_b64_tr_b16 v[228:229], v11 offset:32768
    v_mfma_f32_16x16x32_bf16 v[108:111], v[32:35], v[212:215], v[108:111]
    ds_read_b128 v[120:123], v2 offset:45056
    s_waitcnt lgkmcnt(12)
    v_mfma_f32_16x16x32_bf16 v[64:67], v[216:219], v[36:39], v[64:67]
    ds_read_b64_tr_b16 v[230:231], v11 offset:33024
    v_mfma_f32_16x16x32_bf16 v[68:71], v[220:223], v[36:39], v[68:71]
    ds_read_b128 v[32:35], v12 offset:12288
    s_waitcnt lgkmcnt(12)
    v_mfma_f32_16x16x32_bf16 v[72:75], v[216:219], v[40:43], v[72:75]
    ds_read_b64_tr_b16 v[232:233], v10 offset:40960
    v_mfma_f32_16x16x32_bf16 v[76:79], v[220:223], v[40:43], v[76:79]
    ds_read_b128 v[36:39], v12 offset:28672
    s_waitcnt lgkmcnt(12)
    v_mfma_f32_16x16x32_bf16 v[80:83], v[216:219], v[44:47], v[80:83]
    ds_read_b64_tr_b16 v[234:235], v10 offset:41216
    v_mfma_f32_16x16x32_bf16 v[84:87], v[220:223], v[44:47], v[84:87]
    ds_read_b128 v[40:43], v2 offset:13312
    s_waitcnt lgkmcnt(13)
    v_mfma_f32_16x16x32_bf16 v[96:99], v[48:51], v[216:219], v[96:99]
    ds_read_b64_tr_b16 v[236:237], v11 offset:40960
    v_mfma_f32_16x16x32_bf16 v[104:107], v[48:51], v[220:223], v[104:107]
    ds_read_b128 v[44:47], v2 offset:29696
    s_waitcnt lgkmcnt(14)
    v_mfma_f32_16x16x32_bf16 v[100:103], v[52:55], v[216:219], v[100:103]
    ds_read_b64_tr_b16 v[238:239], v11 offset:41216
    buffer_load_dwordx4 v2, s[40:43], s51 offen offset:2048 sc1 lds
    v_mfma_f32_16x16x32_bf16 v[108:111], v[52:55], v[220:223], v[108:111]
    ds_read_b128 v[48:51], v2 offset:46080
    buffer_load_dwordx4 v2, s[40:43], s51 offen offset:3072 sc1 lds
    s_waitcnt lgkmcnt(1)
    v_mfma_f32_16x16x32_bf16 v[56:59], v[224:227], v[224:227], v[56:59]
    v_mfma_f32_16x16x32_bf16 v[60:63], v[228:231], v[228:231], v[60:63]
    v_mfma_f32_16x16x32_bf16 v[56:59], v[232:235], v[232:235], v[56:59]
    v_mfma_f32_16x16x32_bf16 v[60:63], v[236:239], v[236:239], v[60:63]
    s_waitcnt vmcnt(8)
    s_barrier
    s_waitcnt lgkmcnt(14)
    v_mfma_f32_16x16x32_bf16 v[64:67], v[224:227], v[112:115], v[64:67]
    s_lshl_b32 s51, s44, 12
    s_add_u32 m0, s51, 131072
    v_mfma_f32_16x16x32_bf16 v[68:71], v[228:231], v[112:115], v[68:71]
    ds_read_b128 v[52:55], v12 offset:13312
    s_waitcnt lgkmcnt(13)
    v_mfma_f32_16x16x32_bf16 v[72:75], v[224:227], v[116:119], v[72:75]
    s_add_u32 s51, s51, s22
    buffer_load_dwordx4 v2, s[40:43], s51 offen sc1 lds
    v_mfma_f32_16x16x32_bf16 v[76:79], v[228:231], v[116:119], v[76:79]
    ds_read_b128 v[112:115], v12 offset:29696
    s_waitcnt lgkmcnt(12)
    v_mfma_f32_16x16x32_bf16 v[80:83], v[224:227], v[120:123], v[80:83]
    buffer_load_dwordx4 v2, s[40:43], s51 offen offset:1024 sc1 lds
    ds_read_b64_tr_b16 v[240:241], v10 offset:49152
    v_mfma_f32_16x16x32_bf16 v[84:87], v[228:231], v[120:123], v[84:87]
    ds_read_b128 v[116:119], v2 offset:14336
    s_waitcnt lgkmcnt(12)
    v_mfma_f32_16x16x32_bf16 v[96:99], v[32:35], v[224:227], v[96:99]
    ds_read_b64_tr_b16 v[242:243], v10 offset:49408
    v_mfma_f32_16x16x32_bf16 v[104:107], v[32:35], v[228:231], v[104:107]
    ds_read_b128 v[120:123], v2 offset:30720
    s_waitcnt lgkmcnt(12)
    v_mfma_f32_16x16x32_bf16 v[100:103], v[36:39], v[224:227], v[100:103]
    ds_read_b64_tr_b16 v[244:245], v11 offset:49152
    v_mfma_f32_16x16x32_bf16 v[108:111], v[36:39], v[228:231], v[108:111]
    ds_read_b128 v[32:35], v2 offset:47104
    s_waitcnt lgkmcnt(12)
    v_mfma_f32_16x16x32_bf16 v[64:67], v[232:235], v[40:43], v[64:67]
    ds_read_b64_tr_b16 v[246:247], v11 offset:49408
    v_mfma_f32_16x16x32_bf16 v[68:71], v[236:239], v[40:43], v[68:71]
    ds_read_b128 v[36:39], v12 offset:14336
    s_waitcnt lgkmcnt(12)
    v_mfma_f32_16x16x32_bf16 v[72:75], v[232:235], v[44:47], v[72:75]
    ds_read_b64_tr_b16 v[248:249], v10 offset:57344
    v_mfma_f32_16x16x32_bf16 v[76:79], v[236:239], v[44:47], v[76:79]
    ds_read_b128 v[40:43], v12 offset:30720
    s_waitcnt lgkmcnt(12)
    v_mfma_f32_16x16x32_bf16 v[80:83], v[232:235], v[48:51], v[80:83]
    ds_read_b64_tr_b16 v[250:251], v10 offset:57600
    v_mfma_f32_16x16x32_bf16 v[84:87], v[236:239], v[48:51], v[84:87]
    ds_read_b128 v[44:47], v2 offset:15360
    s_waitcnt lgkmcnt(13)
    v_mfma_f32_16x16x32_bf16 v[96:99], v[52:55], v[232:235], v[96:99]
    ds_read_b64_tr_b16 v[252:253], v11 offset:57344
    v_mfma_f32_16x16x32_bf16 v[104:107], v[52:55], v[236:239], v[104:107]
    ds_read_b128 v[48:51], v2 offset:31744
    s_waitcnt lgkmcnt(14)
    v_mfma_f32_16x16x32_bf16 v[100:103], v[112:115], v[232:235], v[100:103]
    ds_read_b64_tr_b16 v[254:255], v11 offset:57600
    buffer_load_dwordx4 v2, s[40:43], s51 offen offset:2048 sc1 lds
    v_mfma_f32_16x16x32_bf16 v[108:111], v[112:115], v[236:239], v[108:111]
    ds_read_b128 v[52:55], v2 offset:48128
    buffer_load_dwordx4 v2, s[40:43], s51 offen offset:3072 sc1 lds
    s_waitcnt lgkmcnt(1)
    v_mfma_f32_16x16x32_bf16 v[56:59], v[240:243], v[240:243], v[56:59]
    v_mfma_f32_16x16x32_bf16 v[60:63], v[244:247], v[244:247], v[60:63]
    v_mfma_f32_16x16x32_bf16 v[56:59], v[248:251], v[248:251], v[56:59]
    v_mfma_f32_16x16x32_bf16 v[60:63], v[252:255], v[252:255], v[60:63]
    s_waitcnt lgkmcnt(14)
    v_mfma_f32_16x16x32_bf16 v[64:67], v[240:243], v[116:119], v[64:67]
    v_mfma_f32_16x16x32_bf16 v[68:71], v[244:247], v[116:119], v[68:71]
    ds_read_b128 v[112:115], v12 offset:15360
    s_waitcnt lgkmcnt(13)
    v_mfma_f32_16x16x32_bf16 v[72:75], v[240:243], v[120:123], v[72:75]
    v_mov_b32 v10, v18
    v_mov_b32 v11, v19
    v_mfma_f32_16x16x32_bf16 v[76:79], v[244:247], v[120:123], v[76:79]
    ds_read_b128 v[116:119], v12 offset:31744
    s_waitcnt lgkmcnt(12)
    v_mfma_f32_16x16x32_bf16 v[80:83], v[240:243], v[32:35], v[80:83]
    v_cndmask_b32 v18, v56, v57, s[4:5]
    v_cndmask_b32 v16, v58, v59, s[4:5]
    v_mfma_f32_16x16x32_bf16 v[84:87], v[244:247], v[32:35], v[84:87]
    v_cndmask_b32 v16, v18, v16, s[6:7]
    s_waitcnt lgkmcnt(10)
    v_mfma_f32_16x16x32_bf16 v[96:99], v[36:39], v[240:243], v[96:99]
    v_cndmask_b32 v18, v60, v61, s[4:5]
    v_cndmask_b32 v17, v62, v63, s[4:5]
    v_mfma_f32_16x16x32_bf16 v[104:107], v[36:39], v[244:247], v[104:107]
    v_cndmask_b32 v17, v18, v17, s[6:7]
    s_waitcnt lgkmcnt(8)
    v_mfma_f32_16x16x32_bf16 v[100:103], v[40:43], v[240:243], v[100:103]
    ds_bpermute_b32 v56, v13, v16 offset:0
    ds_bpermute_b32 v57, v13, v16 offset:4
    v_mfma_f32_16x16x32_bf16 v[108:111], v[40:43], v[244:247], v[108:111]
    ds_bpermute_b32 v58, v13, v16 offset:8
    s_waitcnt lgkmcnt(9)
    v_mfma_f32_16x16x32_bf16 v[64:67], v[248:251], v[44:47], v[64:67]
    ds_bpermute_b32 v59, v13, v16 offset:12
    ds_bpermute_b32 v60, v13, v17 offset:0
    v_mfma_f32_16x16x32_bf16 v[68:71], v[252:255], v[44:47], v[68:71]
    ds_bpermute_b32 v61, v13, v17 offset:4
    s_waitcnt lgkmcnt(10)
    v_mfma_f32_16x16x32_bf16 v[72:75], v[248:251], v[48:51], v[72:75]
    ds_bpermute_b32 v62, v13, v17 offset:8
    ds_bpermute_b32 v63, v13, v17 offset:12
    v_mfma_f32_16x16x32_bf16 v[76:79], v[252:255], v[48:51], v[76:79]
    ds_bpermute_b32 v26, v9, v16
    s_waitcnt lgkmcnt(11)
    v_mfma_f32_16x16x32_bf16 v[80:83], v[248:251], v[52:55], v[80:83]
    ds_bpermute_b32 v28, v9, v17
    v_mov_b32_e64 v18, 0x3f000000
    v_mfma_f32_16x16x32_bf16 v[84:87], v[252:255], v[52:55], v[84:87]
    v_mov_b32 v20, 0x3b27c5ac
    s_waitcnt lgkmcnt(11)
    v_mfma_f32_16x16x32_bf16 v[96:99], v[112:115], v[248:251], v[96:99]
    v_mfma_f32_16x16x32_bf16 v[104:107], v[112:115], v[252:255], v[104:107]
    s_waitcnt lgkmcnt(10)
    v_mfma_f32_16x16x32_bf16 v[100:103], v[116:119], v[248:251], v[100:103]
    v_mfma_f32_16x16x32_bf16 v[108:111], v[116:119], v[252:255], v[108:111]
    s_waitcnt lgkmcnt(0)
    s_barrier
    s_lshl_b32 s49, s66, 2
    s_add_u32 s49, s49, s44
    s_add_u32 s16, s68, 4
    s_lshl_b32 s16, s16, 6
    s_add_u32 s16, s16, s49
    s_lshl_b32 s16, s16, 10
    s_add_u32 s16, s16, 13631488
    v_mov_b32 v116, -1
    v_mov_b32 v117, -1
    v_mov_b32 v118, -1
    v_mov_b32 v119, -1
    v_lshlrev_b32 v115, 3, v1
    s_lshl_b32 s53, s64, 3
    s_add_u32 s53, s53, s65
    s_lshl_b32 s53, s53, 2
    s_add_u32 s53, s53, s44
    s_mul_i32 s53, s53, 3584
    s_add_u32 s53, s53, 19922944
    buffer_store_dwordx4 v[116:119], v2, s[40:43], s53 offen offset:0 sc1
    buffer_store_dwordx4 v[116:119], v2, s[40:43], s53 offen offset:1024 sc1
    buffer_store_dwordx4 v[116:119], v2, s[40:43], s53 offen offset:2048 sc1
    buffer_store_dwordx2 v[116:117], v115, s[40:43], s53 offen offset:3072 sc1
    s_mul_i32 s69, s44, 8320
    s_add_u32 s69, s69, 0
    s_cmp_eq_u32 s44, 3
    s_cselect_b32 s69, 24960, s69
    s_mov_b32 m0, s69
    s_add_u32 s69, s44, 2
    s_and_b32 s69, s69, 3
    s_lshl_b32 s69, s69, 16
    s_add_u32 s69, s69, s61
    s_xor_b32 s69, s69, 512
    buffer_load_dwordx4 v5, s[24:27], s69 offen lds
    s_add_u32 m0, m0, 1040
    s_add_u32 s69, s69, 4096
    buffer_load_dwordx4 v5, s[24:27], s69 offen lds
    s_add_u32 m0, m0, 1040
    s_add_u32 s69, s69, 4096
    buffer_load_dwordx4 v5, s[24:27], s69 offen lds
    s_add_u32 m0, m0, 1040
    s_add_u32 s69, s69, 4096
    v_pk_fma_f32 v[56:57], v[56:57], v[18:19], v[20:21] op_sel_hi:[1,0,0]
    v_pk_fma_f32 v[58:59], v[58:59], v[18:19], v[20:21] op_sel_hi:[1,0,0]
    v_pk_fma_f32 v[60:61], v[60:61], v[18:19], v[20:21] op_sel_hi:[1,0,0]
    v_pk_fma_f32 v[62:63], v[62:63], v[18:19], v[20:21] op_sel_hi:[1,0,0]
    v_fma_f32 v26, v26, v18, v20
    v_fma_f32 v28, v28, v18, v20
    v_rsq_f32 v56, v56
    v_rsq_f32 v57, v57
    v_rsq_f32 v58, v58
    v_rsq_f32 v59, v59
    v_rsq_f32 v60, v60
    v_rsq_f32 v61, v61
    v_rsq_f32 v62, v62
    v_rsq_f32 v63, v63
    v_rsq_f32 v26, v26
    v_rsq_f32 v28, v28
    v_pk_mul_f32 v[64:65], v[64:65], v[56:57]
    v_pk_mul_f32 v[68:69], v[68:69], v[60:61]
    v_pk_mul_f32 v[66:67], v[66:67], v[58:59]
    v_pk_mul_f32 v[70:71], v[70:71], v[62:63]
    v_pk_mul_f32 v[16:17], v[64:65], v[64:65]
    v_pk_mul_f32 v[20:21], v[68:69], v[68:69]
    v_pk_mul_f32 v[18:19], v[66:67], v[66:67]
    v_pk_mul_f32 v[22:23], v[70:71], v[70:71]
    v_pk_fma_f32 v[16:17], v[16:17], v[30:31], v[14:15] op_sel_hi:[1,0,0]
    v_pk_fma_f32 v[20:21], v[20:21], v[30:31], v[14:15] op_sel_hi:[1,0,0]
    v_pk_fma_f32 v[18:19], v[18:19], v[30:31], v[14:15] op_sel_hi:[1,0,0]
    v_pk_fma_f32 v[22:23], v[22:23], v[30:31], v[14:15] op_sel_hi:[1,0,0]
    v_pk_mul_f32 v[16:17], v[16:17], v[64:65]
    v_pk_mul_f32 v[20:21], v[20:21], v[68:69]
    v_pk_mul_f32 v[18:19], v[18:19], v[66:67]
    v_pk_mul_f32 v[22:23], v[22:23], v[70:71]
    v_exp_f32 v16, v16
    v_exp_f32 v20, v20
    v_exp_f32 v17, v17
    v_exp_f32 v21, v21
    v_exp_f32 v18, v18
    v_exp_f32 v22, v22
    v_exp_f32 v19, v19
    v_exp_f32 v23, v23
    v_pk_add_f32 v[16:17], v[16:17], 1.0 op_sel_hi:[1,0]
    v_pk_add_f32 v[20:21], v[20:21], 1.0 op_sel_hi:[1,0]
    v_pk_add_f32 v[18:19], v[18:19], 1.0 op_sel_hi:[1,0]
    v_pk_add_f32 v[22:23], v[22:23], 1.0 op_sel_hi:[1,0]
    v_rcp_f32 v16, v16
    v_rcp_f32 v20, v20
    v_rcp_f32 v17, v17
    v_rcp_f32 v21, v21
    v_rcp_f32 v18, v18
    v_rcp_f32 v22, v22
    v_rcp_f32 v19, v19
    v_rcp_f32 v23, v23
    v_pk_mul_f32 v[64:65], v[64:65], v[16:17]
    v_pk_mul_f32 v[68:69], v[68:69], v[20:21]
    v_pk_mul_f32 v[66:67], v[66:67], v[18:19]
    v_pk_mul_f32 v[70:71], v[70:71], v[22:23]
    buffer_load_dwordx4 v5, s[24:27], s69 offen lds
    s_add_u32 m0, m0, 1040
    s_add_u32 s69, s69, 4096
    v_pk_mul_f32 v[40:41], v[64:65], v[64:65]
    v_pk_mul_f32 v[42:43], v[66:67], v[66:67]
    v_pk_mul_f32 v[44:45], v[68:69], v[68:69]
    v_pk_mul_f32 v[46:47], v[70:71], v[70:71]
    v_pk_mul_f32 v[72:73], v[72:73], v[56:57]
    v_pk_mul_f32 v[76:77], v[76:77], v[60:61]
    v_pk_mul_f32 v[74:75], v[74:75], v[58:59]
    v_pk_mul_f32 v[78:79], v[78:79], v[62:63]
    v_pk_mul_f32 v[16:17], v[72:73], v[72:73]
    v_pk_mul_f32 v[20:21], v[76:77], v[76:77]
    v_pk_mul_f32 v[18:19], v[74:75], v[74:75]
    v_pk_mul_f32 v[22:23], v[78:79], v[78:79]
    v_pk_fma_f32 v[16:17], v[16:17], v[30:31], v[14:15] op_sel_hi:[1,0,0]
    v_pk_fma_f32 v[20:21], v[20:21], v[30:31], v[14:15] op_sel_hi:[1,0,0]
    v_pk_fma_f32 v[18:19], v[18:19], v[30:31], v[14:15] op_sel_hi:[1,0,0]
    v_pk_fma_f32 v[22:23], v[22:23], v[30:31], v[14:15] op_sel_hi:[1,0,0]
    v_pk_mul_f32 v[16:17], v[16:17], v[72:73]
    v_pk_mul_f32 v[20:21], v[20:21], v[76:77]
    v_pk_mul_f32 v[18:19], v[18:19], v[74:75]
    v_pk_mul_f32 v[22:23], v[22:23], v[78:79]
    v_exp_f32 v16, v16
    v_exp_f32 v20, v20
    v_exp_f32 v17, v17
    v_exp_f32 v21, v21
    v_exp_f32 v18, v18
    v_exp_f32 v22, v22
    v_exp_f32 v19, v19
    v_exp_f32 v23, v23
    v_pk_add_f32 v[16:17], v[16:17], 1.0 op_sel_hi:[1,0]
    v_pk_add_f32 v[20:21], v[20:21], 1.0 op_sel_hi:[1,0]
    v_pk_add_f32 v[18:19], v[18:19], 1.0 op_sel_hi:[1,0]
    v_pk_add_f32 v[22:23], v[22:23], 1.0 op_sel_hi:[1,0]
    v_rcp_f32 v16, v16
    v_rcp_f32 v20, v20
    v_rcp_f32 v17, v17
    v_rcp_f32 v21, v21
    v_rcp_f32 v18, v18
    v_rcp_f32 v22, v22
    v_rcp_f32 v19, v19
    v_rcp_f32 v23, v23
    v_pk_mul_f32 v[72:73], v[72:73], v[16:17]
    v_pk_mul_f32 v[76:77], v[76:77], v[20:21]
    v_pk_mul_f32 v[74:75], v[74:75], v[18:19]
    v_pk_mul_f32 v[78:79], v[78:79], v[22:23]
    buffer_load_dwordx4 v5, s[24:27], s69 offen lds
    s_add_u32 m0, m0, 1040
    s_add_u32 s69, s69, 4096
    v_pk_add_f32 v[32:33], v[64:65], v[72:73]
    v_pk_fma_f32 v[40:41], v[72:73], v[72:73], v[40:41]
    v_pk_add_f32 v[34:35], v[66:67], v[74:75]
    v_pk_fma_f32 v[42:43], v[74:75], v[74:75], v[42:43]
    v_pk_add_f32 v[36:37], v[68:69], v[76:77]
    v_pk_fma_f32 v[44:45], v[76:77], v[76:77], v[44:45]
    v_pk_add_f32 v[38:39], v[70:71], v[78:79]
    v_pk_fma_f32 v[46:47], v[78:79], v[78:79], v[46:47]
    v_pk_mul_f32 v[80:81], v[80:81], v[56:57]
    v_pk_mul_f32 v[84:85], v[84:85], v[60:61]
    v_pk_mul_f32 v[82:83], v[82:83], v[58:59]
    v_pk_mul_f32 v[86:87], v[86:87], v[62:63]
    v_pk_mul_f32 v[16:17], v[80:81], v[80:81]
    v_pk_mul_f32 v[20:21], v[84:85], v[84:85]
    v_pk_mul_f32 v[18:19], v[82:83], v[82:83]
    v_pk_mul_f32 v[22:23], v[86:87], v[86:87]
    v_pk_fma_f32 v[16:17], v[16:17], v[30:31], v[14:15] op_sel_hi:[1,0,0]
    v_pk_fma_f32 v[20:21], v[20:21], v[30:31], v[14:15] op_sel_hi:[1,0,0]
    v_pk_fma_f32 v[18:19], v[18:19], v[30:31], v[14:15] op_sel_hi:[1,0,0]
    v_pk_fma_f32 v[22:23], v[22:23], v[30:31], v[14:15] op_sel_hi:[1,0,0]
    v_pk_mul_f32 v[16:17], v[16:17], v[80:81]
    v_pk_mul_f32 v[20:21], v[20:21], v[84:85]
    v_pk_mul_f32 v[18:19], v[18:19], v[82:83]
    v_pk_mul_f32 v[22:23], v[22:23], v[86:87]
    v_exp_f32 v16, v16
    v_exp_f32 v20, v20
    v_exp_f32 v17, v17
    v_exp_f32 v21, v21
    v_exp_f32 v18, v18
    v_exp_f32 v22, v22
    v_exp_f32 v19, v19
    v_exp_f32 v23, v23
    v_pk_add_f32 v[16:17], v[16:17], 1.0 op_sel_hi:[1,0]
    v_pk_add_f32 v[20:21], v[20:21], 1.0 op_sel_hi:[1,0]
    v_pk_add_f32 v[18:19], v[18:19], 1.0 op_sel_hi:[1,0]
    v_pk_add_f32 v[22:23], v[22:23], 1.0 op_sel_hi:[1,0]
    v_rcp_f32 v16, v16
    v_rcp_f32 v20, v20
    v_rcp_f32 v17, v17
    v_rcp_f32 v21, v21
    v_rcp_f32 v18, v18
    v_rcp_f32 v22, v22
    v_rcp_f32 v19, v19
    v_rcp_f32 v23, v23
    v_pk_mul_f32 v[80:81], v[80:81], v[16:17]
    v_pk_mul_f32 v[84:85], v[84:85], v[20:21]
    v_pk_mul_f32 v[82:83], v[82:83], v[18:19]
    v_pk_mul_f32 v[86:87], v[86:87], v[22:23]
    buffer_load_dwordx4 v5, s[24:27], s69 offen lds
    s_add_u32 m0, m0, 1040
    s_add_u32 s69, s69, 4096
    v_pk_add_f32 v[32:33], v[32:33], v[80:81]
    v_pk_fma_f32 v[40:41], v[80:81], v[80:81], v[40:41]
    v_pk_add_f32 v[34:35], v[34:35], v[82:83]
    v_pk_fma_f32 v[42:43], v[82:83], v[82:83], v[42:43]
    v_pk_add_f32 v[36:37], v[36:37], v[84:85]
    v_pk_fma_f32 v[44:45], v[84:85], v[84:85], v[44:45]
    v_pk_add_f32 v[38:39], v[38:39], v[86:87]
    v_pk_fma_f32 v[46:47], v[86:87], v[86:87], v[46:47]
    v_add_f32_dpp v32, v32, v32 row_ror:8 row_mask:0xf bank_mask:0x3
    v_add_f32_dpp v33, v33, v33 row_ror:8 row_mask:0xf bank_mask:0x3
    v_add_f32_dpp v34, v34, v34 row_ror:8 row_mask:0xf bank_mask:0x3
    v_add_f32_dpp v35, v35, v35 row_ror:8 row_mask:0xf bank_mask:0x3
    v_add_f32_dpp v40, v40, v40 row_ror:8 row_mask:0xf bank_mask:0x3
    v_add_f32_dpp v41, v41, v41 row_ror:8 row_mask:0xf bank_mask:0x3
    v_add_f32_dpp v42, v42, v42 row_ror:8 row_mask:0xf bank_mask:0x3
    v_add_f32_dpp v43, v43, v43 row_ror:8 row_mask:0xf bank_mask:0x3
    v_add_f32_dpp v32, v36, v36 row_ror:8 row_mask:0xf bank_mask:0xc
    v_add_f32_dpp v33, v37, v37 row_ror:8 row_mask:0xf bank_mask:0xc
    v_add_f32_dpp v34, v38, v38 row_ror:8 row_mask:0xf bank_mask:0xc
    v_add_f32_dpp v35, v39, v39 row_ror:8 row_mask:0xf bank_mask:0xc
    v_add_f32_dpp v40, v44, v44 row_ror:8 row_mask:0xf bank_mask:0xc
    v_add_f32_dpp v41, v45, v45 row_ror:8 row_mask:0xf bank_mask:0xc
    v_add_f32_dpp v42, v46, v46 row_ror:8 row_mask:0xf bank_mask:0xc
    v_add_f32_dpp v43, v47, v47 row_ror:8 row_mask:0xf bank_mask:0xc
    v_mov_b32 v17, s45
    v_mov_b32 v19, s45
    v_add_f32_dpp v32, v32, v32 row_half_mirror row_mask:0xf bank_mask:0x5
    v_add_f32_dpp v33, v33, v33 row_half_mirror row_mask:0xf bank_mask:0x5
    v_add_f32_dpp v40, v40, v40 row_half_mirror row_mask:0xf bank_mask:0x5
    v_add_f32_dpp v41, v41, v41 row_half_mirror row_mask:0xf bank_mask:0x5
    v_add_f32_dpp v32, v34, v34 row_half_mirror row_mask:0xf bank_mask:0xa
    v_add_f32_dpp v33, v35, v35 row_half_mirror row_mask:0xf bank_mask:0xa
    v_add_f32_dpp v40, v42, v42 row_half_mirror row_mask:0xf bank_mask:0xa
    v_add_f32_dpp v41, v43, v43 row_half_mirror row_mask:0xf bank_mask:0xa
    v_add_f32_dpp v32, v32, v32 quad_perm:[1,0,3,2] row_mask:0xf bank_mask:0xf
    v_add_f32_dpp v33, v33, v33 quad_perm:[1,0,3,2] row_mask:0xf bank_mask:0xf
    v_add_f32_dpp v40, v40, v40 quad_perm:[1,0,3,2] row_mask:0xf bank_mask:0xf
    v_add_f32_dpp v41, v41, v41 quad_perm:[1,0,3,2] row_mask:0xf bank_mask:0xf
    v_add_f32_dpp v32, v32, v32 quad_perm:[2,3,0,1] row_mask:0xf bank_mask:0xf
    v_add_f32_dpp v33, v33, v33 quad_perm:[2,3,0,1] row_mask:0xf bank_mask:0xf
    v_add_f32_dpp v40, v40, v40 quad_perm:[2,3,0,1] row_mask:0xf bank_mask:0xf
    v_add_f32_dpp v41, v41, v41 quad_perm:[2,3,0,1] row_mask:0xf bank_mask:0xf
    v_cndmask_b32 v16, v32, v33, s[4:5]
    v_cndmask_b32 v18, v40, v41, s[4:5]
    s_not_b64 exec, s[6:7]
    buffer_store_dwordx4 v[16:19], v25, s[40:43], s13 offen sc1
    s_mov_b64 exec, -1
    s_waitcnt vmcnt(11)
    s_barrier
    ds_read_b128 v[32:35], v2 offset:49152
    ds_read_b128 v[36:39], v2 offset:50176
    ds_read_b128 v[40:43], v2 offset:51200
    ds_read_b128 v[44:47], v2 offset:52224
    ds_read_b128 v[48:51], v2 offset:53248
    s_waitcnt lgkmcnt(3)
    v_mfma_f32_16x16x32_bf16 v[56:59], v[32:35], v[128:131], 0
    buffer_load_dwordx4 v5, s[24:27], s69 offen lds
    s_add_u32 m0, m0, 1040
    s_add_u32 s69, s69, 4096
    v_mfma_f32_16x16x32_bf16 v[60:63], v[32:35], v[132:135], 0
    ds_read_b128 v[52:55], v2 offset:54272
    buffer_load_dwordx4 v5, s[24:27], s69 offen lds
    v_mfma_f32_16x16x32_bf16 v[56:59], v[36:39], v[136:139], v[56:59]
    s_mul_i32 s69, s44, 8320
    s_add_u32 s69, s69, 65536
    s_cmp_eq_u32 s44, 3
    s_cselect_b32 s69, 147456, s69
    v_mfma_f32_16x16x32_bf16 v[60:63], v[36:39], v[140:143], v[60:63]
    ds_read_b128 v[32:35], v2 offset:55296
    s_mov_b32 m0, s69
    s_waitcnt lgkmcnt(3)
    v_mfma_f32_16x16x32_bf16 v[56:59], v[40:43], v[144:147], v[56:59]
    s_add_u32 s69, s44, 3
    s_and_b32 s69, s69, 3
    s_lshl_b32 s69, s69, 16
    v_mfma_f32_16x16x32_bf16 v[60:63], v[40:43], v[148:151], v[60:63]
    ds_read_b128 v[36:39], v2 offset:56320
    s_add_u32 s69, s69, s61
    buffer_load_dwordx4 v5, s[24:27], s69 offen lds
    v_mfma_f32_16x16x32_bf16 v[56:59], v[44:47], v[152:155], v[56:59]
    s_add_u32 m0, m0, 1040
    s_add_u32 s69, s69, 4096
    buffer_load_dwordx4 v5, s[24:27], s69 offen lds
    v_mfma_f32_16x16x32_bf16 v[60:63], v[44:47], v[156:159], v[60:63]
    ds_read_b128 v[40:43], v2 offset:57344
    s_add_u32 m0, m0, 1040
    s_waitcnt lgkmcnt(3)
    v_mfma_f32_16x16x32_bf16 v[56:59], v[48:51], v[160:163], v[56:59]
    s_add_u32 s69, s69, 4096
    buffer_load_dwordx4 v5, s[24:27], s69 offen lds
    s_add_u32 m0, m0, 1040
    v_mfma_f32_16x16x32_bf16 v[60:63], v[48:51], v[164:167], v[60:63]
    ds_read_b128 v[44:47], v2 offset:58368
    s_add_u32 s69, s69, 4096
    buffer_load_dwordx4 v5, s[24:27], s69 offen lds
    v_mfma_f32_16x16x32_bf16 v[56:59], v[52:55], v[168:171], v[56:59]
    s_add_u32 m0, m0, 1040
    s_add_u32 s69, s69, 4096
    buffer_load_dwordx4 v5, s[24:27], s69 offen lds
    v_mfma_f32_16x16x32_bf16 v[60:63], v[52:55], v[172:175], v[60:63]
    ds_read_b128 v[48:51], v2 offset:59392
    s_add_u32 m0, m0, 1040
    s_waitcnt lgkmcnt(3)
    v_mfma_f32_16x16x32_bf16 v[56:59], v[32:35], v[176:179], v[56:59]
    s_add_u32 s69, s69, 4096
    buffer_load_dwordx4 v5, s[24:27], s69 offen lds
    s_add_u32 m0, m0, 1040
    v_mfma_f32_16x16x32_bf16 v[60:63], v[32:35], v[180:183], v[60:63]
    ds_read_b128 v[52:55], v2 offset:60416
    s_add_u32 s69, s69, 4096
    buffer_load_dwordx4 v5, s[24:27], s69 offen lds
    v_mfma_f32_16x16x32_bf16 v[56:59], v[36:39], v[184:187], v[56:59]
    s_add_u32 m0, m0, 1040
    s_add_u32 s69, s69, 4096
    buffer_load_dwordx4 v5, s[24:27], s69 offen lds
    v_mfma_f32_16x16x32_bf16 v[60:63], v[36:39], v[188:191], v[60:63]
    ds_read_b128 v[32:35], v2 offset:61440
    s_lshl_b32 s17, s66, 3
    s_waitcnt lgkmcnt(3)
    v_mfma_f32_16x16x32_bf16 v[56:59], v[40:43], v[192:195], v[56:59]
    s_lshl_b32 s49, s44, 1
    s_add_u32 s17, s17, s49
    s_mul_i32 s14, s17, 56
    v_mfma_f32_16x16x32_bf16 v[60:63], v[40:43], v[196:199], v[60:63]
    ds_read_b128 v[36:39], v2 offset:62464
    s_add_u32 s14, s14, s68
    s_add_u32 s14, s14, 3
    v_mfma_f32_16x16x32_bf16 v[56:59], v[44:47], v[200:203], v[56:59]
    s_lshl_b32 s14, s14, 9
    s_add_u32 s14, s14, 9961472
    s_add_u32 s15, s14, 28672
    v_mfma_f32_16x16x32_bf16 v[60:63], v[44:47], v[204:207], v[60:63]
    ds_read_b128 v[40:43], v2 offset:63488
    s_lshl_b32 s17, s17, 4
    s_waitcnt lgkmcnt(3)
    v_mfma_f32_16x16x32_bf16 v[56:59], v[48:51], v[208:211], v[56:59]
    s_add_u32 s17, s17, s67
    s_lshl_b32 s17, s17, 10
    s_add_u32 s17, s17, 17825792
    v_mfma_f32_16x16x32_bf16 v[60:63], v[48:51], v[212:215], v[60:63]
    ds_read_b128 v[44:47], v2 offset:64512
    s_lshl_b32 s48, s44, 10
    s_add_u32 s48, s48, 90496
    v_mfma_f32_16x16x32_bf16 v[56:59], v[52:55], v[216:219], v[56:59]
    v_and_b32 v18, 31, v1
    v_lshl_add_u32 v9, v18, 2, s48
    v_lshl_add_u32 v13, v4, 4, s48
    v_mfma_f32_16x16x32_bf16 v[60:63], v[52:55], v[220:223], v[60:63]
    ds_read_b128 v[48:51], v12 offset:32768
    s_waitcnt lgkmcnt(3)
    v_mfma_f32_16x16x32_bf16 v[56:59], v[32:35], v[224:227], v[56:59]
    v_mfma_f32_16x16x32_bf16 v[60:63], v[32:35], v[228:231], v[60:63]
    ds_read_b128 v[52:55], v12 offset:33792
    v_mfma_f32_16x16x32_bf16 v[56:59], v[36:39], v[232:235], v[56:59]
    v_mfma_f32_16x16x32_bf16 v[60:63], v[36:39], v[236:239], v[60:63]
    ds_read_b128 v[32:35], v12 offset:34816
    s_waitcnt lgkmcnt(3)
    v_mfma_f32_16x16x32_bf16 v[56:59], v[40:43], v[240:243], v[56:59]
    v_mfma_f32_16x16x32_bf16 v[60:63], v[40:43], v[244:247], v[60:63]
    ds_read_b128 v[36:39], v12 offset:35840
    v_mfma_f32_16x16x32_bf16 v[56:59], v[44:47], v[248:251], v[56:59]
    s_mul_i32 s62, s44, 8320
    s_add_u32 s62, s62, 0
    s_cmp_eq_u32 s44, 3
    s_cselect_b32 s62, 24960, s62
    v_mfma_f32_16x16x32_bf16 v[60:63], v[44:47], v[252:255], v[60:63]
    ds_read_b128 v[40:43], v12 offset:36864
    v_add_u32 v6, s62, v27
    s_waitcnt lgkmcnt(3)
    v_mfma_f32_16x16x32_bf16 v[88:91], v[48:51], v[128:131], 0
    v_add_u32 v7, s62, v31
    s_waitcnt vmcnt(8)
    v_mfma_f32_16x16x32_bf16 v[92:95], v[48:51], v[132:135], 0
    ds_read_b128 v[44:47], v12 offset:37888
    v_mfma_f32_16x16x32_bf16 v[88:91], v[52:55], v[136:139], v[88:91]
    ds_read_b128 a[160:163], v6 offset:0
    v_mfma_f32_16x16x32_bf16 v[92:95], v[52:55], v[140:143], v[92:95]
    ds_read_b128 v[48:51], v12 offset:38912
    s_waitcnt lgkmcnt(4)
    v_mfma_f32_16x16x32_bf16 v[88:91], v[32:35], v[144:147], v[88:91]
    ds_read_b128 a[164:167], v6 offset:64
    v_mfma_f32_16x16x32_bf16 v[92:95], v[32:35], v[148:151], v[92:95]
    ds_read_b128 v[52:55], v12 offset:39936
    v_mfma_f32_16x16x32_bf16 v[88:91], v[36:39], v[152:155], v[88:91]
    ds_read_b128 a[168:171], v7 offset:0
    v_mfma_f32_16x16x32_bf16 v[92:95], v[36:39], v[156:159], v[92:95]
    ds_read_b128 v[32:35], v12 offset:40960
    s_waitcnt lgkmcnt(6)
    v_mfma_f32_16x16x32_bf16 v[88:91], v[40:43], v[160:163], v[88:91]
    ds_read_b128 a[172:175], v7 offset:64
    v_mfma_f32_16x16x32_bf16 v[92:95], v[40:43], v[164:167], v[92:95]
    ds_read_b128 v[36:39], v12 offset:41984
    v_mfma_f32_16x16x32_bf16 v[88:91], v[44:47], v[168:171], v[88:91]
    ds_read_b128 a[176:179], v6 offset:256
    v_mfma_f32_16x16x32_bf16 v[92:95], v[44:47], v[172:175], v[92:95]
    ds_read_b128 v[40:43], v12 offset:43008
    s_waitcnt lgkmcnt(6)
    v_mfma_f32_16x16x32_bf16 v[88:91], v[48:51], v[176:179], v[88:91]
    ds_read_b128 a[180:183], v6 offset:320
    v_mfma_f32_16x16x32_bf16 v[92:95], v[48:51], v[180:183], v[92:95]
    ds_read_b128 v[44:47], v12 offset:44032
    v_mfma_f32_16x16x32_bf16 v[88:91], v[52:55], v[184:187], v[88:91]
    ds_read_b128 a[184:187], v7 offset:256
    v_mfma_f32_16x16x32_bf16 v[92:95], v[52:55], v[188:191], v[92:95]
    ds_read_b128 v[48:51], v12 offset:45056
    s_waitcnt lgkmcnt(6)
    v_mfma_f32_16x16x32_bf16 v[88:91], v[32:35], v[192:195], v[88:91]
    ds_read_b128 a[188:191], v7 offset:320
    v_and_b32 v17, 3, v1
    v_lshlrev_b32 v17, 6, v17
    v_mfma_f32_16x16x32_bf16 v[92:95], v[32:35], v[196:199], v[92:95]
    ds_read_b128 v[52:55], v12 offset:46080
    v_and_b32 v19, 60, v1
    v_add_u32 v17, v17, v19
    v_mfma_f32_16x16x32_bf16 v[88:91], v[36:39], v[200:203], v[88:91]
    v_mov_b32 v16, 0x3d800000
    s_add_u32 s50, s17, 16384
    v_fma_f32 v96, v96, v16, v10
    v_mfma_f32_16x16x32_bf16 v[92:95], v[36:39], v[204:207], v[92:95]
    ds_read_b128 v[32:35], v12 offset:47104
    v_fma_f32 v97, v97, v16, v10
    s_waitcnt lgkmcnt(5)
    v_mfma_f32_16x16x32_bf16 v[88:91], v[40:43], v[208:211], v[88:91]
    v_fma_f32 v98, v98, v16, v10
    v_fma_f32 v99, v99, v16, v10
    v_fma_f32 v100, v100, v16, v10
    v_mfma_f32_16x16x32_bf16 v[92:95], v[40:43], v[212:215], v[92:95]
    ds_read_b128 v[36:39], v12 offset:48128
    v_fma_f32 v101, v101, v16, v10
    s_waitcnt lgkmcnt(3)
    v_mfma_f32_16x16x32_bf16 v[88:91], v[44:47], v[216:219], v[88:91]
    s_mul_i32 s69, s44, 8320
    s_add_u32 s69, s69, 0
    s_cmp_eq_u32 s44, 3
    s_cselect_b32 s69, 24960, s69
    v_mfma_f32_16x16x32_bf16 v[92:95], v[44:47], v[220:223], v[92:95]
    ds_read_b128 v[40:43], v12 offset:49152
    s_mov_b32 m0, s69
    s_waitcnt lgkmcnt(3)
    v_mfma_f32_16x16x32_bf16 v[88:91], v[48:51], v[224:227], v[88:91]
    s_add_u32 s69, s44, 3
    s_and_b32 s69, s69, 3
    s_lshl_b32 s69, s69, 16
    v_mfma_f32_16x16x32_bf16 v[92:95], v[48:51], v[228:231], v[92:95]
    ds_read_b128 v[44:47], v12 offset:50176
    s_add_u32 s69, s69, s61
    s_xor_b32 s69, s69, 512
    v_mfma_f32_16x16x32_bf16 v[88:91], v[52:55], v[232:235], v[88:91]
    buffer_load_dwordx4 v5, s[24:27], s69 offen lds
    s_add_u32 m0, m0, 1040
    s_add_u32 s69, s69, 4096
    v_mfma_f32_16x16x32_bf16 v[92:95], v[52:55], v[236:239], v[92:95]
    ds_read_b128 v[48:51], v12 offset:51200
    v_fma_f32 v102, v102, v16, v10
    s_waitcnt lgkmcnt(3)
    v_mfma_f32_16x16x32_bf16 v[88:91], v[32:35], v[240:243], v[88:91]
    v_fma_f32 v103, v103, v16, v10
    v_mfma_f32_16x16x32_bf16 v[92:95], v[32:35], v[244:247], v[92:95]
    ds_read_b128 v[52:55], v12 offset:52224
    buffer_load_dwordx4 v5, s[24:27], s69 offen lds
    s_add_u32 m0, m0, 1040
    v_mfma_f32_16x16x32_bf16 v[88:91], v[36:39], v[248:251], v[88:91]
    s_add_u32 s69, s69, 4096
    v_cvt_pk_bf16_f32 v96, v96, v97
    v_cvt_pk_bf16_f32 v97, v98, v99
    v_mfma_f32_16x16x32_bf16 v[92:95], v[36:39], v[252:255], v[92:95]
    ds_read_b128 v[32:35], v12 offset:53248
    buffer_load_dwordx4 v5, s[24:27], s69 offen lds
    s_waitcnt lgkmcnt(3)
    v_mfma_f32_16x16x32_bf16 v[112:115], v[40:43], v[128:131], 0
    s_add_u32 m0, m0, 1040
    s_add_u32 s69, s69, 4096
    v_cvt_pk_bf16_f32 v98, v100, v101
    v_mfma_f32_16x16x32_bf16 v[116:119], v[40:43], v[132:135], 0
    ds_read_b128 v[36:39], v12 offset:54272
    v_cvt_pk_bf16_f32 v99, v102, v103
    v_mfma_f32_16x16x32_bf16 v[112:115], v[44:47], v[136:139], v[112:115]
    buffer_load_dwordx4 v5, s[24:27], s69 offen lds
    s_add_u32 m0, m0, 1040
    s_add_u32 s69, s69, 4096
    v_mfma_f32_16x16x32_bf16 v[116:119], v[44:47], v[140:143], v[116:119]
    ds_read_b128 v[40:43], v12 offset:55296
    ds_bpermute_b32 v100, v17, v96
    s_waitcnt lgkmcnt(4)
    v_mfma_f32_16x16x32_bf16 v[112:115], v[48:51], v[144:147], v[112:115]
    ds_bpermute_b32 v101, v17, v97
    buffer_load_dwordx4 v5, s[24:27], s69 offen lds
    s_add_u32 m0, m0, 1040
    v_mfma_f32_16x16x32_bf16 v[116:119], v[48:51], v[148:151], v[116:119]
    ds_read_b128 v[44:47], v12 offset:56320
    s_add_u32 s69, s69, 4096
    ds_bpermute_b32 v102, v17, v98
    v_mfma_f32_16x16x32_bf16 v[112:115], v[52:55], v[152:155], v[112:115]
    ds_bpermute_b32 v103, v17, v99
    buffer_load_dwordx4 v5, s[24:27], s69 offen lds
    s_add_u32 m0, m0, 1040
    v_mfma_f32_16x16x32_bf16 v[116:119], v[52:55], v[156:159], v[116:119]
    ds_read_b128 v[48:51], v12 offset:57344
    s_add_u32 s69, s69, 4096
    s_waitcnt lgkmcnt(7)
    v_mfma_f32_16x16x32_bf16 v[112:115], v[32:35], v[160:163], v[112:115]
    v_fma_f32 v104, v104, v16, v11
    v_mfma_f32_16x16x32_bf16 v[116:119], v[32:35], v[164:167], v[116:119]
    ds_read_b128 v[52:55], v12 offset:58368
    buffer_load_dwordx4 v5, s[24:27], s69 offen lds
    s_add_u32 m0, m0, 1040
    v_mfma_f32_16x16x32_bf16 v[112:115], v[36:39], v[168:171], v[112:115]
    s_add_u32 s69, s69, 4096
    v_fma_f32 v105, v105, v16, v11
    v_fma_f32 v106, v106, v16, v11
    v_mfma_f32_16x16x32_bf16 v[116:119], v[36:39], v[172:175], v[116:119]
    ds_read_b128 v[32:35], v12 offset:59392
    buffer_load_dwordx4 v5, s[24:27], s69 offen lds
    s_waitcnt lgkmcnt(5)
    v_mfma_f32_16x16x32_bf16 v[112:115], v[40:43], v[176:179], v[112:115]
    v_fma_f32 v107, v107, v16, v11
    v_fma_f32 v108, v108, v16, v11
    v_fma_f32 v109, v109, v16, v11
    v_mfma_f32_16x16x32_bf16 v[116:119], v[40:43], v[180:183], v[116:119]
    ds_read_b128 v[36:39], v12 offset:60416
    v_fma_f32 v110, v110, v16, v11
    v_fma_f32 v111, v111, v16, v11
    v_mfma_f32_16x16x32_bf16 v[112:115], v[44:47], v[184:187], v[112:115]
    v_cvt_pk_bf16_f32 v104, v104, v105
    v_cvt_pk_bf16_f32 v105, v106, v107
    v_cvt_pk_bf16_f32 v106, v108, v109
    v_mfma_f32_16x16x32_bf16 v[116:119], v[44:47], v[188:191], v[116:119]
    ds_read_b128 v[40:43], v12 offset:61440
    v_cvt_pk_bf16_f32 v107, v110, v111
    s_waitcnt lgkmcnt(3)
    v_mfma_f32_16x16x32_bf16 v[112:115], v[48:51], v[192:195], v[112:115]
    ds_bpermute_b32 v108, v17, v104
    ds_bpermute_b32 v109, v17, v105
    ds_bpermute_b32 v110, v17, v106
    v_mfma_f32_16x16x32_bf16 v[116:119], v[48:51], v[196:199], v[116:119]
    ds_read_b128 v[44:47], v12 offset:62464
    ds_bpermute_b32 v111, v17, v107
    s_waitcnt lgkmcnt(9)
    v_mfma_f32_16x16x32_bf16 v[112:115], v[52:55], v[200:203], v[112:115]
    buffer_store_dwordx4 v[100:103], v2, s[40:43], s17 offen sc1
    s_waitcnt lgkmcnt(0)
    v_mfma_f32_16x16x32_bf16 v[116:119], v[52:55], v[204:207], v[116:119]
    ds_read_b128 v[48:51], v12 offset:63488
    s_waitcnt lgkmcnt(7)
    v_mfma_f32_16x16x32_bf16 v[112:115], v[32:35], v[208:211], v[112:115]
    buffer_store_dwordx4 v[108:111], v2, s[40:43], s50 offen sc1
    v_mfma_f32_16x16x32_bf16 v[116:119], v[32:35], v[212:215], v[116:119]
    ds_read_b128 v[52:55], v12 offset:64512
    v_mfma_f32_16x16x32_bf16 v[112:115], v[36:39], v[216:219], v[112:115]
    s_or_b32 s50, s2, s44
    s_cmp_eq_u32 s50, 0
    s_cselect_b32 exec_lo, 1, 0
    s_mov_b32 exec_hi, 0
    v_mov_b32 v6, s45
    v_mov_b32_e64 v7, 0
    buffer_store_dword v6, v7, s[40:43], 0 offen offset:0 sc1
    s_mov_b64 exec, -1
    v_mfma_f32_16x16x32_bf16 v[116:119], v[36:39], v[220:223], v[116:119]
    ds_read_b128 v[32:35], v8 offset:0
    s_waitcnt lgkmcnt(4)
    v_mfma_f32_16x16x32_bf16 v[112:115], v[40:43], v[224:227], v[112:115]
    v_mfma_f32_16x16x32_bf16 v[116:119], v[40:43], v[228:231], v[116:119]
    ds_read_b128 v[36:39], v8 offset:1024
    v_mfma_f32_16x16x32_bf16 v[112:115], v[44:47], v[232:235], v[112:115]
    v_mfma_f32_16x16x32_bf16 v[116:119], v[44:47], v[236:239], v[116:119]
    ds_read_b128 v[40:43], v8 offset:2048
    s_waitcnt lgkmcnt(3)
    v_mfma_f32_16x16x32_bf16 v[112:115], v[48:51], v[240:243], v[112:115]
    v_mfma_f32_16x16x32_bf16 v[116:119], v[48:51], v[244:247], v[116:119]
    ds_read_b128 v[44:47], v8 offset:3072
    v_mfma_f32_16x16x32_bf16 v[112:115], v[52:55], v[248:251], v[112:115]
    s_add_u32 s49, s12, 0
    buffer_load_dwordx4 v[96:99], v24, s[40:43], s49 offen sc1
    s_add_u32 s49, s12, 4096
    v_mfma_f32_16x16x32_bf16 v[116:119], v[52:55], v[252:255], v[116:119]
    ds_read_b128 v[48:51], v8 offset:4096
    buffer_load_dwordx4 v[100:103], v24, s[40:43], s49 offen sc1
    s_waitcnt lgkmcnt(3)
    v_mfma_f32_16x16x32_bf16 v[120:123], v[32:35], v[128:131], 0
    s_add_u32 s49, s12, 8192
    buffer_load_dwordx4 v[104:107], v24, s[40:43], s49 offen sc1
    s_add_u32 s49, s12, 12288
    v_mfma_f32_16x16x32_bf16 v[124:127], v[32:35], v[132:135], 0
    ds_read_b128 v[52:55], v8 offset:5120
    buffer_load_dwordx4 v[108:111], v24, s[40:43], s49 offen sc1
    s_add_u32 s49, s12, 16384
    v_mfma_f32_16x16x32_bf16 v[120:123], v[36:39], v[136:139], v[120:123]
    buffer_load_dwordx4 v[16:19], v24, s[40:43], s49 offen sc1
    s_add_u32 s49, s12, 20480
    buffer_load_dwordx4 v[20:23], v24, s[40:43], s49 offen sc1
    v_mfma_f32_16x16x32_bf16 v[124:127], v[36:39], v[140:143], v[124:127]
    ds_read_b128 v[32:35], v8 offset:6144
    s_add_u32 s49, s12, 24576
    s_waitcnt lgkmcnt(3)
    v_mfma_f32_16x16x32_bf16 v[120:123], v[40:43], v[144:147], v[120:123]
    buffer_load_dwordx4 a[248:251], v24, s[40:43], s49 offen sc1
    s_add_u32 s49, s12, 28672
    buffer_load_dwordx4 a[252:255], v24, s[40:43], s49 offen sc1
    v_mfma_f32_16x16x32_bf16 v[124:127], v[40:43], v[148:151], v[124:127]
    ds_read_b128 v[36:39], v8 offset:7168
    v_mfma_f32_16x16x32_bf16 v[120:123], v[44:47], v[152:155], v[120:123]
    v_mfma_f32_16x16x32_bf16 v[124:127], v[44:47], v[156:159], v[124:127]
    ds_read_b128 v[40:43], v8 offset:8192
    s_waitcnt lgkmcnt(3)
    v_mfma_f32_16x16x32_bf16 v[120:123], v[48:51], v[160:163], v[120:123]
    v_mfma_f32_16x16x32_bf16 v[124:127], v[48:51], v[164:167], v[124:127]
    ds_read_b128 v[44:47], v8 offset:9216
    v_mfma_f32_16x16x32_bf16 v[120:123], v[52:55], v[168:171], v[120:123]
    v_mfma_f32_16x16x32_bf16 v[124:127], v[52:55], v[172:175], v[124:127]
    ds_read_b128 v[48:51], v8 offset:10240
    s_waitcnt lgkmcnt(3)
    v_mfma_f32_16x16x32_bf16 v[120:123], v[32:35], v[176:179], v[120:123]
    v_mfma_f32_16x16x32_bf16 v[124:127], v[32:35], v[180:183], v[124:127]
    ds_read_b128 v[52:55], v8 offset:11264
    v_mfma_f32_16x16x32_bf16 v[120:123], v[36:39], v[184:187], v[120:123]
    v_mfma_f32_16x16x32_bf16 v[124:127], v[36:39], v[188:191], v[124:127]
    ds_read_b128 v[32:35], v8 offset:12288
    s_waitcnt lgkmcnt(3)
    v_mfma_f32_16x16x32_bf16 v[120:123], v[40:43], v[192:195], v[120:123]
    v_mfma_f32_16x16x32_bf16 v[124:127], v[40:43], v[196:199], v[124:127]
    ds_read_b128 v[36:39], v8 offset:13312
    v_mfma_f32_16x16x32_bf16 v[120:123], v[44:47], v[200:203], v[120:123]
    v_mfma_f32_16x16x32_bf16 v[124:127], v[44:47], v[204:207], v[124:127]
    ds_read_b128 v[40:43], v8 offset:14336
    s_waitcnt lgkmcnt(3)
    v_mfma_f32_16x16x32_bf16 v[120:123], v[48:51], v[208:211], v[120:123]
    v_mfma_f32_16x16x32_bf16 v[124:127], v[48:51], v[212:215], v[124:127]
    ds_read_b128 v[44:47], v8 offset:15360
    v_mfma_f32_16x16x32_bf16 v[120:123], v[52:55], v[216:219], v[120:123]
    v_mfma_f32_16x16x32_bf16 v[124:127], v[52:55], v[220:223], v[124:127]
    s_waitcnt lgkmcnt(2)
    v_mfma_f32_16x16x32_bf16 v[120:123], v[32:35], v[224:227], v[120:123]
    v_mfma_f32_16x16x32_bf16 v[124:127], v[32:35], v[228:231], v[124:127]
    v_mfma_f32_16x16x32_bf16 v[120:123], v[36:39], v[232:235], v[120:123]
    v_mfma_f32_16x16x32_bf16 v[124:127], v[36:39], v[236:239], v[124:127]
    s_waitcnt lgkmcnt(0)
    v_mfma_f32_16x16x32_bf16 v[120:123], v[40:43], v[240:243], v[120:123]
    v_mfma_f32_16x16x32_bf16 v[124:127], v[40:43], v[244:247], v[124:127]
    v_mfma_f32_16x16x32_bf16 v[120:123], v[44:47], v[248:251], v[120:123]
    v_mfma_f32_16x16x32_bf16 v[124:127], v[44:47], v[252:255], v[124:127]
    s_waitcnt vmcnt(0)
    v_accvgpr_read_b32 v36, a248
    v_accvgpr_read_b32 v37, a249
    v_accvgpr_read_b32 v38, a250
    v_accvgpr_read_b32 v39, a251
    v_accvgpr_read_b32 v40, a252
    v_accvgpr_read_b32 v41, a253
    v_accvgpr_read_b32 v42, a254
    v_accvgpr_read_b32 v43, a255
    v_min_u32 v32, v97, v99
    v_max_u32_e64 v33, v97, v99
    v_min3_u32 v32, v32, v101, v103
    v_max3_u32 v33, v33, v101, v103
    v_min3_u32 v32, v32, v105, v107
    v_max3_u32 v33, v33, v105, v107
    v_min3_u32 v32, v32, v109, v111
    v_max3_u32 v33, v33, v109, v111
    v_min3_u32 v32, v32, v17, v19
    v_max3_u32 v33, v33, v17, v19
    v_min3_u32 v32, v32, v21, v23
    v_max3_u32 v33, v33, v21, v23
    v_min3_u32 v32, v32, v37, v39
    v_max3_u32 v33, v33, v37, v39
    v_min3_u32 v32, v32, v41, v43
    v_max3_u32 v33, v33, v41, v43
    v_cmp_ne_u32_e64 vcc, s45, v32
    v_cmp_ne_u32 s[62:63], s45, v33
    s_nop 0
    s_or_b64 vcc, vcc, s[62:63]
    s_cbranch_vccnz L_slow_17
L_back_18:
    v_add_f32 v96, v96, v16
    v_add_f32 v98, v98, v18
    v_add_f32 v100, v100, v20
    v_add_f32 v102, v102, v22
    v_add_f32 v104, v104, v36
    v_add_f32 v106, v106, v38
    v_add_f32 v108, v108, v40
    v_add_f32 v110, v110, v42
    v_add_f32 v96, v96, v104
    v_add_f32 v98, v98, v106
    v_add_f32 v100, v100, v108
    v_add_f32 v102, v102, v110
    v_add_f32 v96, v96, v100
    v_add_f32 v98, v98, v102
    v_mov_b32 v97, v96
    v_mov_b32 v99, v98
    s_nop 0
    v_permlane32_swap_b32 v96, v97
    v_permlane32_swap_b32 v98, v99
    v_add_f32 v96, v96, v97
    v_add_f32 v98, v98, v99
    v_mul_f32 v96, 0x3a924925, v96
    v_mul_f32 v98, 0x3a924925, v98
    v_fma_f32 v98, -v96, v96, v98
    v_max_f32_e64 v98, 0, v98
    v_add_f32 v98, 0x3727c5ac, v98
    v_rsq_f32 v98, v98
    s_nop 0
    v_mul_f32 v96, -v96, v98
    ds_write2_b32 v9, v96, v98 offset0:32 offset1:64
    s_waitcnt lgkmcnt(0)
    ds_read_b128 v[36:39], v13 offset:128
    ds_read_b128 v[44:47], v13 offset:256
    ds_read_b128 v[40:43], v13 offset:192
    ds_read_b128 v[48:51], v13 offset:320
    s_mul_i32 s62, s44, 8320
    s_add_u32 s62, s62, 65536
    s_cmp_eq_u32 s44, 3
    s_cselect_b32 s62, 147456, s62
    v_add_u32 v6, s62, v27
    v_add_u32 v7, s62, v31
    s_waitcnt vmcnt(18)
    ds_read_b128 a[192:195], v6 offset:0
    ds_read_b128 a[196:199], v6 offset:64
    ds_read_b128 a[200:203], v7 offset:0
    ds_read_b128 a[204:207], v7 offset:64
    ds_read_b128 a[208:211], v6 offset:256
    ds_read_b128 a[212:215], v6 offset:320
    ds_read_b128 a[216:219], v7 offset:256
    ds_read_b128 a[220:223], v7 offset:320
    s_mul_i32 s62, s44, 8320
    s_add_u32 s62, s62, 0
    s_cmp_eq_u32 s44, 3
    s_cselect_b32 s62, 24960, s62
    v_add_u32 v6, s62, v27
    v_add_u32 v7, s62, v31
    s_waitcnt vmcnt(10)
    ds_read_b128 a[224:227], v6 offset:0
    ds_read_b128 a[228:231], v6 offset:64
    ds_read_b128 a[232:235], v7 offset:0
    ds_read_b128 a[236:239], v7 offset:64
    ds_read_b128 a[240:243], v6 offset:256
    ds_read_b128 a[244:247], v6 offset:320
    ds_read_b128 a[248:251], v7 offset:256
    ds_read_b128 a[252:255], v7 offset:320
    s_waitcnt lgkmcnt(15)
    v_pk_fma_f32 v[64:65], v[64:65], v[44:45], v[36:37]
    v_pk_fma_f32 v[66:67], v[66:67], v[46:47], v[38:39]
    v_pk_fma_f32 v[68:69], v[68:69], v[48:49], v[40:41]
    v_pk_fma_f32 v[70:71], v[70:71], v[50:51], v[42:43]
    v_cvt_pk_bf16_f32 v64, v64, v65
    v_cvt_pk_bf16_f32 v65, v66, v67
    v_cvt_pk_bf16_f32 v66, v68, v69
    v_cvt_pk_bf16_f32 v67, v70, v71
    s_nop 0
    v_permlane32_swap_b32 v64, v66
    v_permlane32_swap_b32 v65, v67
    s_nop 0
    v_permlane16_swap_b32 v64, v66
    v_permlane16_swap_b32 v65, v67
    buffer_store_dwordx4 v[64:67], v2, s[40:43], s16 offen sc1
    s_add_u32 s16, s16, 65536
    v_pk_fma_f32 v[72:73], v[72:73], v[44:45], v[36:37]
    v_pk_fma_f32 v[74:75], v[74:75], v[46:47], v[38:39]
    v_pk_fma_f32 v[76:77], v[76:77], v[48:49], v[40:41]
    v_pk_fma_f32 v[78:79], v[78:79], v[50:51], v[42:43]
    v_cvt_pk_bf16_f32 v72, v72, v73
    v_cvt_pk_bf16_f32 v73, v74, v75
    v_cvt_pk_bf16_f32 v74, v76, v77
    v_cvt_pk_bf16_f32 v75, v78, v79
    s_nop 0
    v_permlane32_swap_b32 v72, v74
    v_permlane32_swap_b32 v73, v75
    s_nop 0
    v_permlane16_swap_b32 v72, v74
    v_permlane16_swap_b32 v73, v75
    buffer_store_dwordx4 v[72:75], v2, s[40:43], s16 offen sc1
    s_add_u32 s16, s16, 65536
    v_pk_fma_f32 v[80:81], v[80:81], v[44:45], v[36:37]
    v_pk_fma_f32 v[82:83], v[82:83], v[46:47], v[38:39]
    v_pk_fma_f32 v[84:85], v[84:85], v[48:49], v[40:41]
    v_pk_fma_f32 v[86:87], v[86:87], v[50:51], v[42:43]
    v_cvt_pk_bf16_f32 v80, v80, v81
    v_cvt_pk_bf16_f32 v81, v82, v83
    v_cvt_pk_bf16_f32 v82, v84, v85
    v_cvt_pk_bf16_f32 v83, v86, v87
    s_nop 0
    v_permlane32_swap_b32 v80, v82
    v_permlane32_swap_b32 v81, v83
    s_nop 0
    v_permlane16_swap_b32 v80, v82
    v_permlane16_swap_b32 v81, v83
    buffer_store_dwordx4 v[80:83], v2, s[40:43], s16 offen sc1
    v_lshrrev_b32 v24, 3, v1
    v_and_b32 v25, 7, v1
    v_and_b32 v15, 6, v24
    v_xor_b32 v25, v25, v15
    v_lshlrev_b32 v24, 10, v24
    v_lshl_add_u32 v15, v25, 4, v24
    s_mul_i32 s69, s44, 229376
    s_lshl_b32 s49, s60, 7
    s_add_u32 s69, s69, s49
    s_mul_i32 m0, s44, 28672
    v_lshlrev_b32 v8, 3, v1
    s_waitcnt lgkmcnt(0)
    s_barrier
    v_pk_mul_f32 v[56:57], v[56:57], v[26:27] op_sel_hi:[1,0]
    v_pk_mul_f32 v[60:61], v[60:61], v[28:29] op_sel_hi:[1,0]
    v_pk_mul_f32 v[58:59], v[58:59], v[26:27] op_sel_hi:[1,0]
    v_pk_mul_f32 v[62:63], v[62:63], v[28:29] op_sel_hi:[1,0]
    v_pk_mul_f32 v[16:17], v[56:57], v[56:57]
    v_pk_mul_f32 v[20:21], v[60:61], v[60:61]
    v_pk_mul_f32 v[18:19], v[58:59], v[58:59]
    v_pk_mul_f32 v[22:23], v[62:63], v[62:63]
    v_pk_fma_f32 v[16:17], v[16:17], v[30:31], v[14:15] op_sel_hi:[1,0,0]
    v_pk_fma_f32 v[20:21], v[20:21], v[30:31], v[14:15] op_sel_hi:[1,0,0]
    v_pk_fma_f32 v[18:19], v[18:19], v[30:31], v[14:15] op_sel_hi:[1,0,0]
    v_pk_fma_f32 v[22:23], v[22:23], v[30:31], v[14:15] op_sel_hi:[1,0,0]
    v_pk_mul_f32 v[16:17], v[16:17], v[56:57]
    v_pk_mul_f32 v[20:21], v[20:21], v[60:61]
    v_pk_mul_f32 v[18:19], v[18:19], v[58:59]
    v_pk_mul_f32 v[22:23], v[22:23], v[62:63]
    v_exp_f32 v16, v16
    v_exp_f32_e64 v20, v20
    buffer_load_dwordx4 v15, s[32:35], s69 offen lds
    s_add_u32 m0, m0, 1024
    s_add_u32 s69, s69, 8192
    v_exp_f32 v17, v17
    v_exp_f32 v21, v21
    v_exp_f32 v18, v18
    v_exp_f32 v22, v22
    v_exp_f32 v19, v19
    v_exp_f32 v23, v23
    v_pk_add_f32 v[16:17], v[16:17], 1.0 op_sel_hi:[1,0]
    v_pk_add_f32 v[20:21], v[20:21], 1.0 op_sel_hi:[1,0]
    v_pk_add_f32 v[18:19], v[18:19], 1.0 op_sel_hi:[1,0]
    v_pk_add_f32 v[22:23], v[22:23], 1.0 op_sel_hi:[1,0]
    v_rcp_f32 v16, v16
    v_rcp_f32 v20, v20
    v_rcp_f32 v17, v17
    v_rcp_f32 v21, v21
    v_rcp_f32 v18, v18
    v_rcp_f32 v22, v22
    v_rcp_f32_e64 v19, v19
    buffer_load_dwordx4 v15, s[32:35], s69 offen lds
    s_add_u32 m0, m0, 1024
    s_add_u32 s69, s69, 8192
    v_rcp_f32_e64 v23, v23
    v_pk_mul_f32 v[56:57], v[56:57], v[16:17]
    v_pk_mul_f32 v[60:61], v[60:61], v[20:21]
    v_pk_mul_f32 v[58:59], v[58:59], v[18:19]
    v_pk_mul_f32 v[62:63], v[62:63], v[22:23]
    v_cvt_pk_bf16_f32 v56, v56, v57
    v_cvt_pk_bf16_f32 v57, v58, v59
    v_cvt_pk_bf16_f32 v60, v60, v61
    v_cvt_pk_bf16_f32 v61, v62, v63
    v_pk_mul_f32 v[88:89], v[88:89], v[26:27] op_sel_hi:[1,0]
    v_pk_mul_f32 v[92:93], v[92:93], v[28:29] op_sel_hi:[1,0]
    v_pk_mul_f32 v[90:91], v[90:91], v[26:27] op_sel_hi:[1,0]
    v_pk_mul_f32 v[94:95], v[94:95], v[28:29] op_sel_hi:[1,0]
    v_pk_mul_f32 v[16:17], v[88:89], v[88:89]
    v_pk_mul_f32 v[20:21], v[92:93], v[92:93]
    v_pk_mul_f32 v[18:19], v[90:91], v[90:91]
    v_pk_mul_f32 v[22:23], v[94:95], v[94:95]
    v_pk_fma_f32 v[16:17], v[16:17], v[30:31], v[14:15] op_sel_hi:[1,0,0]
    buffer_load_dwordx4 v15, s[32:35], s69 offen lds
    s_add_u32 m0, m0, 1024
    s_add_u32 s69, s69, 8192
    v_pk_fma_f32 v[20:21], v[20:21], v[30:31], v[14:15] op_sel_hi:[1,0,0]
    v_pk_fma_f32 v[18:19], v[18:19], v[30:31], v[14:15] op_sel_hi:[1,0,0]
    v_pk_fma_f32 v[22:23], v[22:23], v[30:31], v[14:15] op_sel_hi:[1,0,0]
    v_pk_mul_f32 v[16:17], v[16:17], v[88:89]
    v_pk_mul_f32 v[20:21], v[20:21], v[92:93]
    v_pk_mul_f32 v[18:19], v[18:19], v[90:91]
    v_pk_mul_f32 v[22:23], v[22:23], v[94:95]
    v_exp_f32 v16, v16
    v_exp_f32 v20, v20
    v_exp_f32 v17, v17
    v_exp_f32 v21, v21
    v_exp_f32 v18, v18
    v_exp_f32 v22, v22
    v_exp_f32 v19, v19
    v_exp_f32 v23, v23
    v_pk_add_f32 v[16:17], v[16:17], 1.0 op_sel_hi:[1,0]
    v_pk_add_f32 v[20:21], v[20:21], 1.0 op_sel_hi:[1,0]
    buffer_load_dwordx4 v15, s[32:35], s69 offen lds
    s_add_u32 m0, m0, 1024
    s_add_u32 s69, s69, 8192
    v_pk_add_f32 v[18:19], v[18:19], 1.0 op_sel_hi:[1,0]
    v_pk_add_f32 v[22:23], v[22:23], 1.0 op_sel_hi:[1,0]
    v_rcp_f32 v16, v16
    v_rcp_f32 v20, v20
    v_rcp_f32 v17, v17
    v_rcp_f32 v21, v21
    v_rcp_f32 v18, v18
    v_rcp_f32 v22, v22
    v_rcp_f32 v19, v19
    v_rcp_f32 v23, v23
    v_pk_mul_f32 v[88:89], v[88:89], v[16:17]
    v_pk_mul_f32 v[92:93], v[92:93], v[20:21]
    v_pk_mul_f32 v[90:91], v[90:91], v[18:19]
    v_pk_mul_f32 v[94:95], v[94:95], v[22:23]
    v_cvt_pk_bf16_f32 v58, v88, v89
    v_cvt_pk_bf16_f32 v59, v90, v91
    buffer_store_dwordx4 v[56:59], v2, s[40:43], s14 offen offset:0 sc1
    v_cvt_pk_bf16_f32 v62, v92, v93
    v_cvt_pk_bf16_f32 v63, v94, v95
    buffer_store_dwordx4 v[60:63], v2, s[40:43], s15 offen offset:0 sc1
    s_waitcnt vmcnt(6)
    s_barrier
    s_cmp_eq_u32 s44, 0
    s_cbranch_scc0 L_nf_19
    s_lshl_b32 s48, s2, 7
    s_add_u32 s48, s48, 163840
    v_mov_b32 v6, s45
    v_mov_b32 v7, 0
    s_mov_b64 exec, 1
    buffer_store_dword v6, v7, s[40:43], s48 offen sc1
    s_mov_b64 exec, -1
L_nf_19:
    v_pk_mul_f32 v[112:113], v[112:113], v[26:27] op_sel_hi:[1,0]
    v_pk_mul_f32 v[116:117], v[116:117], v[28:29] op_sel_hi:[1,0]
    v_pk_mul_f32 v[114:115], v[114:115], v[26:27] op_sel_hi:[1,0]
    buffer_load_dwordx4 v15, s[32:35], s69 offen lds
    s_add_u32 m0, m0, 1024
    s_add_u32 s69, s69, 8192
    v_pk_mul_f32 v[118:119], v[118:119], v[28:29] op_sel_hi:[1,0]
    v_pk_mul_f32 v[16:17], v[112:113], v[112:113]
    buffer_load_dwordx4 v15, s[32:35], s69 offen lds
    s_add_u32 m0, m0, 1024
    s_add_u32 s69, s69, 8192
    v_pk_mul_f32 v[20:21], v[116:117], v[116:117]
    v_pk_mul_f32 v[18:19], v[114:115], v[114:115]
    v_pk_mul_f32 v[22:23], v[118:119], v[118:119]
    buffer_load_dwordx4 v15, s[32:35], s69 offen lds
    s_add_u32 m0, m0, 1024
    s_add_u32 s69, s69, 8192
    v_pk_fma_f32 v[16:17], v[16:17], v[30:31], v[14:15] op_sel_hi:[1,0,0]
    v_pk_fma_f32 v[20:21], v[20:21], v[30:31], v[14:15] op_sel_hi:[1,0,0]
    buffer_load_dwordx4 v15, s[32:35], s69 offen lds
    s_add_u32 m0, m0, 7168
    s_add_u32 s69, s69, 57344
    v_pk_fma_f32 v[18:19], v[18:19], v[30:31], v[14:15] op_sel_hi:[1,0,0]
    v_pk_fma_f32 v[22:23], v[22:23], v[30:31], v[14:15] op_sel_hi:[1,0,0]
    v_pk_mul_f32 v[16:17], v[16:17], v[112:113]
    buffer_load_dwordx4 v15, s[32:35], s69 offen lds
    s_add_u32 m0, m0, 1024
    s_add_u32 s69, s69, 8192
    v_pk_mul_f32 v[20:21], v[20:21], v[116:117]
    v_pk_mul_f32 v[18:19], v[18:19], v[114:115]
    buffer_load_dwordx4 v15, s[32:35], s69 offen lds
    s_add_u32 m0, m0, 1024
    s_add_u32 s69, s69, 8192
    v_pk_mul_f32 v[22:23], v[22:23], v[118:119]
    v_exp_f32 v16, v16
    v_exp_f32_e64 v20, v20
    buffer_load_dwordx4 v15, s[32:35], s69 offen lds
    s_add_u32 m0, m0, 1024
    s_add_u32 s69, s69, 8192
    v_exp_f32 v17, v17
    v_exp_f32 v21, v21
    buffer_load_dwordx4 v15, s[32:35], s69 offen lds
    s_add_u32 m0, m0, 1024
    s_add_u32 s69, s69, 8192
    v_exp_f32 v18, v18
    v_exp_f32 v22, v22
    v_exp_f32_e64 v19, v19
    buffer_load_dwordx4 v15, s[32:35], s69 offen lds
    s_add_u32 m0, m0, 1024
    s_add_u32 s69, s69, 8192
    v_exp_f32_e64 v23, v23
    v_pk_add_f32 v[16:17], v[16:17], 1.0 op_sel_hi:[1,0]
    buffer_load_dwordx4 v15, s[32:35], s69 offen lds
    s_add_u32 m0, m0, 1024
    s_add_u32 s69, s69, 8192
    v_pk_add_f32 v[20:21], v[20:21], 1.0 op_sel_hi:[1,0]
    v_pk_add_f32 v[18:19], v[18:19], 1.0 op_sel_hi:[1,0]
    v_pk_add_f32 v[22:23], v[22:23], 1.0 op_sel_hi:[1,0]
    buffer_load_dwordx4 v15, s[32:35], s69 offen lds
    s_add_u32 m0, m0, 1024
    s_add_u32 s69, s69, 8192
    v_rcp_f32 v16, v16
    v_rcp_f32 v20, v20
    buffer_load_dwordx4 v15, s[32:35], s69 offen lds
    s_add_u32 m0, m0, -13312
    s_add_u32 s69, s69, -106496
    v_rcp_f32 v17, v17
    v_rcp_f32 v21, v21
    v_rcp_f32 v18, v18
    v_rcp_f32 v22, v22
    v_rcp_f32 v19, v19
    v_rcp_f32 v23, v23
    v_pk_mul_f32 v[112:113], v[112:113], v[16:17]
    v_pk_mul_f32 v[116:117], v[116:117], v[20:21]
    v_pk_mul_f32 v[114:115], v[114:115], v[18:19]
    v_pk_mul_f32 v[118:119], v[118:119], v[22:23]
    v_cvt_pk_bf16_f32 v112, v112, v113
    v_cvt_pk_bf16_f32 v113, v114, v115
    v_cvt_pk_bf16_f32 v116, v116, v117
    v_cvt_pk_bf16_f32 v117, v118, v119
    v_pk_mul_f32 v[120:121], v[120:121], v[26:27] op_sel_hi:[1,0]
    v_pk_mul_f32 v[124:125], v[124:125], v[28:29] op_sel_hi:[1,0]
    v_pk_mul_f32 v[122:123], v[122:123], v[26:27] op_sel_hi:[1,0]
    v_pk_mul_f32 v[126:127], v[126:127], v[28:29] op_sel_hi:[1,0]
    v_pk_mul_f32 v[16:17], v[120:121], v[120:121]
    v_pk_mul_f32 v[20:21], v[124:125], v[124:125]
    v_pk_mul_f32 v[18:19], v[122:123], v[122:123]
    v_pk_mul_f32 v[22:23], v[126:127], v[126:127]
    v_pk_fma_f32 v[16:17], v[16:17], v[30:31], v[14:15] op_sel_hi:[1,0,0]
    v_pk_fma_f32 v[20:21], v[20:21], v[30:31], v[14:15] op_sel_hi:[1,0,0]
    v_pk_fma_f32 v[18:19], v[18:19], v[30:31], v[14:15] op_sel_hi:[1,0,0]
    v_pk_fma_f32 v[22:23], v[22:23], v[30:31], v[14:15] op_sel_hi:[1,0,0]
    v_pk_mul_f32 v[16:17], v[16:17], v[120:121]
    v_pk_mul_f32 v[20:21], v[20:21], v[124:125]
    v_pk_mul_f32 v[18:19], v[18:19], v[122:123]
    v_pk_mul_f32 v[22:23], v[22:23], v[126:127]
    v_exp_f32 v16, v16
    v_exp_f32 v20, v20
    v_exp_f32 v17, v17
    v_exp_f32 v21, v21
    v_exp_f32 v18, v18
    v_exp_f32 v22, v22
    v_exp_f32 v19, v19
    v_exp_f32 v23, v23
    v_pk_add_f32 v[16:17], v[16:17], 1.0 op_sel_hi:[1,0]
    v_pk_add_f32 v[20:21], v[20:21], 1.0 op_sel_hi:[1,0]
    v_pk_add_f32 v[18:19], v[18:19], 1.0 op_sel_hi:[1,0]
    v_pk_add_f32 v[22:23], v[22:23], 1.0 op_sel_hi:[1,0]
    v_rcp_f32 v16, v16
    v_rcp_f32 v20, v20
    v_rcp_f32 v17, v17
    v_rcp_f32 v21, v21
    v_rcp_f32 v18, v18
    v_rcp_f32 v22, v22
    v_rcp_f32 v19, v19
    v_rcp_f32 v23, v23
    v_pk_mul_f32 v[120:121], v[120:121], v[16:17]
    v_pk_mul_f32 v[124:125], v[124:125], v[20:21]
    v_pk_mul_f32 v[122:123], v[122:123], v[18:19]
    v_pk_mul_f32 v[126:127], v[126:127], v[22:23]
    v_cvt_pk_bf16_f32 v114, v120, v121
    v_cvt_pk_bf16_f32 v115, v122, v123
    buffer_store_dwordx4 v[112:115], v2, s[40:43], s14 offen offset:1024 sc1
    v_cvt_pk_bf16_f32 v118, v124, v125
    v_cvt_pk_bf16_f32 v119, v126, v127
    buffer_store_dwordx4 v[116:119], v2, s[40:43], s15 offen offset:1024 sc1
    v_bfe_u32 v32, v1, 1, 2
    v_lshl_add_u32 v32, s44, 2, v32
    v_and_b32 v33, 1, v1
    s_lshl_b32 s48, s65, 1
    v_add_u32 v33, s48, v33
    s_lshr_b32 s48, s64, 1
    v_mov_b32 v13, s48
    v_lshrrev_b32 v34, 2, v32
    v_and_b32_e64 v32, 3, v32
    v_lshl_add_u32 v32, v32, 3, v34
    v_lshrrev_b32_e64 v34, 3, v33
    v_lshl_add_u32 v32, v34, 2, v32
    v_and_b32_e64 v34, 7, v33
    v_lshl_add_u32 v32, v34, 5, v32
    v_lshrrev_b32 v34, 2, v13
    v_and_b32 v13, 3, v13
    v_lshl_add_u32 v13, v13, 3, v34
    v_lshrrev_b32_e64 v34, 3, v33
    v_lshl_add_u32 v13, v34, 2, v13
    v_and_b32_e64 v34, 7, v33
    v_lshl_add_u32 v13, v34, 5, v13
    v_lshlrev_b32_e64 v32, 7, v32
    v_add_u32 v32, 163840, v32
    s_mul_i32 s52, s65, 458752
    s_lshl_b32 s48, s44, 14
    s_add_u32 s52, s52, s48
    s_add_u32 s52, s52, 13631488
    s_lshl_b32 s48, s64, 7
    s_lshl_b32 s49, s44, 5
    s_add_u32 s48, s48, s49
    v_lshlrev_b32 v33, 1, v3
    buffer_load_ushort v9, v33, s[28:31], s48 offen
    s_mov_b32 s48, 0
L_poll_20:
    buffer_load_dword v6, v32, s[40:43], 0 offen sc1
    s_add_u32 s48, s48, 1
    s_cmp_ge_u32 s48, 65536
    s_cbranch_scc1 L_pdone_21
    s_waitcnt vmcnt(0)
    v_cmp_ne_u32 vcc, s45, v6
    s_nop 0
    s_and_b64 exec, exec, vcc
    s_nop 2
    s_cbranch_scc1 L_poll_20
L_pdone_21:
    s_mov_b64 exec, -1
    s_waitcnt vmcnt(0)
    s_add_u32 s51, s52, 0
    buffer_load_dwordx4 v[128:131], v2, s[40:43], s51 offen offset:0 sc1
    buffer_load_dwordx4 v[132:135], v2, s[40:43], s51 offen offset:1024 sc1
    buffer_load_dwordx4 v[136:139], v2, s[40:43], s51 offen offset:2048 sc1
    buffer_load_dwordx4 v[140:143], v2, s[40:43], s51 offen offset:3072 sc1
    s_add_u32 s51, s52, 4096
    buffer_load_dwordx4 v[144:147], v2, s[40:43], s51 offen offset:0 sc1
    buffer_load_dwordx4 v[148:151], v2, s[40:43], s51 offen offset:1024 sc1
    buffer_load_dwordx4 v[152:155], v2, s[40:43], s51 offen offset:2048 sc1
    buffer_load_dwordx4 v[156:159], v2, s[40:43], s51 offen offset:3072 sc1
    s_add_u32 s51, s52, 8192
    buffer_load_dwordx4 v[160:163], v2, s[40:43], s51 offen offset:0 sc1
    buffer_load_dwordx4 v[164:167], v2, s[40:43], s51 offen offset:1024 sc1
    buffer_load_dwordx4 v[168:171], v2, s[40:43], s51 offen offset:2048 sc1
    buffer_load_dwordx4 v[172:175], v2, s[40:43], s51 offen offset:3072 sc1
L_p4join_11:
    s_barrier
    s_lshl_b32 s62, s2, 7
    s_add_u32 s62, s62, 196608
    s_cmp_eq_u32 s44, 0
    s_cselect_b32 exec_lo, 1, 0
    s_mov_b32 exec_hi, 0
    v_mov_b32 v6, s45
    v_mov_b32_e64 v7, 0
    buffer_store_dword v6, v7, s[40:43], s62 offen sc1
    s_mov_b64 exec, -1
    s_waitcnt vmcnt(11)
    v_mfma_f32_16x16x32_bf16 v[192:195], v[128:131], a[0:3], 0
    s_add_u32 s51, s52, 12288
    buffer_load_dwordx4 v[176:179], v2, s[40:43], s51 offen offset:0 sc1
    v_mfma_f32_16x16x32_bf16 v[196:199], v[128:131], a[64:67], 0
    v_lshlrev_b32 v9, 16, v9
    v_lshlrev_b32 v12, 3, v1
    v_mfma_f32_16x16x32_bf16 v[200:203], v[128:131], a[128:131], 0
    s_add_u32 s48, s44, 1
    s_and_b32 s48, s48, 3
    v_mfma_f32_16x16x32_bf16 v[204:207], v[128:131], a[192:195], 0
    s_mul_i32 s48, s48, 3072
    s_waitcnt vmcnt(11)
    v_mfma_f32_16x16x32_bf16 v[192:195], v[132:135], a[4:7], v[192:195]
    buffer_load_dwordx4 v[180:183], v2, s[40:43], s51 offen offset:1024 sc1
    s_add_u32 s48, s48, 114688
    v_mfma_f32_16x16x32_bf16 v[196:199], v[132:135], a[68:71], v[196:199]
    v_add_u32 v89, s48, v2
    s_add_u32 s48, s44, 2
    v_mfma_f32_16x16x32_bf16 v[200:203], v[132:135], a[132:135], v[200:203]
    s_and_b32 s48, s48, 3
    s_mul_i32 s48, s48, 3072
    v_mfma_f32_16x16x32_bf16 v[204:207], v[132:135], a[196:199], v[204:207]
    s_add_u32 s48, s48, 115712
    s_waitcnt vmcnt(11)
    v_mfma_f32_16x16x32_bf16 v[192:195], v[136:139], a[8:11], v[192:195]
    buffer_load_dwordx4 v[184:187], v2, s[40:43], s51 offen offset:2048 sc1
    v_add_u32 v90, s48, v2
    v_mfma_f32_16x16x32_bf16 v[196:199], v[136:139], a[72:75], v[196:199]
    s_add_u32 s48, s44, 3
    s_and_b32 s48, s48, 3
    v_mfma_f32_16x16x32_bf16 v[200:203], v[136:139], a[136:139], v[200:203]
    s_mul_i32 s48, s48, 3072
    s_add_u32 s48, s48, 116736
    v_mfma_f32_16x16x32_bf16 v[204:207], v[136:139], a[200:203], v[204:207]
    v_add_u32 v91, s48, v2
    s_waitcnt vmcnt(11)
    v_mfma_f32_16x16x32_bf16 v[192:195], v[140:143], a[12:15], v[192:195]
    buffer_load_dwordx4 v[188:191], v2, s[40:43], s51 offen offset:3072 sc1
    s_mul_i32 s48, s44, 3072
    v_mfma_f32_16x16x32_bf16 v[196:199], v[140:143], a[76:79], v[196:199]
    s_add_u32 s48, s48, 114688
    v_add_u32_e64 v11, s48, v2
    v_mfma_f32_16x16x32_bf16 v[200:203], v[140:143], a[140:143], v[200:203]
    s_lshl_b32 s50, s64, 2
    s_add_u32 s50, s50, s44
    v_mfma_f32_16x16x32_bf16 v[204:207], v[140:143], a[204:207], v[204:207]
    s_mul_i32 s50, s50, 56
    s_waitcnt vmcnt(11)
    v_mfma_f32_16x16x32_bf16 v[192:195], v[144:147], a[16:19], v[192:195]
    s_add_u32 s51, s52, 65536
    buffer_load_dwordx4 v[128:131], v2, s[40:43], s51 offen offset:0 sc1
    v_mfma_f32_16x16x32_bf16 v[196:199], v[144:147], a[80:83], v[196:199]
    s_mul_i32 s49, s65, 7
    s_add_u32 s50, s50, s49
    v_mfma_f32_16x16x32_bf16 v[200:203], v[144:147], a[144:147], v[200:203]
    s_lshl_b32 s50, s50, 9
    s_add_u32 s54, s50, 9961472
    v_mfma_f32_16x16x32_bf16 v[204:207], v[144:147], a[208:211], v[204:207]
    v_bfe_u32 v233, v1, 2, 2
    s_waitcnt vmcnt(11)
    v_mfma_f32_16x16x32_bf16 v[192:195], v[148:151], a[20:23], v[192:195]
    buffer_load_dwordx4 v[132:135], v2, s[40:43], s51 offen offset:1024 sc1
    v_lshl_add_u32 v234, v4, 2, v233
    v_mfma_f32_16x16x32_bf16 v[196:199], v[148:151], a[84:87], v[196:199]
    v_lshrrev_b32 v235, 1, v234
    v_and_b32 v235, 3, v235
    v_mfma_f32_16x16x32_bf16 v[200:203], v[148:151], a[148:151], v[200:203]
    v_lshlrev_b32_e64 v234, 7, v234
    v_lshl_add_u32 v234, v235, 5, v234
    v_mfma_f32_16x16x32_bf16 v[204:207], v[148:151], a[212:215], v[204:207]
    v_and_b32 v235, 3, v1
    s_waitcnt vmcnt(11)
    v_mfma_f32_16x16x32_bf16 v[192:195], v[152:155], a[24:27], v[192:195]
    buffer_load_dwordx4 v[136:139], v2, s[40:43], s51 offen offset:2048 sc1
    v_lshl_add_u32 v234, v235, 3, v234
    v_mfma_f32_16x16x32_bf16 v[196:199], v[152:155], a[88:91], v[196:199]
    s_mul_i32 s48, s44, 28672
    v_xor_b32_e64 v224, 0, v234
    v_mfma_f32_16x16x32_bf16 v[200:203], v[152:155], a[152:155], v[200:203]
    v_add_u32 v224, s48, v224
    v_xor_b32 v225, 32, v234
    v_mfma_f32_16x16x32_bf16 v[204:207], v[152:155], a[216:219], v[204:207]
    v_add_u32 v225, s48, v225
    s_waitcnt vmcnt(11)
    v_mfma_f32_16x16x32_bf16 v[192:195], v[156:159], a[28:31], v[192:195]
    buffer_load_dwordx4 v[140:143], v2, s[40:43], s51 offen offset:3072 sc1
    v_xor_b32_e64 v226, 64, v234
    v_mfma_f32_16x16x32_bf16 v[196:199], v[156:159], a[92:95], v[196:199]
    v_add_u32_e64 v226, s48, v226
    v_xor_b32 v227, 96, v234
    v_mfma_f32_16x16x32_bf16 v[200:203], v[156:159], a[156:159], v[200:203]
    v_add_u32 v227, s48, v227
    v_and_b32 v233, 1, v1
    v_mfma_f32_16x16x32_bf16 v[204:207], v[156:159], a[220:223], v[204:207]
    s_lshl_b32 s48, s60, 1
    s_waitcnt vmcnt(11)
    v_mfma_f32_16x16x32_bf16 v[192:195], v[160:163], a[32:35], v[192:195]
    s_add_u32 s51, s52, 69632
    buffer_load_dwordx4 v[144:147], v2, s[40:43], s51 offen offset:0 sc1
    v_mfma_f32_16x16x32_bf16 v[196:199], v[160:163], a[96:99], v[196:199]
    v_add_u32 v233, s48, v233
    s_lshr_b32 s48, s3, 1
    v_mfma_f32_16x16x32_bf16 v[200:203], v[160:163], a[160:163], v[200:203]
    v_mov_b32 v234, s48
    v_lshrrev_b32 v235, 2, v234
    v_mfma_f32_16x16x32_bf16 v[204:207], v[160:163], a[224:227], v[204:207]
    v_and_b32 v234, 3, v234
    s_waitcnt vmcnt(11)
    v_mfma_f32_16x16x32_bf16 v[192:195], v[164:167], a[36:39], v[192:195]
    buffer_load_dwordx4 v[148:151], v2, s[40:43], s51 offen offset:1024 sc1
    v_lshl_add_u32 v234, v234, 3, v235
    v_mfma_f32_16x16x32_bf16 v[196:199], v[164:167], a[100:103], v[196:199]
    v_lshrrev_b32_e64 v235, 3, v233
    v_lshl_add_u32 v234, v235, 2, v234
    v_mfma_f32_16x16x32_bf16 v[200:203], v[164:167], a[164:167], v[200:203]
    v_and_b32_e64 v235, 7, v233
    v_lshl_add_u32 v233, v235, 5, v234
    v_mfma_f32_16x16x32_bf16 v[204:207], v[164:167], a[228:231], v[204:207]
    v_cmp_gt_u32 vcc, 2, v1
    v_and_b32 v234, 1, v1
    s_nop 0
    v_cndmask_b32 v13, v233, v13, vcc
    s_waitcnt vmcnt(11)
    v_mfma_f32_16x16x32_bf16 v[192:195], v[168:171], a[40:43], v[192:195]
    buffer_load_dwordx4 v[152:155], v2, s[40:43], s51 offen offset:2048 sc1
    s_lshr_b32 s48, s44, 1
    v_mfma_f32_16x16x32_bf16 v[196:199], v[168:171], a[104:107], v[196:199]
    s_and_b32 s49, s44, 1
    s_lshl_b32 s49, s49, 4
    v_mfma_f32_16x16x32_bf16 v[200:203], v[168:171], a[168:171], v[200:203]
    s_add_u32 s48, s48, s49
    s_lshr_b32 s49, s3, 3
    v_mfma_f32_16x16x32_bf16 v[204:207], v[168:171], a[232:235], v[204:207]
    s_lshl_b32 s49, s49, 1
    s_waitcnt vmcnt(11)
    v_mfma_f32_16x16x32_bf16 v[192:195], v[172:175], a[44:47], v[192:195]
    buffer_load_dwordx4 v[156:159], v2, s[40:43], s51 offen offset:3072 sc1
    s_add_u32 s48, s48, s49
    v_mfma_f32_16x16x32_bf16 v[196:199], v[172:175], a[108:111], v[196:199]
    s_and_b32 s49, s3, 7
    s_lshl_b32 s49, s49, 5
    v_mfma_f32_16x16x32_bf16 v[200:203], v[172:175], a[172:175], v[200:203]
    s_add_u32 s48, s48, s49
    v_lshl_add_u32 v233, v234, 3, s48
    v_mfma_f32_16x16x32_bf16 v[204:207], v[172:175], a[236:239], v[204:207]
    v_cmp_gt_u32_e64 vcc, 4, v1
    v_bfe_u32 v234, v1, 2, 1
    v_lshlrev_b32 v229, 10, v234
    v_cndmask_b32 v13, v233, v13, vcc
    s_waitcnt vmcnt(11)
    v_mfma_f32_16x16x32_bf16 v[192:195], v[176:179], a[48:51], v[192:195]
    s_add_u32 s51, s52, 73728
    buffer_load_dwordx4 v[160:163], v2, s[40:43], s51 offen offset:0 sc1
    v_mfma_f32_16x16x32_bf16 v[196:199], v[176:179], a[112:115], v[196:199]
    v_lshlrev_b32 v13, 7, v13
    v_add_u32 v13, 196608, v13
    v_mfma_f32_16x16x32_bf16 v[200:203], v[176:179], a[176:179], v[200:203]
    v_and_b32_e64 v234, 3, v1
    v_lshl_add_u32 v229, v234, 4, v229
    v_mfma_f32_16x16x32_bf16 v[204:207], v[176:179], a[240:243], v[204:207]
    v_lshrrev_b32 v234, 3, v1
    s_waitcnt vmcnt(11)
    v_mfma_f32_16x16x32_bf16 v[192:195], v[180:183], a[52:55], v[192:195]
    buffer_load_dwordx4 v[164:167], v2, s[40:43], s51 offen offset:1024 sc1
    v_lshl_add_u32 v229, v234, 6, v229
    v_mfma_f32_16x16x32_bf16 v[196:199], v[180:183], a[116:119], v[196:199]
    s_mul_i32 s48, s44, 4352
    v_mul_u32_u24 v230, 272, v3
    v_mfma_f32_16x16x32_bf16 v[200:203], v[180:183], a[180:183], v[200:203]
    v_lshl_add_u32 v230, v4, 4, v230
    v_add_u32_e64 v230, s48, v230
    v_mfma_f32_16x16x32_bf16 v[204:207], v[180:183], a[244:247], v[204:207]
    s_mul_i32 s48, s44, 17408
    s_waitcnt vmcnt(11)
    v_mfma_f32_16x16x32_bf16 v[192:195], v[184:187], a[56:59], v[192:195]
    buffer_load_dwordx4 v[168:171], v2, s[40:43], s51 offen offset:2048 sc1
    v_mul_u32_u24 v231, 272, v234
    v_mfma_f32_16x16x32_bf16 v[196:199], v[184:187], a[120:123], v[196:199]
    v_and_b32 v235, 7, v1
    v_lshl_add_u32 v231, v235, 5, v231
    v_mfma_f32_16x16x32_bf16 v[200:203], v[184:187], a[184:187], v[200:203]
    v_add_u32 v231, s48, v231
    v_lshlrev_b32 v232, 10, v234
    v_mfma_f32_16x16x32_bf16 v[204:207], v[184:187], a[248:251], v[204:207]
    v_lshl_add_u32 v232, v235, 4, v232
    s_waitcnt vmcnt(11)
    v_mfma_f32_16x16x32_bf16 v[192:195], v[188:191], a[60:63], v[192:195]
    buffer_load_dwordx4 v[172:175], v2, s[40:43], s51 offen offset:3072 sc1
    s_lshl_b32 s55, s3, 3
    v_mfma_f32_16x16x32_bf16 v[196:199], v[188:191], a[124:127], v[196:199]
    s_lshl_b32 s48, s44, 1
    s_add_u32 s55, s55, s48
    v_mfma_f32_16x16x32_bf16 v[200:203], v[188:191], a[188:191], v[200:203]
    s_mul_i32 s55, s55, 14336
    s_add_u32 s55, s55, 19922944
    v_mfma_f32_16x16x32_bf16 v[204:207], v[188:191], a[252:255], v[204:207]
    s_lshl_b32 s56, s3, 2
    s_waitcnt vmcnt(11)
    v_mfma_f32_16x16x32_bf16 v[208:211], v[128:131], a[0:3], 0
    s_add_u32 s51, s52, 77824
    buffer_load_dwordx4 v[176:179], v2, s[40:43], s51 offen offset:0 sc1
    v_mfma_f32_16x16x32_bf16 v[212:215], v[128:131], a[64:67], 0
    s_add_u32 s56, s56, s44
    s_lshl_b32 s57, s56, 14
    v_mfma_f32_16x16x32_bf16 v[216:219], v[128:131], a[128:131], 0
    ds_write_b128 v89, v[196:199] offset:0
    v_mfma_f32_16x16x32_bf16 v[220:223], v[128:131], a[192:195], 0
    s_lshl_b32 s48, s60, 7
    s_waitcnt vmcnt(11)
    v_mfma_f32_16x16x32_bf16 v[208:211], v[132:135], a[4:7], v[208:211]
    buffer_load_dwordx4 v[180:183], v2, s[40:43], s51 offen offset:1024 sc1
    s_add_u32 s57, s57, s48
    v_mfma_f32_16x16x32_bf16 v[212:215], v[132:135], a[68:71], v[212:215]
    s_lshl_b32 s56, s56, 4
    s_lshl_b32 s48, s60, 1
    v_mfma_f32_16x16x32_bf16 v[216:219], v[132:135], a[132:135], v[216:219]
    ds_write_b128 v90, v[200:203] offset:0
    v_mfma_f32_16x16x32_bf16 v[220:223], v[132:135], a[196:199], v[220:223]
    s_add_u32 s56, s56, s48
    s_waitcnt vmcnt(11)
    v_mfma_f32_16x16x32_bf16 v[208:211], v[136:139], a[8:11], v[208:211]
    buffer_load_dwordx4 v[184:187], v2, s[40:43], s51 offen offset:2048 sc1
    s_lshl_b32 s56, s56, 10
    v_mfma_f32_16x16x32_bf16 v[212:215], v[136:139], a[72:75], v[212:215]
    s_add_u32 s56, s56, 17825792
    v_mfma_f32_16x16x32_bf16 v[216:219], v[136:139], a[136:139], v[216:219]
    ds_write_b128 v91, v[204:207] offset:0
    v_mfma_f32_16x16x32_bf16 v[220:223], v[136:139], a[200:203], v[220:223]
    s_waitcnt vmcnt(11)
    v_mfma_f32_16x16x32_bf16 v[208:211], v[140:143], a[12:15], v[208:211]
    buffer_load_dwordx4 v[188:191], v2, s[40:43], s51 offen offset:3072 sc1
    v_mfma_f32_16x16x32_bf16 v[212:215], v[140:143], a[76:79], v[212:215]
    v_mfma_f32_16x16x32_bf16 v[216:219], v[140:143], a[140:143], v[216:219]
    v_mfma_f32_16x16x32_bf16 v[220:223], v[140:143], a[204:207], v[220:223]
    s_waitcnt vmcnt(11)
    v_mfma_f32_16x16x32_bf16 v[208:211], v[144:147], a[16:19], v[208:211]
    s_add_u32 s51, s52, 131072
    buffer_load_dwordx4 v[128:131], v2, s[40:43], s51 offen offset:0 sc1
    v_mfma_f32_16x16x32_bf16 v[212:215], v[144:147], a[80:83], v[212:215]
    v_mfma_f32_16x16x32_bf16 v[216:219], v[144:147], a[144:147], v[216:219]
    s_waitcnt lgkmcnt(0)
    s_barrier
    v_mfma_f32_16x16x32_bf16 v[220:223], v[144:147], a[208:211], v[220:223]
    ds_read_b128 v[32:35], v11 offset:0
    s_waitcnt vmcnt(11)
    v_mfma_f32_16x16x32_bf16 v[208:211], v[148:151], a[20:23], v[208:211]
    buffer_load_dwordx4 v[132:135], v2, s[40:43], s51 offen offset:1024 sc1
    ds_read_b128 v[36:39], v11 offset:1024
    v_mfma_f32_16x16x32_bf16 v[212:215], v[148:151], a[84:87], v[212:215]
    ds_read_b128 v[40:43], v11 offset:2048
    v_mfma_f32_16x16x32_bf16 v[216:219], v[148:151], a[148:151], v[216:219]
    v_mfma_f32_16x16x32_bf16 v[220:223], v[148:151], a[212:215], v[220:223]
    s_waitcnt vmcnt(11)
    v_mfma_f32_16x16x32_bf16 v[208:211], v[152:155], a[24:27], v[208:211]
    buffer_load_dwordx4 v[136:139], v2, s[40:43], s51 offen offset:2048 sc1
    v_mfma_f32_16x16x32_bf16 v[212:215], v[152:155], a[88:91], v[212:215]
    v_mfma_f32_16x16x32_bf16 v[216:219], v[152:155], a[152:155], v[216:219]
    s_waitcnt lgkmcnt(0)
    v_add_f32 v32, v32, v36
    v_mfma_f32_16x16x32_bf16 v[220:223], v[152:155], a[216:219], v[220:223]
    v_add_f32 v33, v33, v37
    s_waitcnt vmcnt(11)
    v_mfma_f32_16x16x32_bf16 v[208:211], v[156:159], a[28:31], v[208:211]
    buffer_load_dwordx4 v[140:143], v2, s[40:43], s51 offen offset:3072 sc1
    v_add_f32_e64 v34, v34, v38
    v_mfma_f32_16x16x32_bf16 v[212:215], v[156:159], a[92:95], v[212:215]
    v_add_f32 v35, v35, v39
    v_add_f32 v40, v40, v192
    v_mfma_f32_16x16x32_bf16 v[216:219], v[156:159], a[156:159], v[216:219]
    v_add_f32 v41, v41, v193
    v_add_f32 v42, v42, v194
    v_mfma_f32_16x16x32_bf16 v[220:223], v[156:159], a[220:223], v[220:223]
    v_add_f32 v43, v43, v195
    s_waitcnt vmcnt(11)
    v_mfma_f32_16x16x32_bf16 v[208:211], v[160:163], a[32:35], v[208:211]
    s_add_u32 s51, s52, 135168
    buffer_load_dwordx4 v[144:147], v2, s[40:43], s51 offen offset:0 sc1
    v_mfma_f32_16x16x32_bf16 v[212:215], v[160:163], a[96:99], v[212:215]
    v_add_f32 v32, v32, v9
    v_add_f32 v33, v33, v9
    v_mfma_f32_16x16x32_bf16 v[216:219], v[160:163], a[160:163], v[216:219]
    v_add_f32 v34, v34, v9
    v_add_f32 v35, v35, v9
    v_mfma_f32_16x16x32_bf16 v[220:223], v[160:163], a[224:227], v[220:223]
    v_add_f32 v44, v32, v40
    s_waitcnt vmcnt(11)
    v_mfma_f32_16x16x32_bf16 v[208:211], v[164:167], a[36:39], v[208:211]
    buffer_load_dwordx4 v[148:151], v2, s[40:43], s51 offen offset:1024 sc1
    v_add_f32_e64 v45, v33, v41
    v_mfma_f32_16x16x32_bf16 v[212:215], v[164:167], a[100:103], v[212:215]
    v_add_f32 v46, v34, v42
    v_add_f32 v47, v35, v43
    v_mfma_f32_16x16x32_bf16 v[216:219], v[164:167], a[164:167], v[216:219]
    v_mfma_f32_16x16x32_bf16 v[220:223], v[164:167], a[228:231], v[220:223]
    s_waitcnt vmcnt(11)
    v_mfma_f32_16x16x32_bf16 v[208:211], v[168:171], a[40:43], v[208:211]
    buffer_load_dwordx4 v[152:155], v2, s[40:43], s51 offen offset:2048 sc1
    v_mfma_f32_16x16x32_bf16 v[212:215], v[168:171], a[104:107], v[212:215]
    v_mfma_f32_16x16x32_bf16 v[216:219], v[168:171], a[168:171], v[216:219]
    v_mfma_f32_16x16x32_bf16 v[220:223], v[168:171], a[232:235], v[220:223]
    s_waitcnt vmcnt(11)
    v_mfma_f32_16x16x32_bf16 v[208:211], v[172:175], a[44:47], v[208:211]
    buffer_load_dwordx4 v[156:159], v2, s[40:43], s51 offen offset:3072 sc1
    v_mfma_f32_16x16x32_bf16 v[212:215], v[172:175], a[108:111], v[212:215]
    v_mfma_f32_16x16x32_bf16 v[216:219], v[172:175], a[172:175], v[216:219]
    v_mfma_f32_16x16x32_bf16 v[220:223], v[172:175], a[236:239], v[220:223]
    s_waitcnt vmcnt(11)
    v_mfma_f32_16x16x32_bf16 v[208:211], v[176:179], a[48:51], v[208:211]
    s_add_u32 s51, s52, 139264
    buffer_load_dwordx4 v[160:163], v2, s[40:43], s51 offen offset:0 sc1
    v_mfma_f32_16x16x32_bf16 v[212:215], v[176:179], a[112:115], v[212:215]
    buffer_load_dword v10, v13, s[40:43], 0 offen sc1
    v_mfma_f32_16x16x32_bf16 v[216:219], v[176:179], a[176:179], v[216:219]
    v_mfma_f32_16x16x32_bf16 v[220:223], v[176:179], a[240:243], v[220:223]
    s_waitcnt vmcnt(12)
    v_mfma_f32_16x16x32_bf16 v[208:211], v[180:183], a[52:55], v[208:211]
    buffer_load_dwordx4 v[164:167], v2, s[40:43], s51 offen offset:1024 sc1
    v_mfma_f32_16x16x32_bf16 v[212:215], v[180:183], a[116:119], v[212:215]
    v_mfma_f32_16x16x32_bf16 v[216:219], v[180:183], a[180:183], v[216:219]
    v_mfma_f32_16x16x32_bf16 v[220:223], v[180:183], a[244:247], v[220:223]
    s_waitcnt vmcnt(12)
    v_mfma_f32_16x16x32_bf16 v[208:211], v[184:187], a[56:59], v[208:211]
    buffer_load_dwordx4 v[168:171], v2, s[40:43], s51 offen offset:2048 sc1
    v_mfma_f32_16x16x32_bf16 v[212:215], v[184:187], a[120:123], v[212:215]
    v_mfma_f32_16x16x32_bf16 v[216:219], v[184:187], a[184:187], v[216:219]
    v_mfma_f32_16x16x32_bf16 v[220:223], v[184:187], a[248:251], v[220:223]
    s_waitcnt vmcnt(12)
    v_mfma_f32_16x16x32_bf16 v[208:211], v[188:191], a[60:63], v[208:211]
    buffer_load_dwordx4 v[172:175], v2, s[40:43], s51 offen offset:3072 sc1
    v_mfma_f32_16x16x32_bf16 v[212:215], v[188:191], a[124:127], v[212:215]
    v_mfma_f32_16x16x32_bf16 v[216:219], v[188:191], a[188:191], v[216:219]
    v_mfma_f32_16x16x32_bf16 v[220:223], v[188:191], a[252:255], v[220:223]
    s_waitcnt vmcnt(12)
    v_mfma_f32_16x16x32_bf16 v[192:195], v[128:131], a[0:3], 0
    s_add_u32 s51, s52, 143360
    buffer_load_dwordx4 v[176:179], v2, s[40:43], s51 offen offset:0 sc1
    v_mfma_f32_16x16x32_bf16 v[196:199], v[128:131], a[64:67], 0
    v_mfma_f32_16x16x32_bf16 v[200:203], v[128:131], a[128:131], 0
    ds_write_b128 v89, v[212:215] offset:12288
    v_mfma_f32_16x16x32_bf16 v[204:207], v[128:131], a[192:195], 0
    s_waitcnt vmcnt(12)
    v_mfma_f32_16x16x32_bf16 v[192:195], v[132:135], a[4:7], v[192:195]
    buffer_load_dwordx4 v[180:183], v2, s[40:43], s51 offen offset:1024 sc1
    v_mfma_f32_16x16x32_bf16 v[196:199], v[132:135], a[68:71], v[196:199]
    v_mfma_f32_16x16x32_bf16 v[200:203], v[132:135], a[132:135], v[200:203]
    ds_write_b128 v90, v[216:219] offset:12288
    v_mfma_f32_16x16x32_bf16 v[204:207], v[132:135], a[196:199], v[204:207]
    s_waitcnt vmcnt(12)
    v_mfma_f32_16x16x32_bf16 v[192:195], v[136:139], a[8:11], v[192:195]
    buffer_load_dwordx4 v[184:187], v2, s[40:43], s51 offen offset:2048 sc1
    v_mfma_f32_16x16x32_bf16 v[196:199], v[136:139], a[72:75], v[196:199]
    v_mfma_f32_16x16x32_bf16 v[200:203], v[136:139], a[136:139], v[200:203]
    ds_write_b128 v91, v[220:223] offset:12288
    v_mfma_f32_16x16x32_bf16 v[204:207], v[136:139], a[200:203], v[204:207]
    s_waitcnt vmcnt(12)
    v_mfma_f32_16x16x32_bf16 v[192:195], v[140:143], a[12:15], v[192:195]
    buffer_load_dwordx4 v[188:191], v2, s[40:43], s51 offen offset:3072 sc1
    v_mfma_f32_16x16x32_bf16 v[196:199], v[140:143], a[76:79], v[196:199]
    v_mfma_f32_16x16x32_bf16 v[200:203], v[140:143], a[140:143], v[200:203]
    v_mfma_f32_16x16x32_bf16 v[204:207], v[140:143], a[204:207], v[204:207]
    s_waitcnt vmcnt(12)
    v_mfma_f32_16x16x32_bf16 v[192:195], v[144:147], a[16:19], v[192:195]
    s_add_u32 s51, s52, 196608
    buffer_load_dwordx4 v[128:131], v2, s[40:43], s51 offen offset:0 sc1
    v_mfma_f32_16x16x32_bf16 v[196:199], v[144:147], a[80:83], v[196:199]
    v_mfma_f32_16x16x32_bf16 v[200:203], v[144:147], a[144:147], v[200:203]
    s_waitcnt lgkmcnt(0)
    s_barrier
    v_mfma_f32_16x16x32_bf16 v[204:207], v[144:147], a[208:211], v[204:207]
    ds_read_b128 v[32:35], v11 offset:12288
    s_waitcnt vmcnt(12)
    v_mfma_f32_16x16x32_bf16 v[192:195], v[148:151], a[20:23], v[192:195]
    buffer_load_dwordx4 v[132:135], v2, s[40:43], s51 offen offset:1024 sc1
    ds_read_b128 v[36:39], v11 offset:13312
    v_mfma_f32_16x16x32_bf16 v[196:199], v[148:151], a[84:87], v[196:199]
    ds_read_b128 v[40:43], v11 offset:14336
    v_mfma_f32_16x16x32_bf16 v[200:203], v[148:151], a[148:151], v[200:203]
    v_mfma_f32_16x16x32_bf16 v[204:207], v[148:151], a[212:215], v[204:207]
    s_waitcnt vmcnt(12)
    v_mfma_f32_16x16x32_bf16 v[192:195], v[152:155], a[24:27], v[192:195]
    buffer_load_dwordx4 v[136:139], v2, s[40:43], s51 offen offset:2048 sc1
    v_mfma_f32_16x16x32_bf16 v[196:199], v[152:155], a[88:91], v[196:199]
    v_mfma_f32_16x16x32_bf16 v[200:203], v[152:155], a[152:155], v[200:203]
    s_waitcnt lgkmcnt(0)
    v_add_f32_e64 v32, v32, v36
    v_mfma_f32_16x16x32_bf16 v[204:207], v[152:155], a[216:219], v[204:207]
    v_add_f32 v33, v33, v37
    s_waitcnt vmcnt(12)
    v_mfma_f32_16x16x32_bf16 v[192:195], v[156:159], a[28:31], v[192:195]
    buffer_load_dwordx4 v[140:143], v2, s[40:43], s51 offen offset:3072 sc1
    v_add_f32_e64 v34, v34, v38
    v_mfma_f32_16x16x32_bf16 v[196:199], v[156:159], a[92:95], v[196:199]
    v_add_f32 v35, v35, v39
    v_add_f32 v40, v40, v208
    v_mfma_f32_16x16x32_bf16 v[200:203], v[156:159], a[156:159], v[200:203]
    v_add_f32 v41, v41, v209
    v_add_f32 v42, v42, v210
    v_mfma_f32_16x16x32_bf16 v[204:207], v[156:159], a[220:223], v[204:207]
    v_add_f32 v43, v43, v211
    s_waitcnt vmcnt(12)
    v_mfma_f32_16x16x32_bf16 v[192:195], v[160:163], a[32:35], v[192:195]
    s_add_u32 s51, s52, 200704
    buffer_load_dwordx4 v[144:147], v2, s[40:43], s51 offen offset:0 sc1
    v_mfma_f32_16x16x32_bf16 v[196:199], v[160:163], a[96:99], v[196:199]
    v_add_f32 v32, v32, v9
    v_add_f32 v33, v33, v9
    v_mfma_f32_16x16x32_bf16 v[200:203], v[160:163], a[160:163], v[200:203]
    v_add_f32 v34, v34, v9
    v_add_f32 v35, v35, v9
    v_mfma_f32_16x16x32_bf16 v[204:207], v[160:163], a[224:227], v[204:207]
    v_add_f32 v48, v32, v40
    s_waitcnt vmcnt(11)
    v_mfma_f32_16x16x32_bf16 v[192:195], v[164:167], a[36:39], v[192:195]
    buffer_load_dwordx4 v[148:151], v2, s[40:43], s51 offen offset:1024 sc1
    v_add_f32_e64 v49, v33, v41
    v_mfma_f32_16x16x32_bf16 v[196:199], v[164:167], a[100:103], v[196:199]
    v_add_f32 v50, v34, v42
    v_add_f32 v51, v35, v43
    v_mfma_f32_16x16x32_bf16 v[200:203], v[164:167], a[164:167], v[200:203]
    s_waitcnt vmcnt(13)
    v_cmp_ne_u32 vcc, s45, v10
    s_nop 0
    s_cbranch_vccnz L_slow_22
L_back_23:
    v_mfma_f32_16x16x32_bf16 v[204:207], v[164:167], a[228:231], v[204:207]
    buffer_load_dwordx4 v[64:67], v2, s[40:43], s54 offen offset:0 sc1
    s_waitcnt vmcnt(12)
    v_mfma_f32_16x16x32_bf16 v[192:195], v[168:171], a[40:43], v[192:195]
    buffer_load_dwordx4 v[152:155], v2, s[40:43], s51 offen offset:2048 sc1
    v_mfma_f32_16x16x32_bf16 v[196:199], v[168:171], a[104:107], v[196:199]
    v_mfma_f32_16x16x32_bf16 v[200:203], v[168:171], a[168:171], v[200:203]
    v_mfma_f32_16x16x32_bf16 v[204:207], v[168:171], a[232:235], v[204:207]
    s_waitcnt vmcnt(12)
    v_mfma_f32_16x16x32_bf16 v[192:195], v[172:175], a[44:47], v[192:195]
    buffer_load_dwordx4 v[156:159], v2, s[40:43], s51 offen offset:3072 sc1
    v_mfma_f32_16x16x32_bf16 v[196:199], v[172:175], a[108:111], v[196:199]
    v_mfma_f32_16x16x32_bf16 v[200:203], v[172:175], a[172:175], v[200:203]
    v_mfma_f32_16x16x32_bf16 v[204:207], v[172:175], a[236:239], v[204:207]
    s_waitcnt vmcnt(12)
    v_mfma_f32_16x16x32_bf16 v[192:195], v[176:179], a[48:51], v[192:195]
    s_add_u32 s51, s52, 204800
    buffer_load_dwordx4 v[160:163], v2, s[40:43], s51 offen offset:0 sc1
    v_mfma_f32_16x16x32_bf16 v[196:199], v[176:179], a[112:115], v[196:199]
    v_mfma_f32_16x16x32_bf16 v[200:203], v[176:179], a[176:179], v[200:203]
    v_mfma_f32_16x16x32_bf16 v[204:207], v[176:179], a[240:243], v[204:207]
    s_waitcnt vmcnt(12)
    v_mfma_f32_16x16x32_bf16 v[192:195], v[180:183], a[52:55], v[192:195]
    buffer_load_dwordx4 v[164:167], v2, s[40:43], s51 offen offset:1024 sc1
    v_mfma_f32_16x16x32_bf16 v[196:199], v[180:183], a[116:119], v[196:199]
    v_mfma_f32_16x16x32_bf16 v[200:203], v[180:183], a[180:183], v[200:203]
    v_mfma_f32_16x16x32_bf16 v[204:207], v[180:183], a[244:247], v[204:207]
    s_waitcnt vmcnt(12)
    v_mfma_f32_16x16x32_bf16 v[192:195], v[184:187], a[56:59], v[192:195]
    buffer_load_dwordx4 v[168:171], v2, s[40:43], s51 offen offset:2048 sc1
    v_mfma_f32_16x16x32_bf16 v[196:199], v[184:187], a[120:123], v[196:199]
    v_mfma_f32_16x16x32_bf16 v[200:203], v[184:187], a[184:187], v[200:203]
    v_mfma_f32_16x16x32_bf16 v[204:207], v[184:187], a[248:251], v[204:207]
    s_waitcnt vmcnt(12)
    v_mfma_f32_16x16x32_bf16 v[192:195], v[188:191], a[60:63], v[192:195]
    buffer_load_dwordx4 v[172:175], v2, s[40:43], s51 offen offset:3072 sc1
    v_mfma_f32_16x16x32_bf16 v[196:199], v[188:191], a[124:127], v[196:199]
    v_mfma_f32_16x16x32_bf16 v[200:203], v[188:191], a[188:191], v[200:203]
    v_mfma_f32_16x16x32_bf16 v[204:207], v[188:191], a[252:255], v[204:207]
    s_waitcnt vmcnt(12)
    v_mfma_f32_16x16x32_bf16 v[208:211], v[128:131], a[0:3], 0
    s_add_u32 s51, s52, 208896
    buffer_load_dwordx4 v[176:179], v2, s[40:43], s51 offen offset:0 sc1
    v_mfma_f32_16x16x32_bf16 v[212:215], v[128:131], a[64:67], 0
    buffer_load_dwordx2 v[76:77], v12, s[40:43], s54 offen offset:1024 sc1
    v_mfma_f32_16x16x32_bf16 v[216:219], v[128:131], a[128:131], 0
    ds_write_b128 v89, v[196:199] offset:0
    v_mfma_f32_16x16x32_bf16 v[220:223], v[128:131], a[192:195], 0
    s_waitcnt vmcnt(13)
    v_mfma_f32_16x16x32_bf16 v[208:211], v[132:135], a[4:7], v[208:211]
    buffer_load_dwordx4 v[180:183], v2, s[40:43], s51 offen offset:1024 sc1
    v_mfma_f32_16x16x32_bf16 v[212:215], v[132:135], a[68:71], v[212:215]
    v_mfma_f32_16x16x32_bf16 v[216:219], v[132:135], a[132:135], v[216:219]
    ds_write_b128 v90, v[200:203] offset:0
    v_mfma_f32_16x16x32_bf16 v[220:223], v[132:135], a[196:199], v[220:223]
    s_waitcnt vmcnt(13)
    v_mfma_f32_16x16x32_bf16 v[208:211], v[136:139], a[8:11], v[208:211]
    buffer_load_dwordx4 v[184:187], v2, s[40:43], s51 offen offset:2048 sc1
    v_mfma_f32_16x16x32_bf16 v[212:215], v[136:139], a[72:75], v[212:215]
    v_mfma_f32_16x16x32_bf16 v[216:219], v[136:139], a[136:139], v[216:219]
    ds_write_b128 v91, v[204:207] offset:0
    v_mfma_f32_16x16x32_bf16 v[220:223], v[136:139], a[200:203], v[220:223]
    s_waitcnt vmcnt(13)
    v_mfma_f32_16x16x32_bf16 v[208:211], v[140:143], a[12:15], v[208:211]
    buffer_load_dwordx4 v[188:191], v2, s[40:43], s51 offen offset:3072 sc1
    v_mfma_f32_16x16x32_bf16 v[212:215], v[140:143], a[76:79], v[212:215]
    v_mfma_f32_16x16x32_bf16 v[216:219], v[140:143], a[140:143], v[216:219]
    v_mfma_f32_16x16x32_bf16 v[220:223], v[140:143], a[204:207], v[220:223]
    s_waitcnt vmcnt(13)
    v_mfma_f32_16x16x32_bf16 v[208:211], v[144:147], a[16:19], v[208:211]
    s_add_u32 s51, s52, 262144
    buffer_load_dwordx4 v[128:131], v2, s[40:43], s51 offen offset:0 sc1
    v_mfma_f32_16x16x32_bf16 v[212:215], v[144:147], a[80:83], v[212:215]
    v_mfma_f32_16x16x32_bf16 v[216:219], v[144:147], a[144:147], v[216:219]
    s_waitcnt lgkmcnt(0)
    s_barrier
    v_mfma_f32_16x16x32_bf16 v[220:223], v[144:147], a[208:211], v[220:223]
    ds_read_b128 v[32:35], v11 offset:0
    s_waitcnt vmcnt(13)
    v_mfma_f32_16x16x32_bf16 v[208:211], v[148:151], a[20:23], v[208:211]
    buffer_load_dwordx4 v[132:135], v2, s[40:43], s51 offen offset:1024 sc1
    ds_read_b128 v[36:39], v11 offset:1024
    v_mfma_f32_16x16x32_bf16 v[212:215], v[148:151], a[84:87], v[212:215]
    ds_read_b128 v[40:43], v11 offset:2048
    v_mfma_f32_16x16x32_bf16 v[216:219], v[148:151], a[148:151], v[216:219]
    v_mfma_f32_16x16x32_bf16 v[220:223], v[148:151], a[212:215], v[220:223]
    s_waitcnt vmcnt(12)
    v_mfma_f32_16x16x32_bf16 v[208:211], v[152:155], a[24:27], v[208:211]
    buffer_load_dwordx4 v[136:139], v2, s[40:43], s51 offen offset:2048 sc1
    v_mfma_f32_16x16x32_bf16 v[212:215], v[152:155], a[88:91], v[212:215]
    v_mfma_f32_16x16x32_bf16 v[216:219], v[152:155], a[152:155], v[216:219]
    s_waitcnt lgkmcnt(0)
    v_add_f32_e64 v32, v32, v36
    v_mfma_f32_16x16x32_bf16 v[220:223], v[152:155], a[216:219], v[220:223]
    v_add_f32 v33, v33, v37
    s_waitcnt vmcnt(12)
    v_mfma_f32_16x16x32_bf16 v[208:211], v[156:159], a[28:31], v[208:211]
    buffer_load_dwordx4 v[140:143], v2, s[40:43], s51 offen offset:3072 sc1
    v_add_f32_e64 v34, v34, v38
    v_mfma_f32_16x16x32_bf16 v[212:215], v[156:159], a[92:95], v[212:215]
    v_add_f32 v35, v35, v39
    v_add_f32 v40, v40, v192
    v_mfma_f32_16x16x32_bf16 v[216:219], v[156:159], a[156:159], v[216:219]
    v_add_f32 v41, v41, v193
    v_add_f32 v42, v42, v194
    v_mfma_f32_16x16x32_bf16 v[220:223], v[156:159], a[220:223], v[220:223]
    v_add_f32 v43, v43, v195
    s_waitcnt vmcnt(12)
    v_mfma_f32_16x16x32_bf16 v[208:211], v[160:163], a[32:35], v[208:211]
    s_add_u32 s51, s52, 266240
    buffer_load_dwordx4 v[144:147], v2, s[40:43], s51 offen offset:0 sc1
    v_mfma_f32_16x16x32_bf16 v[212:215], v[160:163], a[96:99], v[212:215]
    v_add_f32 v32, v32, v9
    v_add_f32 v33, v33, v9
    v_mfma_f32_16x16x32_bf16 v[216:219], v[160:163], a[160:163], v[216:219]
    v_add_f32 v34, v34, v9
    v_add_f32 v35, v35, v9
    v_mfma_f32_16x16x32_bf16 v[220:223], v[160:163], a[224:227], v[220:223]
    v_add_f32 v52, v32, v40
    s_waitcnt vmcnt(12)
    v_mfma_f32_16x16x32_bf16 v[208:211], v[164:167], a[36:39], v[208:211]
    buffer_load_dwordx4 v[148:151], v2, s[40:43], s51 offen offset:1024 sc1
    v_add_f32_e64 v53, v33, v41
    v_mfma_f32_16x16x32_bf16 v[212:215], v[164:167], a[100:103], v[212:215]
    v_add_f32 v54, v34, v42
    v_add_f32 v55, v35, v43
    v_mfma_f32_16x16x32_bf16 v[216:219], v[164:167], a[164:167], v[216:219]
    buffer_load_dwordx4 v[68:71], v2, s[40:43], s54 offen offset:1536 sc1
    v_mfma_f32_16x16x32_bf16 v[220:223], v[164:167], a[228:231], v[220:223]
    s_waitcnt vmcnt(13)
    v_mfma_f32_16x16x32_bf16 v[208:211], v[168:171], a[40:43], v[208:211]
    buffer_load_dwordx4 v[152:155], v2, s[40:43], s51 offen offset:2048 sc1
    v_mfma_f32_16x16x32_bf16 v[212:215], v[168:171], a[104:107], v[212:215]
    v_mfma_f32_16x16x32_bf16 v[216:219], v[168:171], a[168:171], v[216:219]
    v_mfma_f32_16x16x32_bf16 v[220:223], v[168:171], a[232:235], v[220:223]
    s_waitcnt vmcnt(13)
    v_mfma_f32_16x16x32_bf16 v[208:211], v[172:175], a[44:47], v[208:211]
    buffer_load_dwordx4 v[156:159], v2, s[40:43], s51 offen offset:3072 sc1
    v_mfma_f32_16x16x32_bf16 v[212:215], v[172:175], a[108:111], v[212:215]
    v_mfma_f32_16x16x32_bf16 v[216:219], v[172:175], a[172:175], v[216:219]
    v_mfma_f32_16x16x32_bf16 v[220:223], v[172:175], a[236:239], v[220:223]
    s_waitcnt vmcnt(13)
    v_mfma_f32_16x16x32_bf16 v[208:211], v[176:179], a[48:51], v[208:211]
    s_add_u32 s51, s52, 270336
    buffer_load_dwordx4 v[160:163], v2, s[40:43], s51 offen offset:0 sc1
    v_mfma_f32_16x16x32_bf16 v[212:215], v[176:179], a[112:115], v[212:215]
    v_mfma_f32_16x16x32_bf16 v[216:219], v[176:179], a[176:179], v[216:219]
    v_mfma_f32_16x16x32_bf16 v[220:223], v[176:179], a[240:243], v[220:223]
    s_waitcnt vmcnt(12)
    v_mfma_f32_16x16x32_bf16 v[208:211], v[180:183], a[52:55], v[208:211]
    buffer_load_dwordx4 v[164:167], v2, s[40:43], s51 offen offset:1024 sc1
    v_mfma_f32_16x16x32_bf16 v[212:215], v[180:183], a[116:119], v[212:215]
    v_mfma_f32_16x16x32_bf16 v[216:219], v[180:183], a[180:183], v[216:219]
    v_mfma_f32_16x16x32_bf16 v[220:223], v[180:183], a[244:247], v[220:223]
    s_waitcnt vmcnt(12)
    v_mfma_f32_16x16x32_bf16 v[208:211], v[184:187], a[56:59], v[208:211]
    buffer_load_dwordx4 v[168:171], v2, s[40:43], s51 offen offset:2048 sc1
    buffer_load_dwordx4 v[72:75], v2, s[40:43], s54 offen offset:2560 sc1
    v_mfma_f32_16x16x32_bf16 v[212:215], v[184:187], a[120:123], v[212:215]
    v_mfma_f32_16x16x32_bf16 v[216:219], v[184:187], a[184:187], v[216:219]
    v_mfma_f32_16x16x32_bf16 v[220:223], v[184:187], a[248:251], v[220:223]
    s_waitcnt vmcnt(13)
    v_mfma_f32_16x16x32_bf16 v[208:211], v[188:191], a[60:63], v[208:211]
    buffer_load_dwordx4 v[172:175], v2, s[40:43], s51 offen offset:3072 sc1
    v_mfma_f32_16x16x32_bf16 v[212:215], v[188:191], a[124:127], v[212:215]
    v_mfma_f32_16x16x32_bf16 v[216:219], v[188:191], a[188:191], v[216:219]
    v_mfma_f32_16x16x32_bf16 v[220:223], v[188:191], a[252:255], v[220:223]
    s_waitcnt vmcnt(17)
    s_waitcnt vmcnt(13)
    v_mfma_f32_16x16x32_bf16 v[192:195], v[128:131], a[0:3], 0
    s_add_u32 s51, s52, 274432
    buffer_load_dwordx4 v[176:179], v2, s[40:43], s51 offen offset:0 sc1
    v_mfma_f32_16x16x32_bf16 v[196:199], v[128:131], a[64:67], 0
    v_lshlrev_b32_e64 v92, 16, v64
    v_and_b32 v93, 0xffff0000, v64
    v_mfma_f32_16x16x32_bf16 v[200:203], v[128:131], a[128:131], 0
    ds_write_b128 v89, v[212:215] offset:12288
    v_mfma_f32_16x16x32_bf16 v[204:207], v[128:131], a[192:195], 0
    v_lshlrev_b32 v94, 16, v65
    s_waitcnt vmcnt(13)
    v_mfma_f32_16x16x32_bf16 v[192:195], v[132:135], a[4:7], v[192:195]
    buffer_load_dwordx4 v[180:183], v2, s[40:43], s51 offen offset:1024 sc1
    v_and_b32 v95, 0xffff0000, v65
    v_mfma_f32_16x16x32_bf16 v[196:199], v[132:135], a[68:71], v[196:199]
    v_mul_f32 v44, v44, v92
    v_mul_f32 v45, v45, v93
    v_mfma_f32_16x16x32_bf16 v[200:203], v[132:135], a[132:135], v[200:203]
    ds_write_b128 v90, v[216:219] offset:12288
    v_mfma_f32_16x16x32_bf16 v[204:207], v[132:135], a[196:199], v[204:207]
    v_mul_f32 v46, v46, v94
    s_waitcnt vmcnt(13)
    v_mfma_f32_16x16x32_bf16 v[192:195], v[136:139], a[8:11], v[192:195]
    buffer_load_dwordx4 v[184:187], v2, s[40:43], s51 offen offset:2048 sc1
    v_mul_f32_e64 v47, v47, v95
    v_mfma_f32_16x16x32_bf16 v[196:199], v[136:139], a[72:75], v[196:199]
    v_cvt_pk_bf16_f32 v80, v44, v45
    v_cvt_pk_bf16_f32 v81, v46, v47
    v_mfma_f32_16x16x32_bf16 v[200:203], v[136:139], a[136:139], v[200:203]
    ds_write_b128 v91, v[220:223] offset:12288
    v_mfma_f32_16x16x32_bf16 v[204:207], v[136:139], a[200:203], v[204:207]
    v_lshlrev_b32 v92, 16, v66
    s_waitcnt vmcnt(13)
    v_mfma_f32_16x16x32_bf16 v[192:195], v[140:143], a[12:15], v[192:195]
    buffer_load_dwordx4 v[188:191], v2, s[40:43], s51 offen offset:3072 sc1
    v_and_b32 v93, 0xffff0000, v66
    v_mfma_f32_16x16x32_bf16 v[196:199], v[140:143], a[76:79], v[196:199]
    v_lshlrev_b32_e64 v94, 16, v67
    v_and_b32 v95, 0xffff0000, v67
    v_mfma_f32_16x16x32_bf16 v[200:203], v[140:143], a[140:143], v[200:203]
    v_mul_f32 v48, v48, v92
    v_mul_f32 v49, v49, v93
    v_mfma_f32_16x16x32_bf16 v[204:207], v[140:143], a[204:207], v[204:207]
    v_mul_f32 v50, v50, v94
    s_waitcnt vmcnt(13)
    v_mfma_f32_16x16x32_bf16 v[192:195], v[144:147], a[16:19], v[192:195]
    s_add_u32 s51, s52, 327680
    buffer_load_dwordx4 v[128:131], v2, s[40:43], s51 offen offset:0 sc1
    v_mfma_f32_16x16x32_bf16 v[196:199], v[144:147], a[80:83], v[196:199]
    v_mul_f32_e64 v51, v51, v95
    v_cvt_pk_bf16_f32 v82, v48, v49
    v_mfma_f32_16x16x32_bf16 v[200:203], v[144:147], a[144:147], v[200:203]
    s_waitcnt lgkmcnt(0)
    s_barrier
    v_mfma_f32_16x16x32_bf16 v[204:207], v[144:147], a[208:211], v[204:207]
    ds_read_b128 v[32:35], v11 offset:12288
    s_waitcnt vmcnt(13)
    v_mfma_f32_16x16x32_bf16 v[192:195], v[148:151], a[20:23], v[192:195]
    buffer_load_dwordx4 v[132:135], v2, s[40:43], s51 offen offset:1024 sc1
    ds_read_b128 v[36:39], v11 offset:13312
    v_mfma_f32_16x16x32_bf16 v[196:199], v[148:151], a[84:87], v[196:199]
    ds_read_b128 v[40:43], v11 offset:14336
    v_cvt_pk_bf16_f32 v83, v50, v51
    v_mfma_f32_16x16x32_bf16 v[200:203], v[148:151], a[148:151], v[200:203]
    buffer_store_dwordx4 v[80:83], v2, s[40:43], s53 offen offset:0 sc1
    v_mfma_f32_16x16x32_bf16 v[204:207], v[148:151], a[212:215], v[204:207]
    buffer_load_dwordx4 v[240:243], v229, s[40:43], s56 offen offset:0 sc1
    s_waitcnt vmcnt(14)
    v_mfma_f32_16x16x32_bf16 v[192:195], v[152:155], a[24:27], v[192:195]
    buffer_load_dwordx4 v[136:139], v2, s[40:43], s51 offen offset:2048 sc1
    v_lshlrev_b32_e64 v92, 16, v76
    v_mfma_f32_16x16x32_bf16 v[196:199], v[152:155], a[88:91], v[196:199]
    v_and_b32 v93, 0xffff0000, v76
    v_lshlrev_b32_e64 v94, 16, v77
    v_mfma_f32_16x16x32_bf16 v[200:203], v[152:155], a[152:155], v[200:203]
    s_waitcnt lgkmcnt(0)
    v_add_f32 v32, v32, v36
    v_mfma_f32_16x16x32_bf16 v[204:207], v[152:155], a[216:219], v[204:207]
    v_add_f32 v33, v33, v37
    s_waitcnt vmcnt(14)
    v_mfma_f32_16x16x32_bf16 v[192:195], v[156:159], a[28:31], v[192:195]
    buffer_load_dwordx4 v[140:143], v2, s[40:43], s51 offen offset:3072 sc1
    v_add_f32_e64 v34, v34, v38
    v_mfma_f32_16x16x32_bf16 v[196:199], v[156:159], a[92:95], v[196:199]
    v_add_f32 v35, v35, v39
    v_add_f32 v40, v40, v208
    v_mfma_f32_16x16x32_bf16 v[200:203], v[156:159], a[156:159], v[200:203]
    v_add_f32 v41, v41, v209
    v_add_f32 v42, v42, v210
    v_mfma_f32_16x16x32_bf16 v[204:207], v[156:159], a[220:223], v[204:207]
    v_add_f32 v43, v43, v211
    s_waitcnt vmcnt(14)
    v_mfma_f32_16x16x32_bf16 v[192:195], v[160:163], a[32:35], v[192:195]
    s_add_u32 s51, s52, 331776
    buffer_load_dwordx4 v[144:147], v2, s[40:43], s51 offen offset:0 sc1
    v_mfma_f32_16x16x32_bf16 v[196:199], v[160:163], a[96:99], v[196:199]
    v_add_f32 v32, v32, v9
    v_add_f32 v33, v33, v9
    v_mfma_f32_16x16x32_bf16 v[200:203], v[160:163], a[160:163], v[200:203]
    v_add_f32 v34, v34, v9
    v_add_f32 v35, v35, v9
    v_mfma_f32_16x16x32_bf16 v[204:207], v[160:163], a[224:227], v[204:207]
    v_add_f32 v56, v32, v40
    s_waitcnt vmcnt(14)
    v_mfma_f32_16x16x32_bf16 v[192:195], v[164:167], a[36:39], v[192:195]
    buffer_load_dwordx4 v[148:151], v2, s[40:43], s51 offen offset:1024 sc1
    v_add_f32_e64 v57, v33, v41
    v_mfma_f32_16x16x32_bf16 v[196:199], v[164:167], a[100:103], v[196:199]
    v_add_f32 v58, v34, v42
    v_add_f32 v59, v35, v43
    v_mfma_f32_16x16x32_bf16 v[200:203], v[164:167], a[164:167], v[200:203]
    v_and_b32 v95, 0xffff0000, v77
    v_mul_f32_e64 v52, v52, v92
    v_mfma_f32_16x16x32_bf16 v[204:207], v[164:167], a[228:231], v[204:207]
    v_mul_f32 v53, v53, v93
    s_waitcnt vmcnt(14)
    v_mfma_f32_16x16x32_bf16 v[192:195], v[168:171], a[40:43], v[192:195]
    buffer_load_dwordx4 v[152:155], v2, s[40:43], s51 offen offset:2048 sc1
    v_mul_f32_e64 v54, v54, v94
    v_mfma_f32_16x16x32_bf16 v[196:199], v[168:171], a[104:107], v[196:199]
    v_mul_f32_e64 v55, v55, v95
    v_cvt_pk_bf16_f32 v84, v52, v53
    v_mfma_f32_16x16x32_bf16 v[200:203], v[168:171], a[168:171], v[200:203]
    v_cvt_pk_bf16_f32 v85, v54, v55
    v_mfma_f32_16x16x32_bf16 v[204:207], v[168:171], a[232:235], v[204:207]
    s_waitcnt vmcnt(13)
    v_mfma_f32_16x16x32_bf16 v[192:195], v[172:175], a[44:47], v[192:195]
    buffer_load_dwordx4 v[156:159], v2, s[40:43], s51 offen offset:3072 sc1
    v_mfma_f32_16x16x32_bf16 v[196:199], v[172:175], a[108:111], v[196:199]
    v_mfma_f32_16x16x32_bf16 v[200:203], v[172:175], a[172:175], v[200:203]
    v_mfma_f32_16x16x32_bf16 v[204:207], v[172:175], a[236:239], v[204:207]
    s_waitcnt vmcnt(13)
    v_mfma_f32_16x16x32_bf16 v[192:195], v[176:179], a[48:51], v[192:195]
    s_add_u32 s51, s52, 335872
    buffer_load_dwordx4 v[160:163], v2, s[40:43], s51 offen offset:0 sc1
    v_mfma_f32_16x16x32_bf16 v[196:199], v[176:179], a[112:115], v[196:199]
    v_mfma_f32_16x16x32_bf16 v[200:203], v[176:179], a[176:179], v[200:203]
    v_mfma_f32_16x16x32_bf16 v[204:207], v[176:179], a[240:243], v[204:207]
    s_waitcnt vmcnt(13)
    v_mfma_f32_16x16x32_bf16 v[192:195], v[180:183], a[52:55], v[192:195]
    buffer_load_dwordx4 v[164:167], v2, s[40:43], s51 offen offset:1024 sc1
    v_mfma_f32_16x16x32_bf16 v[196:199], v[180:183], a[116:119], v[196:199]
    v_mfma_f32_16x16x32_bf16 v[200:203], v[180:183], a[180:183], v[200:203]
    v_mfma_f32_16x16x32_bf16 v[204:207], v[180:183], a[244:247], v[204:207]
    s_waitcnt vmcnt(13)
    v_mfma_f32_16x16x32_bf16 v[192:195], v[184:187], a[56:59], v[192:195]
    buffer_load_dwordx4 v[168:171], v2, s[40:43], s51 offen offset:2048 sc1
    v_mfma_f32_16x16x32_bf16 v[196:199], v[184:187], a[120:123], v[196:199]
    v_mfma_f32_16x16x32_bf16 v[200:203], v[184:187], a[184:187], v[200:203]
    v_mfma_f32_16x16x32_bf16 v[204:207], v[184:187], a[248:251], v[204:207]
    s_waitcnt vmcnt(13)
    v_mfma_f32_16x16x32_bf16 v[192:195], v[188:191], a[60:63], v[192:195]
    buffer_load_dwordx4 v[172:175], v2, s[40:43], s51 offen offset:3072 sc1
    v_mfma_f32_16x16x32_bf16 v[196:199], v[188:191], a[124:127], v[196:199]
    v_mfma_f32_16x16x32_bf16 v[200:203], v[188:191], a[188:191], v[200:203]
    v_mfma_f32_16x16x32_bf16 v[204:207], v[188:191], a[252:255], v[204:207]
    s_waitcnt vmcnt(25)
    s_waitcnt vmcnt(13)
    v_mfma_f32_16x16x32_bf16 v[208:211], v[128:131], a[0:3], 0
    s_add_u32 s51, s52, 339968
    buffer_load_dwordx4 v[176:179], v2, s[40:43], s51 offen offset:0 sc1
    v_mfma_f32_16x16x32_bf16 v[212:215], v[128:131], a[64:67], 0
    v_lshlrev_b32 v92, 16, v68
    v_and_b32 v93, 0xffff0000, v68
    v_mfma_f32_16x16x32_bf16 v[216:219], v[128:131], a[128:131], 0
    ds_write_b128 v89, v[196:199] offset:0
    v_mfma_f32_16x16x32_bf16 v[220:223], v[128:131], a[192:195], 0
    v_lshlrev_b32 v94, 16, v69
    s_waitcnt vmcnt(13)
    v_mfma_f32_16x16x32_bf16 v[208:211], v[132:135], a[4:7], v[208:211]
    buffer_load_dwordx4 v[180:183], v2, s[40:43], s51 offen offset:1024 sc1
    v_and_b32 v95, 0xffff0000, v69
    v_mfma_f32_16x16x32_bf16 v[212:215], v[132:135], a[68:71], v[212:215]
    v_mul_f32 v56, v56, v92
    v_mul_f32 v57, v57, v93
    v_mfma_f32_16x16x32_bf16 v[216:219], v[132:135], a[132:135], v[216:219]
    ds_write_b128 v90, v[200:203] offset:0
    v_mfma_f32_16x16x32_bf16 v[220:223], v[132:135], a[196:199], v[220:223]
    v_mul_f32 v58, v58, v94
    s_waitcnt vmcnt(11)
    v_mfma_f32_16x16x32_bf16 v[208:211], v[136:139], a[8:11], v[208:211]
    buffer_load_dwordx4 v[184:187], v2, s[40:43], s51 offen offset:2048 sc1
    v_mul_f32_e64 v59, v59, v95
    v_mfma_f32_16x16x32_bf16 v[212:215], v[136:139], a[72:75], v[212:215]
    v_cvt_pk_bf16_f32 v86, v56, v57
    v_cvt_pk_bf16_f32 v87, v58, v59
    v_mfma_f32_16x16x32_bf16 v[216:219], v[136:139], a[136:139], v[216:219]
    ds_write_b128 v91, v[204:207] offset:0
    v_mfma_f32_16x16x32_bf16 v[220:223], v[136:139], a[200:203], v[220:223]
    s_waitcnt vmcnt(11)
    v_mfma_f32_16x16x32_bf16 v[208:211], v[140:143], a[12:15], v[208:211]
    buffer_load_dwordx4 v[188:191], v2, s[40:43], s51 offen offset:3072 sc1
    v_mfma_f32_16x16x32_bf16 v[212:215], v[140:143], a[76:79], v[212:215]
    v_mfma_f32_16x16x32_bf16 v[216:219], v[140:143], a[140:143], v[216:219]
    v_mfma_f32_16x16x32_bf16 v[220:223], v[140:143], a[204:207], v[220:223]
    s_waitcnt vmcnt(11)
    v_mfma_f32_16x16x32_bf16 v[208:211], v[144:147], a[16:19], v[208:211]
    s_add_u32 s51, s52, 393216
    buffer_load_dwordx4 v[128:131], v2, s[40:43], s51 offen offset:0 sc1
    v_mfma_f32_16x16x32_bf16 v[212:215], v[144:147], a[80:83], v[212:215]
    v_mfma_f32_16x16x32_bf16 v[216:219], v[144:147], a[144:147], v[216:219]
    s_waitcnt lgkmcnt(0)
    s_barrier
    v_mfma_f32_16x16x32_bf16 v[220:223], v[144:147], a[208:211], v[220:223]
    ds_read_b128 v[32:35], v11 offset:0
    s_waitcnt vmcnt(11)
    v_mfma_f32_16x16x32_bf16 v[208:211], v[148:151], a[20:23], v[208:211]
    buffer_load_dwordx4 v[132:135], v2, s[40:43], s51 offen offset:1024 sc1
    ds_read_b128 v[36:39], v11 offset:1024
    v_mfma_f32_16x16x32_bf16 v[212:215], v[148:151], a[84:87], v[212:215]
    ds_read_b128 v[40:43], v11 offset:2048
    v_mfma_f32_16x16x32_bf16 v[216:219], v[148:151], a[148:151], v[216:219]
    v_mfma_f32_16x16x32_bf16 v[220:223], v[148:151], a[212:215], v[220:223]
    s_waitcnt vmcnt(11)
    v_mfma_f32_16x16x32_bf16 v[208:211], v[152:155], a[24:27], v[208:211]
    buffer_load_dwordx4 v[136:139], v2, s[40:43], s51 offen offset:2048 sc1
    v_mfma_f32_16x16x32_bf16 v[212:215], v[152:155], a[88:91], v[212:215]
    v_mfma_f32_16x16x32_bf16 v[216:219], v[152:155], a[152:155], v[216:219]
    s_waitcnt lgkmcnt(0)
    v_add_f32 v32, v32, v36
    v_mfma_f32_16x16x32_bf16 v[220:223], v[152:155], a[216:219], v[220:223]
    v_add_f32 v33, v33, v37
    s_waitcnt vmcnt(11)
    v_mfma_f32_16x16x32_bf16 v[208:211], v[156:159], a[28:31], v[208:211]
    buffer_load_dwordx4 v[140:143], v2, s[40:43], s51 offen offset:3072 sc1
    v_add_f32_e64 v34, v34, v38
    v_mfma_f32_16x16x32_bf16 v[212:215], v[156:159], a[92:95], v[212:215]
    v_add_f32 v35, v35, v39
    v_add_f32 v40, v40, v192
    v_mfma_f32_16x16x32_bf16 v[216:219], v[156:159], a[156:159], v[216:219]
    v_add_f32 v41, v41, v193
    v_add_f32 v42, v42, v194
    v_mfma_f32_16x16x32_bf16 v[220:223], v[156:159], a[220:223], v[220:223]
    v_add_f32 v43, v43, v195
    s_waitcnt vmcnt(11)
    v_mfma_f32_16x16x32_bf16 v[208:211], v[160:163], a[32:35], v[208:211]
    s_add_u32 s51, s52, 397312
    buffer_load_dwordx4 v[144:147], v2, s[40:43], s51 offen offset:0 sc1
    v_mfma_f32_16x16x32_bf16 v[212:215], v[160:163], a[96:99], v[212:215]
    v_add_f32 v32, v32, v9
    v_add_f32 v33, v33, v9
    v_mfma_f32_16x16x32_bf16 v[216:219], v[160:163], a[160:163], v[216:219]
    v_add_f32 v34, v34, v9
    v_add_f32 v35, v35, v9
    v_mfma_f32_16x16x32_bf16 v[220:223], v[160:163], a[224:227], v[220:223]
    v_add_f32 v32, v32, v40
    s_waitcnt vmcnt(11)
    v_mfma_f32_16x16x32_bf16 v[208:211], v[164:167], a[36:39], v[208:211]
    buffer_load_dwordx4 v[148:151], v2, s[40:43], s51 offen offset:1024 sc1
    v_add_f32_e64 v33, v33, v41
    v_mfma_f32_16x16x32_bf16 v[212:215], v[164:167], a[100:103], v[212:215]
    v_add_f32 v34, v34, v42
    v_add_f32 v35, v35, v43
    v_mfma_f32_16x16x32_bf16 v[216:219], v[164:167], a[164:167], v[216:219]
    v_lshlrev_b32_e64 v92, 16, v70
    v_and_b32 v93, 0xffff0000, v70
    v_mfma_f32_16x16x32_bf16 v[220:223], v[164:167], a[228:231], v[220:223]
    v_lshlrev_b32 v94, 16, v71
    s_waitcnt vmcnt(11)
    v_mfma_f32_16x16x32_bf16 v[208:211], v[168:171], a[40:43], v[208:211]
    buffer_load_dwordx4 v[152:155], v2, s[40:43], s51 offen offset:2048 sc1
    v_and_b32 v95, 0xffff0000, v71
    v_mfma_f32_16x16x32_bf16 v[212:215], v[168:171], a[104:107], v[212:215]
    v_mul_f32 v32, v32, v92
    v_mul_f32 v33, v33, v93
    v_mfma_f32_16x16x32_bf16 v[216:219], v[168:171], a[168:171], v[216:219]
    v_mul_f32 v34, v34, v94
    v_mul_f32 v35, v35, v95
    v_mfma_f32_16x16x32_bf16 v[220:223], v[168:171], a[232:235], v[220:223]
    v_cvt_pk_bf16_f32 v80, v32, v33
    s_waitcnt vmcnt(11)
    v_mfma_f32_16x16x32_bf16 v[208:211], v[172:175], a[44:47], v[208:211]
    buffer_load_dwordx4 v[156:159], v2, s[40:43], s51 offen offset:3072 sc1
    v_cvt_pk_bf16_f32 v81, v34, v35
    v_mfma_f32_16x16x32_bf16 v[212:215], v[172:175], a[108:111], v[212:215]
    buffer_load_dwordx4 v[244:247], v229, s[40:43], s56 offen offset:512 sc1
    s_waitcnt vmcnt(32)
    v_mfma_f32_16x16x32_bf16 v[216:219], v[172:175], a[172:175], v[216:219]
    v_mfma_f32_16x16x32_bf16 v[220:223], v[172:175], a[236:239], v[220:223]
    s_waitcnt vmcnt(12)
    v_mfma_f32_16x16x32_bf16 v[208:211], v[176:179], a[48:51], v[208:211]
    s_add_u32 s51, s52, 401408
    buffer_load_dwordx4 v[160:163], v2, s[40:43], s51 offen offset:0 sc1
    v_mfma_f32_16x16x32_bf16 v[212:215], v[176:179], a[112:115], v[212:215]
    v_mfma_f32_16x16x32_bf16 v[216:219], v[176:179], a[176:179], v[216:219]
    v_mfma_f32_16x16x32_bf16 v[220:223], v[176:179], a[240:243], v[220:223]
    s_waitcnt vmcnt(12)
    v_mfma_f32_16x16x32_bf16 v[208:211], v[180:183], a[52:55], v[208:211]
    buffer_load_dwordx4 v[164:167], v2, s[40:43], s51 offen offset:1024 sc1
    v_mfma_f32_16x16x32_bf16 v[212:215], v[180:183], a[116:119], v[212:215]
    v_mfma_f32_16x16x32_bf16 v[216:219], v[180:183], a[180:183], v[216:219]
    v_mfma_f32_16x16x32_bf16 v[220:223], v[180:183], a[244:247], v[220:223]
    s_waitcnt vmcnt(12)
    v_mfma_f32_16x16x32_bf16 v[208:211], v[184:187], a[56:59], v[208:211]
    buffer_load_dwordx4 v[168:171], v2, s[40:43], s51 offen offset:2048 sc1
    v_mfma_f32_16x16x32_bf16 v[212:215], v[184:187], a[120:123], v[212:215]
    v_mfma_f32_16x16x32_bf16 v[216:219], v[184:187], a[184:187], v[216:219]
    v_mfma_f32_16x16x32_bf16 v[220:223], v[184:187], a[248:251], v[220:223]
    s_waitcnt vmcnt(12)
    v_mfma_f32_16x16x32_bf16 v[208:211], v[188:191], a[60:63], v[208:211]
    buffer_load_dwordx4 v[172:175], v2, s[40:43], s51 offen offset:3072 sc1
    v_mfma_f32_16x16x32_bf16 v[212:215], v[188:191], a[124:127], v[212:215]
    v_mfma_f32_16x16x32_bf16 v[216:219], v[188:191], a[188:191], v[216:219]
    v_mfma_f32_16x16x32_bf16 v[220:223], v[188:191], a[252:255], v[220:223]
    s_waitcnt vmcnt(12)
    v_mfma_f32_16x16x32_bf16 v[192:195], v[128:131], a[0:3], 0
    s_add_u32 s51, s52, 405504
    buffer_load_dwordx4 v[176:179], v2, s[40:43], s51 offen offset:0 sc1
    v_mfma_f32_16x16x32_bf16 v[196:199], v[128:131], a[64:67], 0
    v_mfma_f32_16x16x32_bf16 v[200:203], v[128:131], a[128:131], 0
    ds_write_b128 v89, v[212:215] offset:12288
    v_mfma_f32_16x16x32_bf16 v[204:207], v[128:131], a[192:195], 0
    s_waitcnt vmcnt(12)
    v_mfma_f32_16x16x32_bf16 v[192:195], v[132:135], a[4:7], v[192:195]
    buffer_load_dwordx4 v[180:183], v2, s[40:43], s51 offen offset:1024 sc1
    v_mfma_f32_16x16x32_bf16 v[196:199], v[132:135], a[68:71], v[196:199]
    v_mfma_f32_16x16x32_bf16 v[200:203], v[132:135], a[132:135], v[200:203]
    ds_write_b128 v90, v[216:219] offset:12288
    v_mfma_f32_16x16x32_bf16 v[204:207], v[132:135], a[196:199], v[204:207]
    s_waitcnt vmcnt(12)
    v_mfma_f32_16x16x32_bf16 v[192:195], v[136:139], a[8:11], v[192:195]
    buffer_load_dwordx4 v[184:187], v2, s[40:43], s51 offen offset:2048 sc1
    v_mfma_f32_16x16x32_bf16 v[196:199], v[136:139], a[72:75], v[196:199]
    v_mfma_f32_16x16x32_bf16 v[200:203], v[136:139], a[136:139], v[200:203]
    ds_write_b128 v91, v[220:223] offset:12288
    v_mfma_f32_16x16x32_bf16 v[204:207], v[136:139], a[200:203], v[204:207]
    s_waitcnt vmcnt(12)
    v_mfma_f32_16x16x32_bf16 v[192:195], v[140:143], a[12:15], v[192:195]
    buffer_load_dwordx4 v[188:191], v2, s[40:43], s51 offen offset:3072 sc1
    v_mfma_f32_16x16x32_bf16 v[196:199], v[140:143], a[76:79], v[196:199]
    v_mfma_f32_16x16x32_bf16 v[200:203], v[140:143], a[140:143], v[200:203]
    v_mfma_f32_16x16x32_bf16 v[204:207], v[140:143], a[204:207], v[204:207]
    s_waitcnt vmcnt(12)
    v_mfma_f32_16x16x32_bf16 v[192:195], v[144:147], a[16:19], v[192:195]
    buffer_load_dwordx4 v15, s[32:35], s69 offen lds
    s_add_u32 m0, m0, 1024
    s_add_u32 s69, s69, 8192
    v_mfma_f32_16x16x32_bf16 v[196:199], v[144:147], a[80:83], v[196:199]
    v_mfma_f32_16x16x32_bf16 v[200:203], v[144:147], a[144:147], v[200:203]
    s_waitcnt lgkmcnt(0)
    s_barrier
    v_mfma_f32_16x16x32_bf16 v[204:207], v[144:147], a[208:211], v[204:207]
    buffer_load_dwordx4 v15, s[32:35], s69 offen lds
    s_add_u32 m0, m0, 1024
    s_add_u32 s69, s69, 8192
    s_waitcnt vmcnt(13)
    v_mfma_f32_16x16x32_bf16 v[192:195], v[148:151], a[20:23], v[192:195]
    ds_read_b128 v[32:35], v11 offset:12288
    v_mfma_f32_16x16x32_bf16 v[196:199], v[148:151], a[84:87], v[196:199]
    ds_read_b128 v[36:39], v11 offset:13312
    v_mfma_f32_16x16x32_bf16 v[200:203], v[148:151], a[148:151], v[200:203]
    buffer_load_dwordx4 v15, s[32:35], s69 offen lds
    s_add_u32 m0, m0, 1024
    s_add_u32 s69, s69, 8192
    v_mfma_f32_16x16x32_bf16 v[204:207], v[148:151], a[212:215], v[204:207]
    ds_read_b128 v[40:43], v11 offset:14336
    s_waitcnt vmcnt(13)
    v_mfma_f32_16x16x32_bf16 v[192:195], v[152:155], a[24:27], v[192:195]
    buffer_store_dwordx4 v[84:87], v2, s[40:43], s53 offen offset:1024 sc1
    v_mfma_f32_16x16x32_bf16 v[196:199], v[152:155], a[88:91], v[196:199]
    buffer_load_dwordx4 v15, s[32:35], s69 offen lds
    s_add_u32 m0, m0, 1024
    s_add_u32 s69, s69, 8192
    v_mfma_f32_16x16x32_bf16 v[200:203], v[152:155], a[152:155], v[200:203]
    s_waitcnt lgkmcnt(0)
    v_add_f32_e64 v32, v32, v36
    v_mfma_f32_16x16x32_bf16 v[204:207], v[152:155], a[216:219], v[204:207]
    v_add_f32 v33, v33, v37
    s_waitcnt vmcnt(14)
    v_mfma_f32_16x16x32_bf16 v[192:195], v[156:159], a[28:31], v[192:195]
    buffer_load_dwordx4 v15, s[32:35], s69 offen lds
    s_add_u32 m0, m0, 1024
    s_add_u32 s69, s69, 8192
    v_mfma_f32_16x16x32_bf16 v[196:199], v[156:159], a[92:95], v[196:199]
    v_add_f32 v34, v34, v38
    v_add_f32 v35, v35, v39
    v_mfma_f32_16x16x32_bf16 v[200:203], v[156:159], a[156:159], v[200:203]
    v_add_f32 v40, v40, v208
    v_add_f32 v41, v41, v209
    v_mfma_f32_16x16x32_bf16 v[204:207], v[156:159], a[220:223], v[204:207]
    buffer_load_dwordx4 v15, s[32:35], s69 offen lds
    s_add_u32 m0, m0, 9216
    s_add_u32 s69, s69, 73728
    s_waitcnt vmcnt(14)
    v_mfma_f32_16x16x32_bf16 v[192:195], v[160:163], a[32:35], v[192:195]
    v_add_f32 v42, v42, v210
    v_add_f32_e64 v43, v43, v211
    v_mfma_f32_16x16x32_bf16 v[196:199], v[160:163], a[96:99], v[196:199]
    v_add_f32 v32, v32, v9
    v_add_f32 v33, v33, v9
    v_mfma_f32_16x16x32_bf16 v[200:203], v[160:163], a[160:163], v[200:203]
    buffer_load_dwordx4 v15, s[32:35], s69 offen lds
    s_add_u32 m0, m0, 1024
    s_add_u32 s69, s69, 8192
    v_mfma_f32_16x16x32_bf16 v[204:207], v[160:163], a[224:227], v[204:207]
    v_add_f32 v34, v34, v9
    s_waitcnt vmcnt(14)
    v_mfma_f32_16x16x32_bf16 v[192:195], v[164:167], a[36:39], v[192:195]
    v_add_f32 v35, v35, v9
    v_add_f32 v32, v32, v40
    v_mfma_f32_16x16x32_bf16 v[196:199], v[164:167], a[100:103], v[196:199]
    buffer_load_dwordx4 v15, s[32:35], s69 offen lds
    s_add_u32 m0, m0, 1024
    s_add_u32 s69, s69, 8192
    v_mfma_f32_16x16x32_bf16 v[200:203], v[164:167], a[164:167], v[200:203]
    v_add_f32 v33, v33, v41
    v_add_f32 v34, v34, v42
    v_mfma_f32_16x16x32_bf16 v[204:207], v[164:167], a[228:231], v[204:207]
    v_add_f32 v35, v35, v43
    s_waitcnt vmcnt(14)
    v_mfma_f32_16x16x32_bf16 v[192:195], v[168:171], a[40:43], v[192:195]
    buffer_load_dwordx4 v15, s[32:35], s69 offen lds
    s_add_u32 m0, m0, 1024
    s_add_u32 s69, s69, 8192
    v_mfma_f32_16x16x32_bf16 v[196:199], v[168:171], a[104:107], v[196:199]
    v_lshlrev_b32_e64 v92, 16, v72
    v_and_b32 v93, 0xffff0000, v72
    v_mfma_f32_16x16x32_bf16 v[200:203], v[168:171], a[168:171], v[200:203]
    v_lshlrev_b32_e64 v94, 16, v73
    v_and_b32 v95, 0xffff0000, v73
    v_mfma_f32_16x16x32_bf16 v[204:207], v[168:171], a[232:235], v[204:207]
    buffer_load_dwordx4 v15, s[32:35], s69 offen lds
    s_add_u32 m0, m0, 1024
    s_add_u32 s69, s69, 8192
    s_waitcnt vmcnt(15)
    v_mfma_f32_16x16x32_bf16 v[192:195], v[172:175], a[44:47], v[192:195]
    v_mul_f32 v32, v32, v92
    v_mul_f32_e64 v33, v33, v93
    v_mfma_f32_16x16x32_bf16 v[196:199], v[172:175], a[108:111], v[196:199]
    v_mul_f32 v34, v34, v94
    v_mul_f32 v35, v35, v95
    v_mfma_f32_16x16x32_bf16 v[200:203], v[172:175], a[172:175], v[200:203]
    buffer_load_dwordx4 v15, s[32:35], s69 offen lds
    s_add_u32 m0, m0, 1024
    s_add_u32 s69, s69, 8192
    v_mfma_f32_16x16x32_bf16 v[204:207], v[172:175], a[236:239], v[204:207]
    v_cvt_pk_bf16_f32 v82, v32, v33
    s_waitcnt vmcnt(15)
    v_mfma_f32_16x16x32_bf16 v[192:195], v[176:179], a[48:51], v[192:195]
    v_cvt_pk_bf16_f32 v83, v34, v35
    v_mfma_f32_16x16x32_bf16 v[196:199], v[176:179], a[112:115], v[196:199]
    buffer_load_dwordx4 v15, s[32:35], s69 offen lds
    v_mfma_f32_16x16x32_bf16 v[200:203], v[176:179], a[176:179], v[200:203]
    buffer_store_dwordx4 v[80:83], v2, s[40:43], s53 offen offset:2048 sc1
    v_mfma_f32_16x16x32_bf16 v[204:207], v[176:179], a[240:243], v[204:207]
    s_waitcnt vmcnt(16)
    v_mfma_f32_16x16x32_bf16 v[192:195], v[180:183], a[52:55], v[192:195]
    v_mfma_f32_16x16x32_bf16 v[196:199], v[180:183], a[116:119], v[196:199]
    v_mfma_f32_16x16x32_bf16 v[200:203], v[180:183], a[180:183], v[200:203]
    v_mfma_f32_16x16x32_bf16 v[204:207], v[180:183], a[244:247], v[204:207]
    s_waitcnt vmcnt(15)
    v_mfma_f32_16x16x32_bf16 v[192:195], v[184:187], a[56:59], v[192:195]
    v_mfma_f32_16x16x32_bf16 v[196:199], v[184:187], a[120:123], v[196:199]
    v_mfma_f32_16x16x32_bf16 v[200:203], v[184:187], a[184:187], v[200:203]
    v_mfma_f32_16x16x32_bf16 v[204:207], v[184:187], a[248:251], v[204:207]
    s_waitcnt vmcnt(14)
    v_mfma_f32_16x16x32_bf16 v[192:195], v[188:191], a[60:63], v[192:195]
    v_mfma_f32_16x16x32_bf16 v[196:199], v[188:191], a[124:127], v[196:199]
    v_mfma_f32_16x16x32_bf16 v[200:203], v[188:191], a[188:191], v[200:203]
    v_mfma_f32_16x16x32_bf16 v[204:207], v[188:191], a[252:255], v[204:207]
    s_nop 5
    ds_write_b128 v89, v[196:199] offset:0
    ds_write_b128 v90, v[200:203] offset:0
    ds_write_b128 v91, v[204:207] offset:0
    s_waitcnt lgkmcnt(0)
    s_barrier
    ds_read_b128 v[32:35], v11 offset:0
    ds_read_b128 v[36:39], v11 offset:1024
    ds_read_b128 v[40:43], v11 offset:2048
    s_waitcnt lgkmcnt(0)
    v_add_f32 v32, v32, v36
    v_add_f32 v33, v33, v37
    v_add_f32 v34, v34, v38
    v_add_f32 v35, v35, v39
    v_add_f32 v40, v40, v192
    v_add_f32 v41, v41, v193
    v_add_f32 v42, v42, v194
    v_add_f32 v43, v43, v195
    v_add_f32 v32, v32, v9
    v_add_f32 v33, v33, v9
    v_add_f32 v34, v34, v9
    v_add_f32 v35, v35, v9
    v_add_f32 v32, v32, v40
    v_add_f32 v33, v33, v41
    v_add_f32 v34, v34, v42
    v_add_f32 v35, v35, v43
    v_lshlrev_b32_e64 v92, 16, v74
    v_and_b32 v93, 0xffff0000, v74
    v_lshlrev_b32_e64 v94, 16, v75
    v_and_b32 v95, 0xffff0000, v75
    v_mul_f32 v32, v32, v92
    v_mul_f32 v33, v33, v93
    v_mul_f32 v34, v34, v94
    v_mul_f32 v35, v35, v95
    v_cvt_pk_bf16_f32 v84, v32, v33
    v_cvt_pk_bf16_f32 v85, v34, v35
    buffer_store_dwordx2 v[84:85], v12, s[40:43], s53 offen offset:3072 sc1
    s_add_u32 s49, s55, 0
    buffer_load_dwordx4 v[16:19], v2, s[40:43], s49 offen sc1
    s_add_u32 s49, s55, 3584
    buffer_load_dwordx4 v[20:23], v2, s[40:43], s49 offen sc1
    s_add_u32 s49, s55, 7168
    buffer_load_dwordx4 v[24:27], v2, s[40:43], s49 offen sc1
    s_add_u32 s49, s55, 10752
    buffer_load_dwordx4 v[28:31], v2, s[40:43], s49 offen sc1
    s_add_u32 s49, s55, 14336
    buffer_load_dwordx4 v[32:35], v2, s[40:43], s49 offen sc1
    s_add_u32 s49, s55, 17920
    buffer_load_dwordx4 v[36:39], v2, s[40:43], s49 offen sc1
    s_add_u32 s49, s55, 21504
    buffer_load_dwordx4 v[40:43], v2, s[40:43], s49 offen sc1
    s_add_u32 s49, s55, 25088
    buffer_load_dwordx4 v[44:47], v2, s[40:43], s49 offen sc1
    s_add_u32 s49, s55, 1024
    buffer_load_dwordx4 v[48:51], v2, s[40:43], s49 offen sc1
    s_add_u32 s49, s55, 4608
    buffer_load_dwordx4 v[52:55], v2, s[40:43], s49 offen sc1
    s_add_u32 s49, s55, 8192
    buffer_load_dwordx4 v[56:59], v2, s[40:43], s49 offen sc1
    s_add_u32 s49, s55, 11776
    buffer_load_dwordx4 v[60:63], v2, s[40:43], s49 offen sc1
    ds_read_b64_tr_b16 a[64:65], v224 offset:0
    ds_read_b64_tr_b16 a[66:67], v224 offset:2048
    ds_read_b64_tr_b16 a[68:69], v225 offset:0
    ds_read_b64_tr_b16 a[70:71], v225 offset:2048
    ds_read_b64_tr_b16 a[72:73], v226 offset:0
    ds_read_b64_tr_b16 a[74:75], v226 offset:2048
    ds_read_b64_tr_b16 a[76:77], v227 offset:0
    ds_read_b64_tr_b16 a[78:79], v227 offset:2048
    ds_read_b64_tr_b16 a[112:113], v224 offset:14336
    ds_read_b64_tr_b16 a[114:115], v224 offset:16384
    ds_read_b64_tr_b16 a[116:117], v225 offset:14336
    ds_read_b64_tr_b16 a[118:119], v225 offset:16384
    ds_read_b64_tr_b16 a[120:121], v226 offset:14336
    ds_read_b64_tr_b16 a[122:123], v226 offset:16384
    ds_read_b64_tr_b16 a[124:125], v227 offset:14336
    ds_read_b64_tr_b16 a[126:127], v227 offset:16384
    ds_read_b64_tr_b16 a[80:81], v224 offset:4096
    ds_read_b64_tr_b16 a[82:83], v224 offset:6144
    ds_read_b64_tr_b16 a[84:85], v225 offset:4096
    ds_read_b64_tr_b16 a[86:87], v225 offset:6144
    ds_read_b64_tr_b16 a[88:89], v226 offset:4096
    ds_read_b64_tr_b16 a[90:91], v226 offset:6144
    ds_read_b64_tr_b16 a[92:93], v227 offset:4096
    ds_read_b64_tr_b16 a[94:95], v227 offset:6144
    ds_read_b64_tr_b16 a[128:129], v224 offset:18432
    ds_read_b64_tr_b16 a[130:131], v224 offset:20480
    ds_read_b64_tr_b16 a[132:133], v225 offset:18432
    ds_read_b64_tr_b16 a[134:135], v225 offset:20480
    ds_read_b64_tr_b16 a[136:137], v226 offset:18432
    ds_read_b64_tr_b16 a[138:139], v226 offset:20480
    ds_read_b64_tr_b16 a[140:141], v227 offset:18432
    ds_read_b64_tr_b16 a[142:143], v227 offset:20480
    s_waitcnt vmcnt(11)
    v_max_u32 v248, v17, v19
    v_cmp_eq_u32 vcc, -1, v248
    s_nop 0
    s_cbranch_vccnz L_slow_24
L_back_25:
    s_waitcnt lgkmcnt(15)
    v_mfma_f32_16x16x32_bf16 a[0:3], a[64:67], v[16:19], 0
    s_add_u32 s49, s55, 15360
    buffer_load_dwordx4 v[64:67], v2, s[40:43], s49 offen sc1
    s_waitcnt vmcnt(15)
    v_mfma_f32_16x16x32_bf16 a[4:7], a[68:71], v[16:19], 0
    ds_read_b64_tr_b16 a[96:97], v224 offset:8192
    s_waitcnt vmcnt(11)
    v_max_u32 v248, v21, v23
    v_mfma_f32_16x16x32_bf16 a[8:11], a[72:75], v[16:19], 0
    ds_read_b64_tr_b16 a[98:99], v224 offset:10240
    v_cmp_eq_u32_e64 vcc, -1, v248
    v_mfma_f32_16x16x32_bf16 a[12:15], a[76:79], v[16:19], 0
    ds_read_b64_tr_b16 a[100:101], v225 offset:8192
    s_cbranch_vccnz L_slow_26
L_back_27:
    v_mfma_f32_16x16x32_bf16 a[16:19], a[64:67], v[20:23], 0
    s_add_u32 s49, s55, 18944
    buffer_load_dwordx4 v[68:71], v2, s[40:43], s49 offen sc1
    ds_read_b64_tr_b16 a[102:103], v225 offset:10240
    v_mfma_f32_16x16x32_bf16 a[20:23], a[68:71], v[20:23], 0
    ds_read_b64_tr_b16 a[104:105], v226 offset:8192
    s_waitcnt vmcnt(11)
    v_max_u32_e64 v248, v25, v27
    v_mfma_f32_16x16x32_bf16 a[24:27], a[72:75], v[20:23], 0
    ds_read_b64_tr_b16 a[106:107], v226 offset:10240
    v_cmp_eq_u32_e64 vcc, -1, v248
    v_mfma_f32_16x16x32_bf16 a[28:31], a[76:79], v[20:23], 0
    ds_read_b64_tr_b16 a[108:109], v227 offset:8192
    s_cbranch_vccnz L_slow_28
L_back_29:
    v_mfma_f32_16x16x32_bf16 a[32:35], a[64:67], v[24:27], 0
    s_add_u32 s49, s55, 22528
    buffer_load_dwordx4 v[72:75], v2, s[40:43], s49 offen sc1
    ds_read_b64_tr_b16 a[110:111], v227 offset:10240
    v_mfma_f32_16x16x32_bf16 a[36:39], a[68:71], v[24:27], 0
    ds_read_b64_tr_b16 a[144:145], v224 offset:22528
    s_waitcnt vmcnt(11)
    v_max_u32_e64 v248, v29, v31
    v_mfma_f32_16x16x32_bf16 a[40:43], a[72:75], v[24:27], 0
    ds_read_b64_tr_b16 a[146:147], v224 offset:24576
    v_cmp_eq_u32_e64 vcc, -1, v248
    v_mfma_f32_16x16x32_bf16 a[44:47], a[76:79], v[24:27], 0
    ds_read_b64_tr_b16 a[148:149], v225 offset:22528
    s_cbranch_vccnz L_slow_30
L_back_31:
    v_mfma_f32_16x16x32_bf16 a[48:51], a[64:67], v[28:31], 0
    s_add_u32 s49, s55, 26112
    buffer_load_dwordx4 v[76:79], v2, s[40:43], s49 offen sc1
    ds_read_b64_tr_b16 a[150:151], v225 offset:24576
    v_mfma_f32_16x16x32_bf16 a[52:55], a[68:71], v[28:31], 0
    ds_read_b64_tr_b16 a[152:153], v226 offset:22528
    s_waitcnt vmcnt(11)
    v_max_u32_e64 v248, v33, v35
    v_mfma_f32_16x16x32_bf16 a[56:59], a[72:75], v[28:31], 0
    ds_read_b64_tr_b16 a[154:155], v226 offset:24576
    v_cmp_eq_u32_e64 vcc, -1, v248
    v_mfma_f32_16x16x32_bf16 a[60:63], a[76:79], v[28:31], 0
    ds_read_b64_tr_b16 a[156:157], v227 offset:22528
    s_cbranch_vccnz L_slow_32
L_back_33:
    s_waitcnt lgkmcnt(15)
    v_mfma_f32_16x16x32_bf16 a[0:3], a[112:115], v[32:35], a[0:3]
    s_add_u32 s49, s55, 2048
    buffer_load_dwordx4 v[80:83], v2, s[40:43], s49 offen sc1
    ds_read_b64_tr_b16 a[158:159], v227 offset:24576
    v_mfma_f32_16x16x32_bf16 a[4:7], a[116:119], v[32:35], a[4:7]
    ds_read_b64_tr_b16 a[160:161], v224 offset:12288
    s_waitcnt vmcnt(11)
    v_max_u32 v248, v37, v39
    v_mfma_f32_16x16x32_bf16 a[8:11], a[120:123], v[32:35], a[8:11]
    ds_read_b64_tr_b16 a[162:163], v224 offset:26624
    v_cmp_eq_u32_e64 vcc, -1, v248
    v_mfma_f32_16x16x32_bf16 a[12:15], a[124:127], v[32:35], a[12:15]
    ds_read_b64_tr_b16 a[164:165], v225 offset:12288
    s_cbranch_vccnz L_slow_34
L_back_35:
    v_mfma_f32_16x16x32_bf16 a[16:19], a[112:115], v[36:39], a[16:19]
    s_add_u32 s49, s55, 16384
    buffer_load_dwordx4 v[84:87], v2, s[40:43], s49 offen sc1
    ds_read_b64_tr_b16 a[166:167], v225 offset:26624
    v_mfma_f32_16x16x32_bf16 a[20:23], a[116:119], v[36:39], a[20:23]
    ds_read_b64_tr_b16 a[168:169], v226 offset:12288
    s_waitcnt vmcnt(11)
    v_max_u32_e64 v248, v41, v43
    v_mfma_f32_16x16x32_bf16 a[24:27], a[120:123], v[36:39], a[24:27]
    ds_read_b64_tr_b16 a[170:171], v226 offset:26624
    v_cmp_eq_u32_e64 vcc, -1, v248
    v_mfma_f32_16x16x32_bf16 a[28:31], a[124:127], v[36:39], a[28:31]
    ds_read_b64_tr_b16 a[172:173], v227 offset:12288
    s_cbranch_vccnz L_slow_36
L_back_37:
    v_mfma_f32_16x16x32_bf16 a[32:35], a[112:115], v[40:43], a[32:35]
    s_add_u32 s49, s55, 0
    buffer_load_dwordx2 v[88:89], v12, s[40:43], s49 offen offset:3072 sc1
    s_add_u32 s49, s55, 14336
    buffer_load_dwordx2 v[90:91], v12, s[40:43], s49 offen offset:3072 sc1
    v_mfma_f32_16x16x32_bf16 a[36:39], a[116:119], v[40:43], a[36:39]
    ds_read_b64_tr_b16 a[174:175], v227 offset:26624
    s_waitcnt vmcnt(12)
    v_max_u32 v248, v45, v47
    v_mfma_f32_16x16x32_bf16 a[40:43], a[120:123], v[40:43], a[40:43]
    v_cmp_eq_u32_e64 vcc, -1, v248
    v_mfma_f32_16x16x32_bf16 a[44:47], a[124:127], v[40:43], a[44:47]
    s_cbranch_vccnz L_slow_38
L_back_39:
    v_mfma_f32_16x16x32_bf16 a[48:51], a[112:115], v[44:47], a[48:51]
    s_add_u32 s49, s55, 5632
    buffer_load_dwordx4 v[92:95], v2, s[40:43], s49 offen sc1
    v_mfma_f32_16x16x32_bf16 a[52:55], a[116:119], v[44:47], a[52:55]
    s_waitcnt vmcnt(12)
    v_max_u32_e64 v248, v49, v51
    v_mfma_f32_16x16x32_bf16 a[56:59], a[120:123], v[44:47], a[56:59]
    v_cmp_eq_u32_e64 vcc, -1, v248
    v_mfma_f32_16x16x32_bf16 a[60:63], a[124:127], v[44:47], a[60:63]
    s_cbranch_vccnz L_slow_40
L_back_41:
    s_waitcnt lgkmcnt(15)
    v_mfma_f32_16x16x32_bf16 a[0:3], a[80:83], v[48:51], a[0:3]
    s_add_u32 s49, s55, 19968
    buffer_load_dwordx4 v[96:99], v2, s[40:43], s49 offen sc1
    v_mfma_f32_16x16x32_bf16 a[4:7], a[84:87], v[48:51], a[4:7]
    s_waitcnt vmcnt(12)
    v_max_u32 v248, v53, v55
    v_mfma_f32_16x16x32_bf16 a[8:11], a[88:91], v[48:51], a[8:11]
    v_cmp_eq_u32_e64 vcc, -1, v248
    v_mfma_f32_16x16x32_bf16 a[12:15], a[92:95], v[48:51], a[12:15]
    s_cbranch_vccnz L_slow_42
L_back_43:
    v_mfma_f32_16x16x32_bf16 a[16:19], a[80:83], v[52:55], a[16:19]
    s_add_u32 s49, s55, 3584
    buffer_load_dwordx2 v[100:101], v12, s[40:43], s49 offen offset:3072 sc1
    s_add_u32 s49, s55, 17920
    buffer_load_dwordx2 v[102:103], v12, s[40:43], s49 offen offset:3072 sc1
    v_mfma_f32_16x16x32_bf16 a[20:23], a[84:87], v[52:55], a[20:23]
    s_waitcnt vmcnt(13)
    v_max_u32_e64 v248, v57, v59
    v_mfma_f32_16x16x32_bf16 a[24:27], a[88:91], v[52:55], a[24:27]
    v_cmp_eq_u32_e64 vcc, -1, v248
    v_mfma_f32_16x16x32_bf16 a[28:31], a[92:95], v[52:55], a[28:31]
    s_cbranch_vccnz L_slow_44
L_back_45:
    v_mfma_f32_16x16x32_bf16 a[32:35], a[80:83], v[56:59], a[32:35]
    s_add_u32 s49, s55, 9216
    buffer_load_dwordx4 v[104:107], v2, s[40:43], s49 offen sc1
    v_mfma_f32_16x16x32_bf16 a[36:39], a[84:87], v[56:59], a[36:39]
    s_waitcnt vmcnt(13)
    v_max_u32_e64 v248, v61, v63
    v_mfma_f32_16x16x32_bf16 a[40:43], a[88:91], v[56:59], a[40:43]
    v_cmp_eq_u32_e64 vcc, -1, v248
    v_mfma_f32_16x16x32_bf16 a[44:47], a[92:95], v[56:59], a[44:47]
    s_cbranch_vccnz L_slow_46
L_back_47:
    v_mfma_f32_16x16x32_bf16 a[48:51], a[80:83], v[60:63], a[48:51]
    s_add_u32 s49, s55, 23552
    buffer_load_dwordx4 v[108:111], v2, s[40:43], s49 offen sc1
    v_mfma_f32_16x16x32_bf16 a[52:55], a[84:87], v[60:63], a[52:55]
    s_waitcnt vmcnt(13)
    v_max_u32_e64 v248, v65, v67
    v_mfma_f32_16x16x32_bf16 a[56:59], a[88:91], v[60:63], a[56:59]
    v_cmp_eq_u32_e64 vcc, -1, v248
    v_mfma_f32_16x16x32_bf16 a[60:63], a[92:95], v[60:63], a[60:63]
    s_cbranch_vccnz L_slow_48
L_back_49:
    s_waitcnt lgkmcnt(15)
    v_mfma_f32_16x16x32_bf16 a[0:3], a[128:131], v[64:67], a[0:3]
    s_add_u32 s49, s55, 7168
    buffer_load_dwordx2 v[112:113], v12, s[40:43], s49 offen offset:3072 sc1
    s_add_u32 s49, s55, 21504
    buffer_load_dwordx2 v[114:115], v12, s[40:43], s49 offen offset:3072 sc1
    v_mfma_f32_16x16x32_bf16 a[4:7], a[132:135], v[64:67], a[4:7]
    s_waitcnt vmcnt(14)
    v_max_u32 v248, v69, v71
    v_mfma_f32_16x16x32_bf16 a[8:11], a[136:139], v[64:67], a[8:11]
    v_cmp_eq_u32_e64 vcc, -1, v248
    v_mfma_f32_16x16x32_bf16 a[12:15], a[140:143], v[64:67], a[12:15]
    s_cbranch_vccnz L_slow_50
L_back_51:
    v_mfma_f32_16x16x32_bf16 a[16:19], a[128:131], v[68:71], a[16:19]
    s_add_u32 s49, s55, 12800
    buffer_load_dwordx4 v[116:119], v2, s[40:43], s49 offen sc1
    v_mfma_f32_16x16x32_bf16 a[20:23], a[132:135], v[68:71], a[20:23]
    s_waitcnt vmcnt(14)
    v_max_u32_e64 v248, v73, v75
    v_mfma_f32_16x16x32_bf16 a[24:27], a[136:139], v[68:71], a[24:27]
    v_cmp_eq_u32_e64 vcc, -1, v248
    v_mfma_f32_16x16x32_bf16 a[28:31], a[140:143], v[68:71], a[28:31]
    s_cbranch_vccnz L_slow_52
L_back_53:
    v_mfma_f32_16x16x32_bf16 a[32:35], a[128:131], v[72:75], a[32:35]
    s_add_u32 s49, s55, 27136
    buffer_load_dwordx4 v[120:123], v2, s[40:43], s49 offen sc1
    v_mfma_f32_16x16x32_bf16 a[36:39], a[132:135], v[72:75], a[36:39]
    s_waitcnt vmcnt(14)
    v_max_u32_e64 v248, v77, v79
    v_mfma_f32_16x16x32_bf16 a[40:43], a[136:139], v[72:75], a[40:43]
    v_cmp_eq_u32_e64 vcc, -1, v248
    v_mfma_f32_16x16x32_bf16 a[44:47], a[140:143], v[72:75], a[44:47]
    s_cbranch_vccnz L_slow_54
L_back_55:
    v_mfma_f32_16x16x32_bf16 a[48:51], a[128:131], v[76:79], a[48:51]
    s_add_u32 s49, s55, 10752
    buffer_load_dwordx2 v[124:125], v12, s[40:43], s49 offen offset:3072 sc1
    s_add_u32 s49, s55, 25088
    buffer_load_dwordx2 v[126:127], v12, s[40:43], s49 offen offset:3072 sc1
    v_mfma_f32_16x16x32_bf16 a[52:55], a[132:135], v[76:79], a[52:55]
    s_waitcnt vmcnt(15)
    v_max_u32_e64 v248, v81, v83
    v_mfma_f32_16x16x32_bf16 a[56:59], a[136:139], v[76:79], a[56:59]
    v_cmp_eq_u32_e64 vcc, -1, v248
    v_mfma_f32_16x16x32_bf16 a[60:63], a[140:143], v[76:79], a[60:63]
    s_cbranch_vccnz L_slow_56
L_back_57:
    s_waitcnt lgkmcnt(15)
    v_mfma_f32_16x16x32_bf16 a[0:3], a[96:99], v[80:83], a[0:3]
    v_mfma_f32_16x16x32_bf16 a[4:7], a[100:103], v[80:83], a[4:7]
    s_waitcnt vmcnt(14)
    v_max_u32 v248, v85, v87
    v_mfma_f32_16x16x32_bf16 a[8:11], a[104:107], v[80:83], a[8:11]
    v_cmp_eq_u32_e64 vcc, -1, v248
    v_mfma_f32_16x16x32_bf16 a[12:15], a[108:111], v[80:83], a[12:15]
    s_cbranch_vccnz L_slow_58
L_back_59:
    s_waitcnt lgkmcnt(8)
    v_mfma_f32_16x16x32_bf16 a[0:3], a[144:147], v[84:87], a[0:3]
    s_waitcnt lgkmcnt(0)
    s_barrier
    v_mfma_f32_16x16x32_bf16 a[4:7], a[148:151], v[84:87], a[4:7]
    s_waitcnt vmcnt(12)
    v_max_u32 v248, v89, v91
    v_mfma_f32_16x16x32_bf16 a[8:11], a[152:155], v[84:87], a[8:11]
    v_cmp_eq_u32_e64 vcc, -1, v248
    v_mfma_f32_16x16x32_bf16 a[12:15], a[156:159], v[84:87], a[12:15]
    s_cbranch_vccnz L_slow_60
L_back_61:
    s_waitcnt lgkmcnt(0)
    v_mfma_f32_16x16x32_bf16 a[0:3], a[160:163], v[88:91], a[0:3]
    v_mfma_f32_16x16x32_bf16 a[4:7], a[164:167], v[88:91], a[4:7]
    s_waitcnt vmcnt(11)
    v_max_u32 v248, v93, v95
    v_mfma_f32_16x16x32_bf16 a[8:11], a[168:171], v[88:91], a[8:11]
    v_cmp_eq_u32_e64 vcc, -1, v248
    v_mfma_f32_16x16x32_bf16 a[12:15], a[172:175], v[88:91], a[12:15]
    s_cbranch_vccnz L_slow_62
L_back_63:
    v_mfma_f32_16x16x32_bf16 a[16:19], a[96:99], v[92:95], a[16:19]
    v_mfma_f32_16x16x32_bf16 a[20:23], a[100:103], v[92:95], a[20:23]
    s_waitcnt vmcnt(10)
    v_max_u32_e64 v248, v97, v99
    v_mfma_f32_16x16x32_bf16 a[24:27], a[104:107], v[92:95], a[24:27]
    ds_write_b128 v230, a[0:3] offset:0
    v_cmp_eq_u32_e64 vcc, -1, v248
    v_mfma_f32_16x16x32_bf16 a[28:31], a[108:111], v[92:95], a[28:31]
    s_cbranch_vccnz L_slow_64
L_back_65:
    v_mfma_f32_16x16x32_bf16 a[16:19], a[144:147], v[96:99], a[16:19]
    ds_write_b128 v230, a[4:7] offset:64
    v_mfma_f32_16x16x32_bf16 a[20:23], a[148:151], v[96:99], a[20:23]
    s_waitcnt vmcnt(8)
    v_max_u32_e64 v248, v101, v103
    v_mfma_f32_16x16x32_bf16 a[24:27], a[152:155], v[96:99], a[24:27]
    ds_write_b128 v230, a[8:11] offset:128
    v_cmp_eq_u32_e64 vcc, -1, v248
    v_mfma_f32_16x16x32_bf16 a[28:31], a[156:159], v[96:99], a[28:31]
    s_cbranch_vccnz L_slow_66
L_back_67:
    v_mfma_f32_16x16x32_bf16 a[16:19], a[160:163], v[100:103], a[16:19]
    ds_write_b128 v230, a[12:15] offset:192
    v_mfma_f32_16x16x32_bf16 a[20:23], a[164:167], v[100:103], a[20:23]
    s_waitcnt vmcnt(7)
    v_max_u32_e64 v248, v105, v107
    v_mfma_f32_16x16x32_bf16 a[24:27], a[168:171], v[100:103], a[24:27]
    v_cmp_eq_u32_e64 vcc, -1, v248
    v_mfma_f32_16x16x32_bf16 a[28:31], a[172:175], v[100:103], a[28:31]
    s_cbranch_vccnz L_slow_68
L_back_69:
    v_mfma_f32_16x16x32_bf16 a[32:35], a[96:99], v[104:107], a[32:35]
    v_mfma_f32_16x16x32_bf16 a[36:39], a[100:103], v[104:107], a[36:39]
    s_waitcnt vmcnt(6)
    v_max_u32_e64 v248, v109, v111
    v_mfma_f32_16x16x32_bf16 a[40:43], a[104:107], v[104:107], a[40:43]
    ds_write_b128 v230, a[16:19] offset:17408
    v_cmp_eq_u32_e64 vcc, -1, v248
    v_mfma_f32_16x16x32_bf16 a[44:47], a[108:111], v[104:107], a[44:47]
    s_cbranch_vccnz L_slow_70
L_back_71:
    v_mfma_f32_16x16x32_bf16 a[32:35], a[144:147], v[108:111], a[32:35]
    ds_write_b128 v230, a[20:23] offset:17472
    v_mfma_f32_16x16x32_bf16 a[36:39], a[148:151], v[108:111], a[36:39]
    s_waitcnt vmcnt(4)
    v_max_u32_e64 v248, v113, v115
    v_mfma_f32_16x16x32_bf16 a[40:43], a[152:155], v[108:111], a[40:43]
    ds_write_b128 v230, a[24:27] offset:17536
    v_cmp_eq_u32_e64 vcc, -1, v248
    v_mfma_f32_16x16x32_bf16 a[44:47], a[156:159], v[108:111], a[44:47]
    s_cbranch_vccnz L_slow_72
L_back_73:
    v_mfma_f32_16x16x32_bf16 a[32:35], a[160:163], v[112:115], a[32:35]
    ds_write_b128 v230, a[28:31] offset:17600
    v_mfma_f32_16x16x32_bf16 a[36:39], a[164:167], v[112:115], a[36:39]
    s_waitcnt vmcnt(3)
    v_max_u32_e64 v248, v117, v119
    v_mfma_f32_16x16x32_bf16 a[40:43], a[168:171], v[112:115], a[40:43]
    v_cmp_eq_u32_e64 vcc, -1, v248
    v_mfma_f32_16x16x32_bf16 a[44:47], a[172:175], v[112:115], a[44:47]
    s_cbranch_vccnz L_slow_74
L_back_75:
    v_mfma_f32_16x16x32_bf16 a[48:51], a[96:99], v[116:119], a[48:51]
    v_mfma_f32_16x16x32_bf16 a[52:55], a[100:103], v[116:119], a[52:55]
    s_waitcnt vmcnt(2)
    v_max_u32_e64 v248, v121, v123
    v_mfma_f32_16x16x32_bf16 a[56:59], a[104:107], v[116:119], a[56:59]
    ds_write_b128 v230, a[32:35] offset:34816
    v_cmp_eq_u32_e64 vcc, -1, v248
    v_mfma_f32_16x16x32_bf16 a[60:63], a[108:111], v[116:119], a[60:63]
    s_cbranch_vccnz L_slow_76
L_back_77:
    v_mfma_f32_16x16x32_bf16 a[48:51], a[144:147], v[120:123], a[48:51]
    ds_write_b128 v230, a[36:39] offset:34880
    v_mfma_f32_16x16x32_bf16 a[52:55], a[148:151], v[120:123], a[52:55]
    s_waitcnt vmcnt(0)
    v_max_u32_e64 v248, v125, v127
    v_mfma_f32_16x16x32_bf16 a[56:59], a[152:155], v[120:123], a[56:59]
    ds_write_b128 v230, a[40:43] offset:34944
    v_cmp_eq_u32_e64 vcc, -1, v248
    v_mfma_f32_16x16x32_bf16 a[60:63], a[156:159], v[120:123], a[60:63]
    s_cbranch_vccnz L_slow_78
L_back_79:
    v_mfma_f32_16x16x32_bf16 a[48:51], a[160:163], v[124:127], a[48:51]
    ds_write_b128 v230, a[44:47] offset:35008
    v_mfma_f32_16x16x32_bf16 a[52:55], a[164:167], v[124:127], a[52:55]
    v_mfma_f32_16x16x32_bf16 a[56:59], a[168:171], v[124:127], a[56:59]
    v_mfma_f32_16x16x32_bf16 a[60:63], a[172:175], v[124:127], a[60:63]
    s_nop 3
    ds_write_b128 v230, a[48:51] offset:52224
    s_nop 0
    ds_write_b128 v230, a[52:55] offset:52288
    ds_write_b128 v230, a[56:59] offset:52352
    ds_write_b128 v230, a[60:63] offset:52416
    s_waitcnt lgkmcnt(0)
    s_barrier
    ds_read_b128 v[16:19], v231 offset:0
    ds_read_b128 v[20:23], v231 offset:16
    ds_read_b128 v[24:27], v231 offset:4352
    ds_read_b128 v[28:31], v231 offset:4368
    ds_read_b128 v[32:35], v231 offset:8704
    ds_read_b128 v[36:39], v231 offset:8720
    ds_read_b128 v[40:43], v231 offset:13056
    ds_read_b128 v[44:47], v231 offset:13072
    ds_read_b128 v[48:51], v231 offset:2176
    ds_read_b128 v[52:55], v231 offset:2192
    ds_read_b128 v[56:59], v231 offset:6528
    ds_read_b128 v[60:63], v231 offset:6544
    ds_read_b128 v[64:67], v231 offset:10880
    ds_read_b128 v[68:71], v231 offset:10896
    ds_read_b128 v[72:75], v231 offset:15232
    ds_read_b128 v[76:79], v231 offset:15248
    s_add_u32 s48, s57, 8192
    v_lshlrev_b32 v248, 16, v240
    v_and_b32 v249, 0xffff0000, v240
    v_lshlrev_b32_e64 v250, 16, v241
    v_and_b32 v251, 0xffff0000, v241
    v_lshlrev_b32_e64 v252, 16, v242
    v_and_b32 v253, 0xffff0000, v242
    v_lshlrev_b32_e64 v254, 16, v243
    v_and_b32 v255, 0xffff0000, v243
    s_waitcnt lgkmcnt(8)
    v_pk_add_f32 v[16:17], v[16:17], v[24:25]
    v_pk_add_f32 v[32:33], v[32:33], v[40:41]
    v_pk_add_f32 v[18:19], v[18:19], v[26:27]
    v_pk_add_f32 v[34:35], v[34:35], v[42:43]
    v_pk_add_f32 v[20:21], v[20:21], v[28:29]
    v_pk_add_f32 v[36:37], v[36:37], v[44:45]
    v_pk_add_f32 v[22:23], v[22:23], v[30:31]
    v_pk_add_f32 v[38:39], v[38:39], v[46:47]
    v_pk_add_f32 v[16:17], v[16:17], v[32:33]
    v_pk_add_f32 v[18:19], v[18:19], v[34:35]
    v_pk_add_f32 v[20:21], v[20:21], v[36:37]
    v_pk_add_f32 v[22:23], v[22:23], v[38:39]
    v_pk_add_f32 v[16:17], v[16:17], v[248:249]
    v_pk_add_f32 v[18:19], v[18:19], v[250:251]
    v_pk_add_f32 v[20:21], v[20:21], v[252:253]
    v_pk_add_f32 v[22:23], v[22:23], v[254:255]
    v_cvt_pk_bf16_f32 v24, v16, v17
    v_cvt_pk_bf16_f32 v25, v18, v19
    v_cvt_pk_bf16_f32 v26, v20, v21
    v_cvt_pk_bf16_f32 v27, v22, v23
    buffer_store_dwordx4 v[24:27], v232, s[36:39], s57 offen
    v_lshlrev_b32 v248, 16, v244
    v_and_b32 v249, 0xffff0000, v244
    v_lshlrev_b32_e64 v250, 16, v245
    v_and_b32 v251, 0xffff0000, v245
    v_lshlrev_b32_e64 v252, 16, v246
    v_and_b32 v253, 0xffff0000, v246
    v_lshlrev_b32_e64 v254, 16, v247
    v_and_b32 v255, 0xffff0000, v247
    s_waitcnt lgkmcnt(0)
    v_pk_add_f32 v[48:49], v[48:49], v[56:57]
    v_pk_add_f32 v[64:65], v[64:65], v[72:73]
    v_pk_add_f32 v[50:51], v[50:51], v[58:59]
    v_pk_add_f32 v[66:67], v[66:67], v[74:75]
    v_pk_add_f32 v[52:53], v[52:53], v[60:61]
    v_pk_add_f32 v[68:69], v[68:69], v[76:77]
    v_pk_add_f32 v[54:55], v[54:55], v[62:63]
    v_pk_add_f32 v[70:71], v[70:71], v[78:79]
    v_pk_add_f32 v[48:49], v[48:49], v[64:65]
    v_pk_add_f32 v[50:51], v[50:51], v[66:67]
    v_pk_add_f32 v[52:53], v[52:53], v[68:69]
    v_pk_add_f32 v[54:55], v[54:55], v[70:71]
    v_pk_add_f32 v[48:49], v[48:49], v[248:249]
    v_pk_add_f32 v[50:51], v[50:51], v[250:251]
    v_pk_add_f32 v[52:53], v[52:53], v[252:253]
    v_pk_add_f32 v[54:55], v[54:55], v[254:255]
    v_cvt_pk_bf16_f32 v56, v48, v49
    v_cvt_pk_bf16_f32 v57, v50, v51
    v_cvt_pk_bf16_f32 v58, v52, v53
    v_cvt_pk_bf16_f32 v59, v54, v55
    buffer_store_dwordx4 v[56:59], v232, s[36:39], s48 offen
    s_nop 1
L_end:
    s_endpgm
L_slow_3:
    s_nop 11
    s_mov_b32 s48, 0
L_poll_80:
    buffer_load_dword v6, v244, s[40:43], 0 offen sc1
    s_add_u32 s48, s48, 1
    s_cmp_ge_u32 s48, 65536
    s_cbranch_scc1 L_pdone_81
    s_waitcnt vmcnt(0)
    v_cmp_ne_u32 vcc, s45, v6
    s_nop 0
    s_and_b64 exec, exec, vcc
    s_nop 2
    s_cbranch_scc1 L_poll_80
L_pdone_81:
    s_mov_b64 exec, -1
    s_waitcnt vmcnt(0)
    s_branch L_back_4
L_slow_5:
    s_nop 11
    s_mov_b32 s48, 0
L_poll_82:
    buffer_load_dword v6, v95, s[40:43], 0 offen sc1
    s_add_u32 s48, s48, 1
    s_cmp_ge_u32 s48, 65536
    s_cbranch_scc1 L_pdone_83
    s_waitcnt vmcnt(0)
    v_cmp_ne_u32 vcc, s45, v6
    s_nop 0
    s_and_b64 exec, exec, vcc
    s_nop 2
    s_cbranch_scc1 L_poll_82
L_pdone_83:
    s_mov_b64 exec, -1
    s_waitcnt vmcnt(0)
    s_branch L_back_6
L_slow_12:
    s_nop 11
    s_mov_b32 s48, 0
L_sp_84:
    s_add_u32 s49, s12, 0
    buffer_load_dwordx4 v[96:99], v24, s[40:43], s49 offen sc1
    s_add_u32 s49, s12, 4096
    buffer_load_dwordx4 v[100:103], v24, s[40:43], s49 offen sc1
    s_add_u32 s49, s12, 8192
    buffer_load_dwordx4 v[104:107], v24, s[40:43], s49 offen sc1
    s_add_u32 s49, s12, 12288
    buffer_load_dwordx4 v[108:111], v24, s[40:43], s49 offen sc1
    s_add_u32 s49, s12, 16384
    buffer_load_dwordx4 v[16:19], v24, s[40:43], s49 offen sc1
    s_add_u32 s49, s12, 20480
    buffer_load_dwordx4 v[20:23], v24, s[40:43], s49 offen sc1
    s_add_u32 s49, s12, 24576
    buffer_load_dwordx4 a[248:251], v24, s[40:43], s49 offen sc1
    s_add_u32 s49, s12, 28672
    buffer_load_dwordx4 a[252:255], v24, s[40:43], s49 offen sc1
    s_add_u32 s48, s48, 1
    s_cmp_ge_u32 s48, 65536
    s_waitcnt vmcnt(0)
    s_cbranch_scc1 L_spd_85
    v_accvgpr_read_b32 v36, a248
    v_accvgpr_read_b32 v37, a249
    v_accvgpr_read_b32 v38, a250
    v_accvgpr_read_b32 v39, a251
    v_accvgpr_read_b32 v40, a252
    v_accvgpr_read_b32 v41, a253
    v_accvgpr_read_b32 v42, a254
    v_accvgpr_read_b32 v43, a255
    v_min_u32 v32, v97, v99
    v_max_u32_e64 v33, v97, v99
    v_min3_u32 v32, v32, v101, v103
    v_max3_u32 v33, v33, v101, v103
    v_min3_u32 v32, v32, v105, v107
    v_max3_u32 v33, v33, v105, v107
    v_min3_u32 v32, v32, v109, v111
    v_max3_u32 v33, v33, v109, v111
    v_min3_u32 v32, v32, v17, v19
    v_max3_u32 v33, v33, v17, v19
    v_min3_u32 v32, v32, v21, v23
    v_max3_u32 v33, v33, v21, v23
    v_min3_u32 v32, v32, v37, v39
    v_max3_u32 v33, v33, v37, v39
    v_min3_u32 v32, v32, v41, v43
    v_max3_u32 v33, v33, v41, v43
    v_cmp_ne_u32_e64 vcc, s45, v32
    v_cmp_ne_u32 s[62:63], s45, v33
    s_nop 0
    s_or_b64 vcc, vcc, s[62:63]
    s_nop 2
    s_cbranch_vccnz L_sp_84
L_spd_85:
    s_branch L_back_13
L_slow_17:
    s_nop 11
    s_mov_b32 s48, 0
L_sp_86:
    s_add_u32 s49, s12, 0
    buffer_load_dwordx4 v[96:99], v24, s[40:43], s49 offen sc1
    s_add_u32 s49, s12, 4096
    buffer_load_dwordx4 v[100:103], v24, s[40:43], s49 offen sc1
    s_add_u32 s49, s12, 8192
    buffer_load_dwordx4 v[104:107], v24, s[40:43], s49 offen sc1
    s_add_u32 s49, s12, 12288
    buffer_load_dwordx4 v[108:111], v24, s[40:43], s49 offen sc1
    s_add_u32 s49, s12, 16384
    buffer_load_dwordx4 v[16:19], v24, s[40:43], s49 offen sc1
    s_add_u32 s49, s12, 20480
    buffer_load_dwordx4 v[20:23], v24, s[40:43], s49 offen sc1
    s_add_u32 s49, s12, 24576
    buffer_load_dwordx4 a[248:251], v24, s[40:43], s49 offen sc1
    s_add_u32 s49, s12, 28672
    buffer_load_dwordx4 a[252:255], v24, s[40:43], s49 offen sc1
    s_add_u32 s48, s48, 1
    s_cmp_ge_u32 s48, 65536
    s_waitcnt vmcnt(0)
    s_cbranch_scc1 L_spd_87
    v_accvgpr_read_b32 v36, a248
    v_accvgpr_read_b32 v37, a249
    v_accvgpr_read_b32 v38, a250
    v_accvgpr_read_b32 v39, a251
    v_accvgpr_read_b32 v40, a252
    v_accvgpr_read_b32 v41, a253
    v_accvgpr_read_b32 v42, a254
    v_accvgpr_read_b32 v43, a255
    v_min_u32 v32, v97, v99
    v_max_u32_e64 v33, v97, v99
    v_min3_u32 v32, v32, v101, v103
    v_max3_u32 v33, v33, v101, v103
    v_min3_u32 v32, v32, v105, v107
    v_max3_u32 v33, v33, v105, v107
    v_min3_u32 v32, v32, v109, v111
    v_max3_u32 v33, v33, v109, v111
    v_min3_u32 v32, v32, v17, v19
    v_max3_u32 v33, v33, v17, v19
    v_min3_u32 v32, v32, v21, v23
    v_max3_u32 v33, v33, v21, v23
    v_min3_u32 v32, v32, v37, v39
    v_max3_u32 v33, v33, v37, v39
    v_min3_u32 v32, v32, v41, v43
    v_max3_u32 v33, v33, v41, v43
    v_cmp_ne_u32_e64 vcc, s45, v32
    v_cmp_ne_u32 s[62:63], s45, v33
    s_nop 0
    s_or_b64 vcc, vcc, s[62:63]
    s_nop 2
    s_cbranch_vccnz L_sp_86
L_spd_87:
    s_branch L_back_18
L_slow_22:
    s_nop 11
    s_mov_b32 s48, 0
L_poll_88:
    buffer_load_dword v6, v13, s[40:43], 0 offen sc1
    s_add_u32 s48, s48, 1
    s_cmp_ge_u32 s48, 65536
    s_cbranch_scc1 L_pdone_89
    s_waitcnt vmcnt(0)
    v_cmp_ne_u32 vcc, s45, v6
    s_nop 0
    s_and_b64 exec, exec, vcc
    s_nop 2
    s_cbranch_scc1 L_poll_88
L_pdone_89:
    s_mov_b64 exec, -1
    s_waitcnt vmcnt(0)
    s_branch L_back_23
L_slow_24:
    s_nop 11
    s_mov_b32 s48, 0
L_re_90:
    s_add_u32 s49, s55, 0
    buffer_load_dwordx4 v[16:19], v2, s[40:43], s49 offen sc1
    s_add_u32 s49, s55, 3584
    buffer_load_dwordx4 v[20:23], v2, s[40:43], s49 offen sc1
    s_add_u32 s49, s55, 7168
    buffer_load_dwordx4 v[24:27], v2, s[40:43], s49 offen sc1
    s_add_u32 s49, s55, 10752
    buffer_load_dwordx4 v[28:31], v2, s[40:43], s49 offen sc1
    s_add_u32 s49, s55, 14336
    buffer_load_dwordx4 v[32:35], v2, s[40:43], s49 offen sc1
    s_add_u32 s49, s55, 17920
    buffer_load_dwordx4 v[36:39], v2, s[40:43], s49 offen sc1
    s_add_u32 s49, s55, 21504
    buffer_load_dwordx4 v[40:43], v2, s[40:43], s49 offen sc1
    s_add_u32 s49, s55, 25088
    buffer_load_dwordx4 v[44:47], v2, s[40:43], s49 offen sc1
    s_add_u32 s49, s55, 1024
    buffer_load_dwordx4 v[48:51], v2, s[40:43], s49 offen sc1
    s_add_u32 s49, s55, 4608
    buffer_load_dwordx4 v[52:55], v2, s[40:43], s49 offen sc1
    s_add_u32 s49, s55, 8192
    buffer_load_dwordx4 v[56:59], v2, s[40:43], s49 offen sc1
    s_add_u32 s49, s55, 11776
    buffer_load_dwordx4 v[60:63], v2, s[40:43], s49 offen sc1
    s_add_u32 s48, s48, 1
    s_cmp_ge_u32 s48, 65536
    s_waitcnt vmcnt(0)
    s_cbranch_scc1 L_ok_91
    v_max_u32 v248, v17, v19
    v_cmp_eq_u32 vcc, -1, v248
    s_nop 0
    s_nop 3
    s_cbranch_vccnz L_re_90
L_ok_91:
    s_branch L_back_25
L_slow_26:
    s_nop 11
    s_mov_b32 s48, 0
L_re_92:
    s_add_u32 s49, s55, 3584
    buffer_load_dwordx4 v[20:23], v2, s[40:43], s49 offen sc1
    s_add_u32 s49, s55, 7168
    buffer_load_dwordx4 v[24:27], v2, s[40:43], s49 offen sc1
    s_add_u32 s49, s55, 10752
    buffer_load_dwordx4 v[28:31], v2, s[40:43], s49 offen sc1
    s_add_u32 s49, s55, 14336
    buffer_load_dwordx4 v[32:35], v2, s[40:43], s49 offen sc1
    s_add_u32 s49, s55, 17920
    buffer_load_dwordx4 v[36:39], v2, s[40:43], s49 offen sc1
    s_add_u32 s49, s55, 21504
    buffer_load_dwordx4 v[40:43], v2, s[40:43], s49 offen sc1
    s_add_u32 s49, s55, 25088
    buffer_load_dwordx4 v[44:47], v2, s[40:43], s49 offen sc1
    s_add_u32 s49, s55, 1024
    buffer_load_dwordx4 v[48:51], v2, s[40:43], s49 offen sc1
    s_add_u32 s49, s55, 4608
    buffer_load_dwordx4 v[52:55], v2, s[40:43], s49 offen sc1
    s_add_u32 s49, s55, 8192
    buffer_load_dwordx4 v[56:59], v2, s[40:43], s49 offen sc1
    s_add_u32 s49, s55, 11776
    buffer_load_dwordx4 v[60:63], v2, s[40:43], s49 offen sc1
    s_add_u32 s49, s55, 15360
    buffer_load_dwordx4 v[64:67], v2, s[40:43], s49 offen sc1
    s_add_u32 s48, s48, 1
    s_cmp_ge_u32 s48, 65536
    s_waitcnt vmcnt(0)
    s_cbranch_scc1 L_ok_93
    v_max_u32 v248, v21, v23
    v_cmp_eq_u32 vcc, -1, v248
    s_nop 0
    s_nop 3
    s_cbranch_vccnz L_re_92
L_ok_93:
    s_branch L_back_27
L_slow_28:
    s_nop 11
    s_mov_b32 s48, 0
L_re_94:
    s_add_u32 s49, s55, 7168
    buffer_load_dwordx4 v[24:27], v2, s[40:43], s49 offen sc1
    s_add_u32 s49, s55, 10752
    buffer_load_dwordx4 v[28:31], v2, s[40:43], s49 offen sc1
    s_add_u32 s49, s55, 14336
    buffer_load_dwordx4 v[32:35], v2, s[40:43], s49 offen sc1
    s_add_u32 s49, s55, 17920
    buffer_load_dwordx4 v[36:39], v2, s[40:43], s49 offen sc1
    s_add_u32 s49, s55, 21504
    buffer_load_dwordx4 v[40:43], v2, s[40:43], s49 offen sc1
    s_add_u32 s49, s55, 25088
    buffer_load_dwordx4 v[44:47], v2, s[40:43], s49 offen sc1
    s_add_u32 s49, s55, 1024
    buffer_load_dwordx4 v[48:51], v2, s[40:43], s49 offen sc1
    s_add_u32 s49, s55, 4608
    buffer_load_dwordx4 v[52:55], v2, s[40:43], s49 offen sc1
    s_add_u32 s49, s55, 8192
    buffer_load_dwordx4 v[56:59], v2, s[40:43], s49 offen sc1
    s_add_u32 s49, s55, 11776
    buffer_load_dwordx4 v[60:63], v2, s[40:43], s49 offen sc1
    s_add_u32 s49, s55, 15360
    buffer_load_dwordx4 v[64:67], v2, s[40:43], s49 offen sc1
    s_add_u32 s49, s55, 18944
    buffer_load_dwordx4 v[68:71], v2, s[40:43], s49 offen sc1
    s_add_u32 s48, s48, 1
    s_cmp_ge_u32 s48, 65536
    s_waitcnt vmcnt(0)
    s_cbranch_scc1 L_ok_95
    v_max_u32 v248, v25, v27
    v_cmp_eq_u32 vcc, -1, v248
    s_nop 0
    s_nop 3
    s_cbranch_vccnz L_re_94
L_ok_95:
    s_branch L_back_29
L_slow_30:
    s_nop 11
    s_mov_b32 s48, 0
L_re_96:
    s_add_u32 s49, s55, 10752
    buffer_load_dwordx4 v[28:31], v2, s[40:43], s49 offen sc1
    s_add_u32 s49, s55, 14336
    buffer_load_dwordx4 v[32:35], v2, s[40:43], s49 offen sc1
    s_add_u32 s49, s55, 17920
    buffer_load_dwordx4 v[36:39], v2, s[40:43], s49 offen sc1
    s_add_u32 s49, s55, 21504
    buffer_load_dwordx4 v[40:43], v2, s[40:43], s49 offen sc1
    s_add_u32 s49, s55, 25088
    buffer_load_dwordx4 v[44:47], v2, s[40:43], s49 offen sc1
    s_add_u32 s49, s55, 1024
    buffer_load_dwordx4 v[48:51], v2, s[40:43], s49 offen sc1
    s_add_u32 s49, s55, 4608
    buffer_load_dwordx4 v[52:55], v2, s[40:43], s49 offen sc1
    s_add_u32 s49, s55, 8192
    buffer_load_dwordx4 v[56:59], v2, s[40:43], s49 offen sc1
    s_add_u32 s49, s55, 11776
    buffer_load_dwordx4 v[60:63], v2, s[40:43], s49 offen sc1
    s_add_u32 s49, s55, 15360
    buffer_load_dwordx4 v[64:67], v2, s[40:43], s49 offen sc1
    s_add_u32 s49, s55, 18944
    buffer_load_dwordx4 v[68:71], v2, s[40:43], s49 offen sc1
    s_add_u32 s49, s55, 22528
    buffer_load_dwordx4 v[72:75], v2, s[40:43], s49 offen sc1
    s_add_u32 s48, s48, 1
    s_cmp_ge_u32 s48, 65536
    s_waitcnt vmcnt(0)
    s_cbranch_scc1 L_ok_97
    v_max_u32 v248, v29, v31
    v_cmp_eq_u32 vcc, -1, v248
    s_nop 0
    s_nop 3
    s_cbranch_vccnz L_re_96
L_ok_97:
    s_branch L_back_31
L_slow_32:
    s_nop 11
    s_mov_b32 s48, 0
L_re_98:
    s_add_u32 s49, s55, 14336
    buffer_load_dwordx4 v[32:35], v2, s[40:43], s49 offen sc1
    s_add_u32 s49, s55, 17920
    buffer_load_dwordx4 v[36:39], v2, s[40:43], s49 offen sc1
    s_add_u32 s49, s55, 21504
    buffer_load_dwordx4 v[40:43], v2, s[40:43], s49 offen sc1
    s_add_u32 s49, s55, 25088
    buffer_load_dwordx4 v[44:47], v2, s[40:43], s49 offen sc1
    s_add_u32 s49, s55, 1024
    buffer_load_dwordx4 v[48:51], v2, s[40:43], s49 offen sc1
    s_add_u32 s49, s55, 4608
    buffer_load_dwordx4 v[52:55], v2, s[40:43], s49 offen sc1
    s_add_u32 s49, s55, 8192
    buffer_load_dwordx4 v[56:59], v2, s[40:43], s49 offen sc1
    s_add_u32 s49, s55, 11776
    buffer_load_dwordx4 v[60:63], v2, s[40:43], s49 offen sc1
    s_add_u32 s49, s55, 15360
    buffer_load_dwordx4 v[64:67], v2, s[40:43], s49 offen sc1
    s_add_u32 s49, s55, 18944
    buffer_load_dwordx4 v[68:71], v2, s[40:43], s49 offen sc1
    s_add_u32 s49, s55, 22528
    buffer_load_dwordx4 v[72:75], v2, s[40:43], s49 offen sc1
    s_add_u32 s49, s55, 26112
    buffer_load_dwordx4 v[76:79], v2, s[40:43], s49 offen sc1
    s_add_u32 s48, s48, 1
    s_cmp_ge_u32 s48, 65536
    s_waitcnt vmcnt(0)
    s_cbranch_scc1 L_ok_99
    v_max_u32 v248, v33, v35
    v_cmp_eq_u32 vcc, -1, v248
    s_nop 0
    s_nop 3
    s_cbranch_vccnz L_re_98
L_ok_99:
    s_branch L_back_33
L_slow_34:
    s_nop 11
    s_mov_b32 s48, 0
L_re_100:
    s_add_u32 s49, s55, 17920
    buffer_load_dwordx4 v[36:39], v2, s[40:43], s49 offen sc1
    s_add_u32 s49, s55, 21504
    buffer_load_dwordx4 v[40:43], v2, s[40:43], s49 offen sc1
    s_add_u32 s49, s55, 25088
    buffer_load_dwordx4 v[44:47], v2, s[40:43], s49 offen sc1
    s_add_u32 s49, s55, 1024
    buffer_load_dwordx4 v[48:51], v2, s[40:43], s49 offen sc1
    s_add_u32 s49, s55, 4608
    buffer_load_dwordx4 v[52:55], v2, s[40:43], s49 offen sc1
    s_add_u32 s49, s55, 8192
    buffer_load_dwordx4 v[56:59], v2, s[40:43], s49 offen sc1
    s_add_u32 s49, s55, 11776
    buffer_load_dwordx4 v[60:63], v2, s[40:43], s49 offen sc1
    s_add_u32 s49, s55, 15360
    buffer_load_dwordx4 v[64:67], v2, s[40:43], s49 offen sc1
    s_add_u32 s49, s55, 18944
    buffer_load_dwordx4 v[68:71], v2, s[40:43], s49 offen sc1
    s_add_u32 s49, s55, 22528
    buffer_load_dwordx4 v[72:75], v2, s[40:43], s49 offen sc1
    s_add_u32 s49, s55, 26112
    buffer_load_dwordx4 v[76:79], v2, s[40:43], s49 offen sc1
    s_add_u32 s49, s55, 2048
    buffer_load_dwordx4 v[80:83], v2, s[40:43], s49 offen sc1
    s_add_u32 s48, s48, 1
    s_cmp_ge_u32 s48, 65536
    s_waitcnt vmcnt(0)
    s_cbranch_scc1 L_ok_101
    v_max_u32 v248, v37, v39
    v_cmp_eq_u32 vcc, -1, v248
    s_nop 0
    s_nop 3
    s_cbranch_vccnz L_re_100
L_ok_101:
    s_branch L_back_35
L_slow_36:
    s_nop 11
    s_mov_b32 s48, 0
L_re_102:
    s_add_u32 s49, s55, 21504
    buffer_load_dwordx4 v[40:43], v2, s[40:43], s49 offen sc1
    s_add_u32 s49, s55, 25088
    buffer_load_dwordx4 v[44:47], v2, s[40:43], s49 offen sc1
    s_add_u32 s49, s55, 1024
    buffer_load_dwordx4 v[48:51], v2, s[40:43], s49 offen sc1
    s_add_u32 s49, s55, 4608
    buffer_load_dwordx4 v[52:55], v2, s[40:43], s49 offen sc1
    s_add_u32 s49, s55, 8192
    buffer_load_dwordx4 v[56:59], v2, s[40:43], s49 offen sc1
    s_add_u32 s49, s55, 11776
    buffer_load_dwordx4 v[60:63], v2, s[40:43], s49 offen sc1
    s_add_u32 s49, s55, 15360
    buffer_load_dwordx4 v[64:67], v2, s[40:43], s49 offen sc1
    s_add_u32 s49, s55, 18944
    buffer_load_dwordx4 v[68:71], v2, s[40:43], s49 offen sc1
    s_add_u32 s49, s55, 22528
    buffer_load_dwordx4 v[72:75], v2, s[40:43], s49 offen sc1
    s_add_u32 s49, s55, 26112
    buffer_load_dwordx4 v[76:79], v2, s[40:43], s49 offen sc1
    s_add_u32 s49, s55, 2048
    buffer_load_dwordx4 v[80:83], v2, s[40:43], s49 offen sc1
    s_add_u32 s49, s55, 16384
    buffer_load_dwordx4 v[84:87], v2, s[40:43], s49 offen sc1
    s_add_u32 s48, s48, 1
    s_cmp_ge_u32 s48, 65536
    s_waitcnt vmcnt(0)
    s_cbranch_scc1 L_ok_103
    v_max_u32 v248, v41, v43
    v_cmp_eq_u32 vcc, -1, v248
    s_nop 0
    s_nop 3
    s_cbranch_vccnz L_re_102
L_ok_103:
    s_branch L_back_37
L_slow_38:
    s_nop 11
    s_mov_b32 s48, 0
L_re_104:
    s_add_u32 s49, s55, 25088
    buffer_load_dwordx4 v[44:47], v2, s[40:43], s49 offen sc1
    s_add_u32 s49, s55, 1024
    buffer_load_dwordx4 v[48:51], v2, s[40:43], s49 offen sc1
    s_add_u32 s49, s55, 4608
    buffer_load_dwordx4 v[52:55], v2, s[40:43], s49 offen sc1
    s_add_u32 s49, s55, 8192
    buffer_load_dwordx4 v[56:59], v2, s[40:43], s49 offen sc1
    s_add_u32 s49, s55, 11776
    buffer_load_dwordx4 v[60:63], v2, s[40:43], s49 offen sc1
    s_add_u32 s49, s55, 15360
    buffer_load_dwordx4 v[64:67], v2, s[40:43], s49 offen sc1
    s_add_u32 s49, s55, 18944
    buffer_load_dwordx4 v[68:71], v2, s[40:43], s49 offen sc1
    s_add_u32 s49, s55, 22528
    buffer_load_dwordx4 v[72:75], v2, s[40:43], s49 offen sc1
    s_add_u32 s49, s55, 26112
    buffer_load_dwordx4 v[76:79], v2, s[40:43], s49 offen sc1
    s_add_u32 s49, s55, 2048
    buffer_load_dwordx4 v[80:83], v2, s[40:43], s49 offen sc1
    s_add_u32 s49, s55, 16384
    buffer_load_dwordx4 v[84:87], v2, s[40:43], s49 offen sc1
    s_add_u32 s49, s55, 0
    buffer_load_dwordx2 v[88:89], v12, s[40:43], s49 offen offset:3072 sc1
    s_add_u32 s49, s55, 14336
    buffer_load_dwordx2 v[90:91], v12, s[40:43], s49 offen offset:3072 sc1
    s_add_u32 s48, s48, 1
    s_cmp_ge_u32 s48, 65536
    s_waitcnt vmcnt(0)
    s_cbranch_scc1 L_ok_105
    v_max_u32 v248, v45, v47
    v_cmp_eq_u32 vcc, -1, v248
    s_nop 0
    s_nop 3
    s_cbranch_vccnz L_re_104
L_ok_105:
    s_branch L_back_39
L_slow_40:
    s_nop 11
    s_mov_b32 s48, 0
L_re_106:
    s_add_u32 s49, s55, 1024
    buffer_load_dwordx4 v[48:51], v2, s[40:43], s49 offen sc1
    s_add_u32 s49, s55, 4608
    buffer_load_dwordx4 v[52:55], v2, s[40:43], s49 offen sc1
    s_add_u32 s49, s55, 8192
    buffer_load_dwordx4 v[56:59], v2, s[40:43], s49 offen sc1
    s_add_u32 s49, s55, 11776
    buffer_load_dwordx4 v[60:63], v2, s[40:43], s49 offen sc1
    s_add_u32 s49, s55, 15360
    buffer_load_dwordx4 v[64:67], v2, s[40:43], s49 offen sc1
    s_add_u32 s49, s55, 18944
    buffer_load_dwordx4 v[68:71], v2, s[40:43], s49 offen sc1
    s_add_u32 s49, s55, 22528
    buffer_load_dwordx4 v[72:75], v2, s[40:43], s49 offen sc1
    s_add_u32 s49, s55, 26112
    buffer_load_dwordx4 v[76:79], v2, s[40:43], s49 offen sc1
    s_add_u32 s49, s55, 2048
    buffer_load_dwordx4 v[80:83], v2, s[40:43], s49 offen sc1
    s_add_u32 s49, s55, 16384
    buffer_load_dwordx4 v[84:87], v2, s[40:43], s49 offen sc1
    s_add_u32 s49, s55, 0
    buffer_load_dwordx2 v[88:89], v12, s[40:43], s49 offen offset:3072 sc1
    s_add_u32 s49, s55, 14336
    buffer_load_dwordx2 v[90:91], v12, s[40:43], s49 offen offset:3072 sc1
    s_add_u32 s49, s55, 5632
    buffer_load_dwordx4 v[92:95], v2, s[40:43], s49 offen sc1
    s_add_u32 s48, s48, 1
    s_cmp_ge_u32 s48, 65536
    s_waitcnt vmcnt(0)
    s_cbranch_scc1 L_ok_107
    v_max_u32 v248, v49, v51
    v_cmp_eq_u32 vcc, -1, v248
    s_nop 0
    s_nop 3
    s_cbranch_vccnz L_re_106
L_ok_107:
    s_branch L_back_41
L_slow_42:
    s_nop 11
    s_mov_b32 s48, 0
L_re_108:
    s_add_u32 s49, s55, 4608
    buffer_load_dwordx4 v[52:55], v2, s[40:43], s49 offen sc1
    s_add_u32 s49, s55, 8192
    buffer_load_dwordx4 v[56:59], v2, s[40:43], s49 offen sc1
    s_add_u32 s49, s55, 11776
    buffer_load_dwordx4 v[60:63], v2, s[40:43], s49 offen sc1
    s_add_u32 s49, s55, 15360
    buffer_load_dwordx4 v[64:67], v2, s[40:43], s49 offen sc1
    s_add_u32 s49, s55, 18944
    buffer_load_dwordx4 v[68:71], v2, s[40:43], s49 offen sc1
    s_add_u32 s49, s55, 22528
    buffer_load_dwordx4 v[72:75], v2, s[40:43], s49 offen sc1
    s_add_u32 s49, s55, 26112
    buffer_load_dwordx4 v[76:79], v2, s[40:43], s49 offen sc1
    s_add_u32 s49, s55, 2048
    buffer_load_dwordx4 v[80:83], v2, s[40:43], s49 offen sc1
    s_add_u32 s49, s55, 16384
    buffer_load_dwordx4 v[84:87], v2, s[40:43], s49 offen sc1
    s_add_u32 s49, s55, 0
    buffer_load_dwordx2 v[88:89], v12, s[40:43], s49 offen offset:3072 sc1
    s_add_u32 s49, s55, 14336
    buffer_load_dwordx2 v[90:91], v12, s[40:43], s49 offen offset:3072 sc1
    s_add_u32 s49, s55, 5632
    buffer_load_dwordx4 v[92:95], v2, s[40:43], s49 offen sc1
    s_add_u32 s49, s55, 19968
    buffer_load_dwordx4 v[96:99], v2, s[40:43], s49 offen sc1
    s_add_u32 s48, s48, 1
    s_cmp_ge_u32 s48, 65536
    s_waitcnt vmcnt(0)
    s_cbranch_scc1 L_ok_109
    v_max_u32 v248, v53, v55
    v_cmp_eq_u32 vcc, -1, v248
    s_nop 0
    s_nop 3
    s_cbranch_vccnz L_re_108
L_ok_109:
    s_branch L_back_43
L_slow_44:
    s_nop 11
    s_mov_b32 s48, 0
L_re_110:
    s_add_u32 s49, s55, 8192
    buffer_load_dwordx4 v[56:59], v2, s[40:43], s49 offen sc1
    s_add_u32 s49, s55, 11776
    buffer_load_dwordx4 v[60:63], v2, s[40:43], s49 offen sc1
    s_add_u32 s49, s55, 15360
    buffer_load_dwordx4 v[64:67], v2, s[40:43], s49 offen sc1
    s_add_u32 s49, s55, 18944
    buffer_load_dwordx4 v[68:71], v2, s[40:43], s49 offen sc1
    s_add_u32 s49, s55, 22528
    buffer_load_dwordx4 v[72:75], v2, s[40:43], s49 offen sc1
    s_add_u32 s49, s55, 26112
    buffer_load_dwordx4 v[76:79], v2, s[40:43], s49 offen sc1
    s_add_u32 s49, s55, 2048
    buffer_load_dwordx4 v[80:83], v2, s[40:43], s49 offen sc1
    s_add_u32 s49, s55, 16384
    buffer_load_dwordx4 v[84:87], v2, s[40:43], s49 offen sc1
    s_add_u32 s49, s55, 0
    buffer_load_dwordx2 v[88:89], v12, s[40:43], s49 offen offset:3072 sc1
    s_add_u32 s49, s55, 14336
    buffer_load_dwordx2 v[90:91], v12, s[40:43], s49 offen offset:3072 sc1
    s_add_u32 s49, s55, 5632
    buffer_load_dwordx4 v[92:95], v2, s[40:43], s49 offen sc1
    s_add_u32 s49, s55, 19968
    buffer_load_dwordx4 v[96:99], v2, s[40:43], s49 offen sc1
    s_add_u32 s49, s55, 3584
    buffer_load_dwordx2 v[100:101], v12, s[40:43], s49 offen offset:3072 sc1
    s_add_u32 s49, s55, 17920
    buffer_load_dwordx2 v[102:103], v12, s[40:43], s49 offen offset:3072 sc1
    s_add_u32 s48, s48, 1
    s_cmp_ge_u32 s48, 65536
    s_waitcnt vmcnt(0)
    s_cbranch_scc1 L_ok_111
    v_max_u32 v248, v57, v59
    v_cmp_eq_u32 vcc, -1, v248
    s_nop 0
    s_nop 3
    s_cbranch_vccnz L_re_110
L_ok_111:
    s_branch L_back_45
L_slow_46:
    s_nop 11
    s_mov_b32 s48, 0
L_re_112:
    s_add_u32 s49, s55, 11776
    buffer_load_dwordx4 v[60:63], v2, s[40:43], s49 offen sc1
    s_add_u32 s49, s55, 15360
    buffer_load_dwordx4 v[64:67], v2, s[40:43], s49 offen sc1
    s_add_u32 s49, s55, 18944
    buffer_load_dwordx4 v[68:71], v2, s[40:43], s49 offen sc1
    s_add_u32 s49, s55, 22528
    buffer_load_dwordx4 v[72:75], v2, s[40:43], s49 offen sc1
    s_add_u32 s49, s55, 26112
    buffer_load_dwordx4 v[76:79], v2, s[40:43], s49 offen sc1
    s_add_u32 s49, s55, 2048
    buffer_load_dwordx4 v[80:83], v2, s[40:43], s49 offen sc1
    s_add_u32 s49, s55, 16384
    buffer_load_dwordx4 v[84:87], v2, s[40:43], s49 offen sc1
    s_add_u32 s49, s55, 0
    buffer_load_dwordx2 v[88:89], v12, s[40:43], s49 offen offset:3072 sc1
    s_add_u32 s49, s55, 14336
    buffer_load_dwordx2 v[90:91], v12, s[40:43], s49 offen offset:3072 sc1
    s_add_u32 s49, s55, 5632
    buffer_load_dwordx4 v[92:95], v2, s[40:43], s49 offen sc1
    s_add_u32 s49, s55, 19968
    buffer_load_dwordx4 v[96:99], v2, s[40:43], s49 offen sc1
    s_add_u32 s49, s55, 3584
    buffer_load_dwordx2 v[100:101], v12, s[40:43], s49 offen offset:3072 sc1
    s_add_u32 s49, s55, 17920
    buffer_load_dwordx2 v[102:103], v12, s[40:43], s49 offen offset:3072 sc1
    s_add_u32 s49, s55, 9216
    buffer_load_dwordx4 v[104:107], v2, s[40:43], s49 offen sc1
    s_add_u32 s48, s48, 1
    s_cmp_ge_u32 s48, 65536
    s_waitcnt vmcnt(0)
    s_cbranch_scc1 L_ok_113
    v_max_u32 v248, v61, v63
    v_cmp_eq_u32 vcc, -1, v248
    s_nop 0
    s_nop 3
    s_cbranch_vccnz L_re_112
L_ok_113:
    s_branch L_back_47
L_slow_48:
    s_nop 11
    s_mov_b32 s48, 0
L_re_114:
    s_add_u32 s49, s55, 15360
    buffer_load_dwordx4 v[64:67], v2, s[40:43], s49 offen sc1
    s_add_u32 s49, s55, 18944
    buffer_load_dwordx4 v[68:71], v2, s[40:43], s49 offen sc1
    s_add_u32 s49, s55, 22528
    buffer_load_dwordx4 v[72:75], v2, s[40:43], s49 offen sc1
    s_add_u32 s49, s55, 26112
    buffer_load_dwordx4 v[76:79], v2, s[40:43], s49 offen sc1
    s_add_u32 s49, s55, 2048
    buffer_load_dwordx4 v[80:83], v2, s[40:43], s49 offen sc1
    s_add_u32 s49, s55, 16384
    buffer_load_dwordx4 v[84:87], v2, s[40:43], s49 offen sc1
    s_add_u32 s49, s55, 0
    buffer_load_dwordx2 v[88:89], v12, s[40:43], s49 offen offset:3072 sc1
    s_add_u32 s49, s55, 14336
    buffer_load_dwordx2 v[90:91], v12, s[40:43], s49 offen offset:3072 sc1
    s_add_u32 s49, s55, 5632
    buffer_load_dwordx4 v[92:95], v2, s[40:43], s49 offen sc1
    s_add_u32 s49, s55, 19968
    buffer_load_dwordx4 v[96:99], v2, s[40:43], s49 offen sc1
    s_add_u32 s49, s55, 3584
    buffer_load_dwordx2 v[100:101], v12, s[40:43], s49 offen offset:3072 sc1
    s_add_u32 s49, s55, 17920
    buffer_load_dwordx2 v[102:103], v12, s[40:43], s49 offen offset:3072 sc1
    s_add_u32 s49, s55, 9216
    buffer_load_dwordx4 v[104:107], v2, s[40:43], s49 offen sc1
    s_add_u32 s49, s55, 23552
    buffer_load_dwordx4 v[108:111], v2, s[40:43], s49 offen sc1
    s_add_u32 s48, s48, 1
    s_cmp_ge_u32 s48, 65536
    s_waitcnt vmcnt(0)
    s_cbranch_scc1 L_ok_115
    v_max_u32 v248, v65, v67
    v_cmp_eq_u32 vcc, -1, v248
    s_nop 0
    s_nop 3
    s_cbranch_vccnz L_re_114
L_ok_115:
    s_branch L_back_49
L_slow_50:
    s_nop 11
    s_mov_b32 s48, 0
L_re_116:
    s_add_u32 s49, s55, 18944
    buffer_load_dwordx4 v[68:71], v2, s[40:43], s49 offen sc1
    s_add_u32 s49, s55, 22528
    buffer_load_dwordx4 v[72:75], v2, s[40:43], s49 offen sc1
    s_add_u32 s49, s55, 26112
    buffer_load_dwordx4 v[76:79], v2, s[40:43], s49 offen sc1
    s_add_u32 s49, s55, 2048
    buffer_load_dwordx4 v[80:83], v2, s[40:43], s49 offen sc1
    s_add_u32 s49, s55, 16384
    buffer_load_dwordx4 v[84:87], v2, s[40:43], s49 offen sc1
    s_add_u32 s49, s55, 0
    buffer_load_dwordx2 v[88:89], v12, s[40:43], s49 offen offset:3072 sc1
    s_add_u32 s49, s55, 14336
    buffer_load_dwordx2 v[90:91], v12, s[40:43], s49 offen offset:3072 sc1
    s_add_u32 s49, s55, 5632
    buffer_load_dwordx4 v[92:95], v2, s[40:43], s49 offen sc1
    s_add_u32 s49, s55, 19968
    buffer_load_dwordx4 v[96:99], v2, s[40:43], s49 offen sc1
    s_add_u32 s49, s55, 3584
    buffer_load_dwordx2 v[100:101], v12, s[40:43], s49 offen offset:3072 sc1
    s_add_u32 s49, s55, 17920
    buffer_load_dwordx2 v[102:103], v12, s[40:43], s49 offen offset:3072 sc1
    s_add_u32 s49, s55, 9216
    buffer_load_dwordx4 v[104:107], v2, s[40:43], s49 offen sc1
    s_add_u32 s49, s55, 23552
    buffer_load_dwordx4 v[108:111], v2, s[40:43], s49 offen sc1
    s_add_u32 s49, s55, 7168
    buffer_load_dwordx2 v[112:113], v12, s[40:43], s49 offen offset:3072 sc1
    s_add_u32 s49, s55, 21504
    buffer_load_dwordx2 v[114:115], v12, s[40:43], s49 offen offset:3072 sc1
    s_add_u32 s48, s48, 1
    s_cmp_ge_u32 s48, 65536
    s_waitcnt vmcnt(0)
    s_cbranch_scc1 L_ok_117
    v_max_u32 v248, v69, v71
    v_cmp_eq_u32 vcc, -1, v248
    s_nop 0
    s_nop 3
    s_cbranch_vccnz L_re_116
L_ok_117:
    s_branch L_back_51
L_slow_52:
    s_nop 11
    s_mov_b32 s48, 0
L_re_118:
    s_add_u32 s49, s55, 22528
    buffer_load_dwordx4 v[72:75], v2, s[40:43], s49 offen sc1
    s_add_u32 s49, s55, 26112
    buffer_load_dwordx4 v[76:79], v2, s[40:43], s49 offen sc1
    s_add_u32 s49, s55, 2048
    buffer_load_dwordx4 v[80:83], v2, s[40:43], s49 offen sc1
    s_add_u32 s49, s55, 16384
    buffer_load_dwordx4 v[84:87], v2, s[40:43], s49 offen sc1
    s_add_u32 s49, s55, 0
    buffer_load_dwordx2 v[88:89], v12, s[40:43], s49 offen offset:3072 sc1
    s_add_u32 s49, s55, 14336
    buffer_load_dwordx2 v[90:91], v12, s[40:43], s49 offen offset:3072 sc1
    s_add_u32 s49, s55, 5632
    buffer_load_dwordx4 v[92:95], v2, s[40:43], s49 offen sc1
    s_add_u32 s49, s55, 19968
    buffer_load_dwordx4 v[96:99], v2, s[40:43], s49 offen sc1
    s_add_u32 s49, s55, 3584
    buffer_load_dwordx2 v[100:101], v12, s[40:43], s49 offen offset:3072 sc1
    s_add_u32 s49, s55, 17920
    buffer_load_dwordx2 v[102:103], v12, s[40:43], s49 offen offset:3072 sc1
    s_add_u32 s49, s55, 9216
    buffer_load_dwordx4 v[104:107], v2, s[40:43], s49 offen sc1
    s_add_u32 s49, s55, 23552
    buffer_load_dwordx4 v[108:111], v2, s[40:43], s49 offen sc1
    s_add_u32 s49, s55, 7168
    buffer_load_dwordx2 v[112:113], v12, s[40:43], s49 offen offset:3072 sc1
    s_add_u32 s49, s55, 21504
    buffer_load_dwordx2 v[114:115], v12, s[40:43], s49 offen offset:3072 sc1
    s_add_u32 s49, s55, 12800
    buffer_load_dwordx4 v[116:119], v2, s[40:43], s49 offen sc1
    s_add_u32 s48, s48, 1
    s_cmp_ge_u32 s48, 65536
    s_waitcnt vmcnt(0)
    s_cbranch_scc1 L_ok_119
    v_max_u32 v248, v73, v75
    v_cmp_eq_u32 vcc, -1, v248
    s_nop 0
    s_nop 3
    s_cbranch_vccnz L_re_118
L_ok_119:
    s_branch L_back_53
L_slow_54:
    s_nop 11
    s_mov_b32 s48, 0
L_re_120:
    s_add_u32 s49, s55, 26112
    buffer_load_dwordx4 v[76:79], v2, s[40:43], s49 offen sc1
    s_add_u32 s49, s55, 2048
    buffer_load_dwordx4 v[80:83], v2, s[40:43], s49 offen sc1
    s_add_u32 s49, s55, 16384
    buffer_load_dwordx4 v[84:87], v2, s[40:43], s49 offen sc1
    s_add_u32 s49, s55, 0
    buffer_load_dwordx2 v[88:89], v12, s[40:43], s49 offen offset:3072 sc1
    s_add_u32 s49, s55, 14336
    buffer_load_dwordx2 v[90:91], v12, s[40:43], s49 offen offset:3072 sc1
    s_add_u32 s49, s55, 5632
    buffer_load_dwordx4 v[92:95], v2, s[40:43], s49 offen sc1
    s_add_u32 s49, s55, 19968
    buffer_load_dwordx4 v[96:99], v2, s[40:43], s49 offen sc1
    s_add_u32 s49, s55, 3584
    buffer_load_dwordx2 v[100:101], v12, s[40:43], s49 offen offset:3072 sc1
    s_add_u32 s49, s55, 17920
    buffer_load_dwordx2 v[102:103], v12, s[40:43], s49 offen offset:3072 sc1
    s_add_u32 s49, s55, 9216
    buffer_load_dwordx4 v[104:107], v2, s[40:43], s49 offen sc1
    s_add_u32 s49, s55, 23552
    buffer_load_dwordx4 v[108:111], v2, s[40:43], s49 offen sc1
    s_add_u32 s49, s55, 7168
    buffer_load_dwordx2 v[112:113], v12, s[40:43], s49 offen offset:3072 sc1
    s_add_u32 s49, s55, 21504
    buffer_load_dwordx2 v[114:115], v12, s[40:43], s49 offen offset:3072 sc1
    s_add_u32 s49, s55, 12800
    buffer_load_dwordx4 v[116:119], v2, s[40:43], s49 offen sc1
    s_add_u32 s49, s55, 27136
    buffer_load_dwordx4 v[120:123], v2, s[40:43], s49 offen sc1
    s_add_u32 s48, s48, 1
    s_cmp_ge_u32 s48, 65536
    s_waitcnt vmcnt(0)
    s_cbranch_scc1 L_ok_121
    v_max_u32 v248, v77, v79
    v_cmp_eq_u32 vcc, -1, v248
    s_nop 0
    s_nop 3
    s_cbranch_vccnz L_re_120
L_ok_121:
    s_branch L_back_55
L_slow_56:
    s_nop 11
    s_mov_b32 s48, 0
L_re_122:
    s_add_u32 s49, s55, 2048
    buffer_load_dwordx4 v[80:83], v2, s[40:43], s49 offen sc1
    s_add_u32 s49, s55, 16384
    buffer_load_dwordx4 v[84:87], v2, s[40:43], s49 offen sc1
    s_add_u32 s49, s55, 0
    buffer_load_dwordx2 v[88:89], v12, s[40:43], s49 offen offset:3072 sc1
    s_add_u32 s49, s55, 14336
    buffer_load_dwordx2 v[90:91], v12, s[40:43], s49 offen offset:3072 sc1
    s_add_u32 s49, s55, 5632
    buffer_load_dwordx4 v[92:95], v2, s[40:43], s49 offen sc1
    s_add_u32 s49, s55, 19968
    buffer_load_dwordx4 v[96:99], v2, s[40:43], s49 offen sc1
    s_add_u32 s49, s55, 3584
    buffer_load_dwordx2 v[100:101], v12, s[40:43], s49 offen offset:3072 sc1
    s_add_u32 s49, s55, 17920
    buffer_load_dwordx2 v[102:103], v12, s[40:43], s49 offen offset:3072 sc1
    s_add_u32 s49, s55, 9216
    buffer_load_dwordx4 v[104:107], v2, s[40:43], s49 offen sc1
    s_add_u32 s49, s55, 23552
    buffer_load_dwordx4 v[108:111], v2, s[40:43], s49 offen sc1
    s_add_u32 s49, s55, 7168
    buffer_load_dwordx2 v[112:113], v12, s[40:43], s49 offen offset:3072 sc1
    s_add_u32 s49, s55, 21504
    buffer_load_dwordx2 v[114:115], v12, s[40:43], s49 offen offset:3072 sc1
    s_add_u32 s49, s55, 12800
    buffer_load_dwordx4 v[116:119], v2, s[40:43], s49 offen sc1
    s_add_u32 s49, s55, 27136
    buffer_load_dwordx4 v[120:123], v2, s[40:43], s49 offen sc1
    s_add_u32 s49, s55, 10752
    buffer_load_dwordx2 v[124:125], v12, s[40:43], s49 offen offset:3072 sc1
    s_add_u32 s49, s55, 25088
    buffer_load_dwordx2 v[126:127], v12, s[40:43], s49 offen offset:3072 sc1
    s_add_u32 s48, s48, 1
    s_cmp_ge_u32 s48, 65536
    s_waitcnt vmcnt(0)
    s_cbranch_scc1 L_ok_123
    v_max_u32 v248, v81, v83
    v_cmp_eq_u32 vcc, -1, v248
    s_nop 0
    s_nop 3
    s_cbranch_vccnz L_re_122
L_ok_123:
    s_branch L_back_57
L_slow_58:
    s_nop 11
    s_mov_b32 s48, 0
L_re_124:
    s_add_u32 s49, s55, 16384
    buffer_load_dwordx4 v[84:87], v2, s[40:43], s49 offen sc1
    s_add_u32 s49, s55, 0
    buffer_load_dwordx2 v[88:89], v12, s[40:43], s49 offen offset:3072 sc1
    s_add_u32 s49, s55, 14336
    buffer_load_dwordx2 v[90:91], v12, s[40:43], s49 offen offset:3072 sc1
    s_add_u32 s49, s55, 5632
    buffer_load_dwordx4 v[92:95], v2, s[40:43], s49 offen sc1
    s_add_u32 s49, s55, 19968
    buffer_load_dwordx4 v[96:99], v2, s[40:43], s49 offen sc1
    s_add_u32 s49, s55, 3584
    buffer_load_dwordx2 v[100:101], v12, s[40:43], s49 offen offset:3072 sc1
    s_add_u32 s49, s55, 17920
    buffer_load_dwordx2 v[102:103], v12, s[40:43], s49 offen offset:3072 sc1
    s_add_u32 s49, s55, 9216
    buffer_load_dwordx4 v[104:107], v2, s[40:43], s49 offen sc1
    s_add_u32 s49, s55, 23552
    buffer_load_dwordx4 v[108:111], v2, s[40:43], s49 offen sc1
    s_add_u32 s49, s55, 7168
    buffer_load_dwordx2 v[112:113], v12, s[40:43], s49 offen offset:3072 sc1
    s_add_u32 s49, s55, 21504
    buffer_load_dwordx2 v[114:115], v12, s[40:43], s49 offen offset:3072 sc1
    s_add_u32 s49, s55, 12800
    buffer_load_dwordx4 v[116:119], v2, s[40:43], s49 offen sc1
    s_add_u32 s49, s55, 27136
    buffer_load_dwordx4 v[120:123], v2, s[40:43], s49 offen sc1
    s_add_u32 s49, s55, 10752
    buffer_load_dwordx2 v[124:125], v12, s[40:43], s49 offen offset:3072 sc1
    s_add_u32 s49, s55, 25088
    buffer_load_dwordx2 v[126:127], v12, s[40:43], s49 offen offset:3072 sc1
    s_add_u32 s48, s48, 1
    s_cmp_ge_u32 s48, 65536
    s_waitcnt vmcnt(0)
    s_cbranch_scc1 L_ok_125
    v_max_u32 v248, v85, v87
    v_cmp_eq_u32 vcc, -1, v248
    s_nop 0
    s_nop 3
    s_cbranch_vccnz L_re_124
L_ok_125:
    s_branch L_back_59
L_slow_60:
    s_nop 11
    s_mov_b32 s48, 0
L_re_126:
    s_add_u32 s49, s55, 0
    buffer_load_dwordx2 v[88:89], v12, s[40:43], s49 offen offset:3072 sc1
    s_add_u32 s49, s55, 14336
    buffer_load_dwordx2 v[90:91], v12, s[40:43], s49 offen offset:3072 sc1
    s_add_u32 s49, s55, 5632
    buffer_load_dwordx4 v[92:95], v2, s[40:43], s49 offen sc1
    s_add_u32 s49, s55, 19968
    buffer_load_dwordx4 v[96:99], v2, s[40:43], s49 offen sc1
    s_add_u32 s49, s55, 3584
    buffer_load_dwordx2 v[100:101], v12, s[40:43], s49 offen offset:3072 sc1
    s_add_u32 s49, s55, 17920
    buffer_load_dwordx2 v[102:103], v12, s[40:43], s49 offen offset:3072 sc1
    s_add_u32 s49, s55, 9216
    buffer_load_dwordx4 v[104:107], v2, s[40:43], s49 offen sc1
    s_add_u32 s49, s55, 23552
    buffer_load_dwordx4 v[108:111], v2, s[40:43], s49 offen sc1
    s_add_u32 s49, s55, 7168
    buffer_load_dwordx2 v[112:113], v12, s[40:43], s49 offen offset:3072 sc1
    s_add_u32 s49, s55, 21504
    buffer_load_dwordx2 v[114:115], v12, s[40:43], s49 offen offset:3072 sc1
    s_add_u32 s49, s55, 12800
    buffer_load_dwordx4 v[116:119], v2, s[40:43], s49 offen sc1
    s_add_u32 s49, s55, 27136
    buffer_load_dwordx4 v[120:123], v2, s[40:43], s49 offen sc1
    s_add_u32 s49, s55, 10752
    buffer_load_dwordx2 v[124:125], v12, s[40:43], s49 offen offset:3072 sc1
    s_add_u32 s49, s55, 25088
    buffer_load_dwordx2 v[126:127], v12, s[40:43], s49 offen offset:3072 sc1
    s_add_u32 s48, s48, 1
    s_cmp_ge_u32 s48, 65536
    s_waitcnt vmcnt(0)
    s_cbranch_scc1 L_ok_127
    v_max_u32 v248, v89, v91
    v_cmp_eq_u32 vcc, -1, v248
    s_nop 0
    s_nop 3
    s_cbranch_vccnz L_re_126
L_ok_127:
    s_branch L_back_61
L_slow_62:
    s_nop 11
    s_mov_b32 s48, 0
L_re_128:
    s_add_u32 s49, s55, 5632
    buffer_load_dwordx4 v[92:95], v2, s[40:43], s49 offen sc1
    s_add_u32 s49, s55, 19968
    buffer_load_dwordx4 v[96:99], v2, s[40:43], s49 offen sc1
    s_add_u32 s49, s55, 3584
    buffer_load_dwordx2 v[100:101], v12, s[40:43], s49 offen offset:3072 sc1
    s_add_u32 s49, s55, 17920
    buffer_load_dwordx2 v[102:103], v12, s[40:43], s49 offen offset:3072 sc1
    s_add_u32 s49, s55, 9216
    buffer_load_dwordx4 v[104:107], v2, s[40:43], s49 offen sc1
    s_add_u32 s49, s55, 23552
    buffer_load_dwordx4 v[108:111], v2, s[40:43], s49 offen sc1
    s_add_u32 s49, s55, 7168
    buffer_load_dwordx2 v[112:113], v12, s[40:43], s49 offen offset:3072 sc1
    s_add_u32 s49, s55, 21504
    buffer_load_dwordx2 v[114:115], v12, s[40:43], s49 offen offset:3072 sc1
    s_add_u32 s49, s55, 12800
    buffer_load_dwordx4 v[116:119], v2, s[40:43], s49 offen sc1
    s_add_u32 s49, s55, 27136
    buffer_load_dwordx4 v[120:123], v2, s[40:43], s49 offen sc1
    s_add_u32 s49, s55, 10752
    buffer_load_dwordx2 v[124:125], v12, s[40:43], s49 offen offset:3072 sc1
    s_add_u32 s49, s55, 25088
    buffer_load_dwordx2 v[126:127], v12, s[40:43], s49 offen offset:3072 sc1
    s_add_u32 s48, s48, 1
    s_cmp_ge_u32 s48, 65536
    s_waitcnt vmcnt(0)
    s_cbranch_scc1 L_ok_129
    v_max_u32 v248, v93, v95
    v_cmp_eq_u32 vcc, -1, v248
    s_nop 0
    s_nop 3
    s_cbranch_vccnz L_re_128
L_ok_129:
    s_branch L_back_63
L_slow_64:
    s_nop 11
    s_mov_b32 s48, 0
L_re_130:
    s_add_u32 s49, s55, 19968
    buffer_load_dwordx4 v[96:99], v2, s[40:43], s49 offen sc1
    s_add_u32 s49, s55, 3584
    buffer_load_dwordx2 v[100:101], v12, s[40:43], s49 offen offset:3072 sc1
    s_add_u32 s49, s55, 17920
    buffer_load_dwordx2 v[102:103], v12, s[40:43], s49 offen offset:3072 sc1
    s_add_u32 s49, s55, 9216
    buffer_load_dwordx4 v[104:107], v2, s[40:43], s49 offen sc1
    s_add_u32 s49, s55, 23552
    buffer_load_dwordx4 v[108:111], v2, s[40:43], s49 offen sc1
    s_add_u32 s49, s55, 7168
    buffer_load_dwordx2 v[112:113], v12, s[40:43], s49 offen offset:3072 sc1
    s_add_u32 s49, s55, 21504
    buffer_load_dwordx2 v[114:115], v12, s[40:43], s49 offen offset:3072 sc1
    s_add_u32 s49, s55, 12800
    buffer_load_dwordx4 v[116:119], v2, s[40:43], s49 offen sc1
    s_add_u32 s49, s55, 27136
    buffer_load_dwordx4 v[120:123], v2, s[40:43], s49 offen sc1
    s_add_u32 s49, s55, 10752
    buffer_load_dwordx2 v[124:125], v12, s[40:43], s49 offen offset:3072 sc1
    s_add_u32 s49, s55, 25088
    buffer_load_dwordx2 v[126:127], v12, s[40:43], s49 offen offset:3072 sc1
    s_add_u32 s48, s48, 1
    s_cmp_ge_u32 s48, 65536
    s_waitcnt vmcnt(0)
    s_cbranch_scc1 L_ok_131
    v_max_u32 v248, v97, v99
    v_cmp_eq_u32 vcc, -1, v248
    s_nop 0
    s_nop 3
    s_cbranch_vccnz L_re_130
L_ok_131:
    s_branch L_back_65
L_slow_66:
    s_nop 11
    s_mov_b32 s48, 0
L_re_132:
    s_add_u32 s49, s55, 3584
    buffer_load_dwordx2 v[100:101], v12, s[40:43], s49 offen offset:3072 sc1
    s_add_u32 s49, s55, 17920
    buffer_load_dwordx2 v[102:103], v12, s[40:43], s49 offen offset:3072 sc1
    s_add_u32 s49, s55, 9216
    buffer_load_dwordx4 v[104:107], v2, s[40:43], s49 offen sc1
    s_add_u32 s49, s55, 23552
    buffer_load_dwordx4 v[108:111], v2, s[40:43], s49 offen sc1
    s_add_u32 s49, s55, 7168
    buffer_load_dwordx2 v[112:113], v12, s[40:43], s49 offen offset:3072 sc1
    s_add_u32 s49, s55, 21504
    buffer_load_dwordx2 v[114:115], v12, s[40:43], s49 offen offset:3072 sc1
    s_add_u32 s49, s55, 12800
    buffer_load_dwordx4 v[116:119], v2, s[40:43], s49 offen sc1
    s_add_u32 s49, s55, 27136
    buffer_load_dwordx4 v[120:123], v2, s[40:43], s49 offen sc1
    s_add_u32 s49, s55, 10752
    buffer_load_dwordx2 v[124:125], v12, s[40:43], s49 offen offset:3072 sc1
    s_add_u32 s49, s55, 25088
    buffer_load_dwordx2 v[126:127], v12, s[40:43], s49 offen offset:3072 sc1
    s_add_u32 s48, s48, 1
    s_cmp_ge_u32 s48, 65536
    s_waitcnt vmcnt(0)
    s_cbranch_scc1 L_ok_133
    v_max_u32 v248, v101, v103
    v_cmp_eq_u32 vcc, -1, v248
    s_nop 0
    s_nop 3
    s_cbranch_vccnz L_re_132
L_ok_133:
    s_branch L_back_67
L_slow_68:
    s_nop 11
    s_mov_b32 s48, 0
L_re_134:
    s_add_u32 s49, s55, 9216
    buffer_load_dwordx4 v[104:107], v2, s[40:43], s49 offen sc1
    s_add_u32 s49, s55, 23552
    buffer_load_dwordx4 v[108:111], v2, s[40:43], s49 offen sc1
    s_add_u32 s49, s55, 7168
    buffer_load_dwordx2 v[112:113], v12, s[40:43], s49 offen offset:3072 sc1
    s_add_u32 s49, s55, 21504
    buffer_load_dwordx2 v[114:115], v12, s[40:43], s49 offen offset:3072 sc1
    s_add_u32 s49, s55, 12800
    buffer_load_dwordx4 v[116:119], v2, s[40:43], s49 offen sc1
    s_add_u32 s49, s55, 27136
    buffer_load_dwordx4 v[120:123], v2, s[40:43], s49 offen sc1
    s_add_u32 s49, s55, 10752
    buffer_load_dwordx2 v[124:125], v12, s[40:43], s49 offen offset:3072 sc1
    s_add_u32 s49, s55, 25088
    buffer_load_dwordx2 v[126:127], v12, s[40:43], s49 offen offset:3072 sc1
    s_add_u32 s48, s48, 1
    s_cmp_ge_u32 s48, 65536
    s_waitcnt vmcnt(0)
    s_cbranch_scc1 L_ok_135
    v_max_u32 v248, v105, v107
    v_cmp_eq_u32 vcc, -1, v248
    s_nop 0
    s_nop 3
    s_cbranch_vccnz L_re_134
L_ok_135:
    s_branch L_back_69
L_slow_70:
    s_nop 11
    s_mov_b32 s48, 0
L_re_136:
    s_add_u32 s49, s55, 23552
    buffer_load_dwordx4 v[108:111], v2, s[40:43], s49 offen sc1
    s_add_u32 s49, s55, 7168
    buffer_load_dwordx2 v[112:113], v12, s[40:43], s49 offen offset:3072 sc1
    s_add_u32 s49, s55, 21504
    buffer_load_dwordx2 v[114:115], v12, s[40:43], s49 offen offset:3072 sc1
    s_add_u32 s49, s55, 12800
    buffer_load_dwordx4 v[116:119], v2, s[40:43], s49 offen sc1
    s_add_u32 s49, s55, 27136
    buffer_load_dwordx4 v[120:123], v2, s[40:43], s49 offen sc1
    s_add_u32 s49, s55, 10752
    buffer_load_dwordx2 v[124:125], v12, s[40:43], s49 offen offset:3072 sc1
    s_add_u32 s49, s55, 25088
    buffer_load_dwordx2 v[126:127], v12, s[40:43], s49 offen offset:3072 sc1
    s_add_u32 s48, s48, 1
    s_cmp_ge_u32 s48, 65536
    s_waitcnt vmcnt(0)
    s_cbranch_scc1 L_ok_137
    v_max_u32 v248, v109, v111
    v_cmp_eq_u32 vcc, -1, v248
    s_nop 0
    s_nop 3
    s_cbranch_vccnz L_re_136
L_ok_137:
    s_branch L_back_71
L_slow_72:
    s_nop 11
    s_mov_b32 s48, 0
L_re_138:
    s_add_u32 s49, s55, 7168
    buffer_load_dwordx2 v[112:113], v12, s[40:43], s49 offen offset:3072 sc1
    s_add_u32 s49, s55, 21504
    buffer_load_dwordx2 v[114:115], v12, s[40:43], s49 offen offset:3072 sc1
    s_add_u32 s49, s55, 12800
    buffer_load_dwordx4 v[116:119], v2, s[40:43], s49 offen sc1
    s_add_u32 s49, s55, 27136
    buffer_load_dwordx4 v[120:123], v2, s[40:43], s49 offen sc1
    s_add_u32 s49, s55, 10752
    buffer_load_dwordx2 v[124:125], v12, s[40:43], s49 offen offset:3072 sc1
    s_add_u32 s49, s55, 25088
    buffer_load_dwordx2 v[126:127], v12, s[40:43], s49 offen offset:3072 sc1
    s_add_u32 s48, s48, 1
    s_cmp_ge_u32 s48, 65536
    s_waitcnt vmcnt(0)
    s_cbranch_scc1 L_ok_139
    v_max_u32 v248, v113, v115
    v_cmp_eq_u32 vcc, -1, v248
    s_nop 0
    s_nop 3
    s_cbranch_vccnz L_re_138
L_ok_139:
    s_branch L_back_73
L_slow_74:
    s_nop 11
    s_mov_b32 s48, 0
L_re_140:
    s_add_u32 s49, s55, 12800
    buffer_load_dwordx4 v[116:119], v2, s[40:43], s49 offen sc1
    s_add_u32 s49, s55, 27136
    buffer_load_dwordx4 v[120:123], v2, s[40:43], s49 offen sc1
    s_add_u32 s49, s55, 10752
    buffer_load_dwordx2 v[124:125], v12, s[40:43], s49 offen offset:3072 sc1
    s_add_u32 s49, s55, 25088
    buffer_load_dwordx2 v[126:127], v12, s[40:43], s49 offen offset:3072 sc1
    s_add_u32 s48, s48, 1
    s_cmp_ge_u32 s48, 65536
    s_waitcnt vmcnt(0)
    s_cbranch_scc1 L_ok_141
    v_max_u32 v248, v117, v119
    v_cmp_eq_u32 vcc, -1, v248
    s_nop 0
    s_nop 3
    s_cbranch_vccnz L_re_140
L_ok_141:
    s_branch L_back_75
L_slow_76:
    s_nop 11
    s_mov_b32 s48, 0
L_re_142:
    s_add_u32 s49, s55, 27136
    buffer_load_dwordx4 v[120:123], v2, s[40:43], s49 offen sc1
    s_add_u32 s49, s55, 10752
    buffer_load_dwordx2 v[124:125], v12, s[40:43], s49 offen offset:3072 sc1
    s_add_u32 s49, s55, 25088
    buffer_load_dwordx2 v[126:127], v12, s[40:43], s49 offen offset:3072 sc1
    s_add_u32 s48, s48, 1
    s_cmp_ge_u32 s48, 65536
    s_waitcnt vmcnt(0)
    s_cbranch_scc1 L_ok_143
    v_max_u32 v248, v121, v123
    v_cmp_eq_u32 vcc, -1, v248
    s_nop 0
    s_nop 3
    s_cbranch_vccnz L_re_142
L_ok_143:
    s_branch L_back_77
L_slow_78:
    s_nop 11
    s_mov_b32 s48, 0
L_re_144:
    s_add_u32 s49, s55, 10752
    buffer_load_dwordx2 v[124:125], v12, s[40:43], s49 offen offset:3072 sc1
    s_add_u32 s49, s55, 25088
    buffer_load_dwordx2 v[126:127], v12, s[40:43], s49 offen offset:3072 sc1
    s_add_u32 s48, s48, 1
    s_cmp_ge_u32 s48, 65536
    s_waitcnt vmcnt(0)
    s_cbranch_scc1 L_ok_145
    v_max_u32 v248, v125, v127
    v_cmp_eq_u32 vcc, -1, v248
    s_nop 0
    s_nop 3
    s_cbranch_vccnz L_re_144
L_ok_145:
    s_branch L_back_79
.type L_pad,@object
L_pad:
.fill 2048, 4, 0xbf800000
L_padend:
.section .rodata,"a"
.p2align 6
.amdhsa_kernel sequential_preLN__spectral_gfnet__mixer_gmlp__prompt_kernel
  .amdhsa_next_free_vgpr 512
  .amdhsa_next_free_sgpr 102
  .amdhsa_accum_offset 256
  .amdhsa_group_segment_fixed_size 0
  .amdhsa_kernarg_size 88
  .amdhsa_user_sgpr_count 2
  .amdhsa_user_sgpr_kernarg_segment_ptr 1
  .amdhsa_system_sgpr_workgroup_id_x 1
  .amdhsa_float_denorm_mode_32 3
.end_amdhsa_kernel
```
